```python
import torch

def _softmax(x, axis=-1):
    return torch.softmax(x, dim=axis)

def _gelu(x):
    return torch.nn.functional.gelu(x, approximate='tanh')

def _silu(x):
    return torch.nn.functional.silu(x)

def _sigmoid(x):
    return torch.sigmoid(x)

def _layernorm(x, axis=-1, eps=1e-05):
    m = x.mean(dim=axis, keepdim=True)
    v = x.var(dim=axis, keepdim=True, unbiased=False)
    return (x - m) / torch.sqrt(v + eps)

def _scatter_add(tgt, idx, src, axis=0):
    return tgt.clone().index_add_(axis, idx, src)

def _segment_sum(src, seg, n):
    out = torch.zeros((n,) + src.shape[1:], dtype=src.dtype)
    return out.index_add_(0, seg, src)

def _pad(x, pw):
    flat = tuple((v for pair in reversed(pw) for v in pair))
    return torch.nn.functional.pad(x, flat)
kernel_name = 'standalone__swin_window_attn__vision'

def setup_inputs():

    _w = lambda a: (lambda t: t.to(torch.bfloat16) if t.is_floating_point() else t)(torch.as_tensor(a))
    H = W = 384 // 7 * 7
    C, win = (384, 7)
    return {'x': _w((lambda *s: torch.randn(*s, dtype=torch.bfloat16) * 0.2)(1, H, W, C)), 'wqkv': _w((lambda *s: torch.randn(*s, dtype=torch.bfloat16) * 0.2)(C, 3 * C)), 'wo': _w((lambda *s: torch.randn(*s, dtype=torch.bfloat16) * 0.05)(C, C))}

def reference(x, wqkv, wo):
    B, H, W, C = x.shape
    win = 7
    nh, nw = (H // win, W // win)
    xw = (lambda x, *d: x.permute(*d))(x.reshape(B, nh, win, nw, win, C), 0, 1, 3, 2, 4, 5)
    xw = xw.reshape(B * nh * nw, win * win, C)
    qkv = xw @ wqkv
    q, k, v = (qkv[..., :C].clone(), qkv[..., C:2 * C].clone(), qkv[..., 2 * C:].clone())
    scale = C ** (-0.5)
    p = _softmax(torch.einsum('bqc,bkc->bqk', q, k) * scale, axis=-1)
    o = torch.einsum('bqk,bkc->bqc', p, v) @ wo
    o = (lambda x, *d: x.permute(*d))(o.reshape(B, nh, nw, win, win, C), 0, 1, 3, 2, 4, 5)
    return o.reshape(B, H, W, C)
```

```asm
; @launch grid=(255,1,1) block=(256,1,1) lds=163840
.amdgcn_target "amdgcn-amd-amdhsa--gfx950"
.text
.globl standalone__swin_window_attn__vision_kernel
.p2align 8
.type standalone__swin_window_attn__vision_kernel,@function
standalone__swin_window_attn__vision_kernel:
s_cmp_ge_u32 s2, 255
s_cbranch_scc1 L_end
s_load_dwordx2 s[28:29], s[0:1], 0
s_load_dwordx2 s[30:31], s[0:1], 40
s_load_dwordx2 s[32:33], s[0:1], 24
s_load_dwordx2 s[34:35], s[0:1], 32
s_load_dwordx4 s[84:87], s[0:1], 8
v_lshrrev_b32 v115, 6, v0
s_nop 0
v_readfirstlane_b32 s16, v115
v_and_b32 v0, 63, v0
s_nop 2
s_mul_i32 s17, s16, 6144
v_mov_b32 v112, v0
v_and_b32 v113, 15, v0
v_lshrrev_b32 v114, 4, v0
v_lshlrev_b32 v252, 4, v0
v_add_u32 v251, s17, v252
s_waitcnt lgkmcnt(0)
s_mov_b32 s12, s30
s_mov_b32 s13, s31
s_mov_b32 s14, 589824
s_mov_b32 s15, 0x20000
s_mov_b32 s76, s84
s_mov_b32 s77, s85
s_mov_b32 s78, 884736
s_mov_b32 s79, 0x20000
s_mov_b32 s80, s86
s_mov_b32 s81, s87
s_mov_b32 s82, 294912
s_mov_b32 s83, 0x20000
s_mov_b32 s4, s28
s_mov_b32 s5, s29
s_mov_b32 s6, 109734912
s_mov_b32 s7, 0x20000
s_mov_b32 s40, s30
s_mov_b32 s41, s31
s_mov_b32 s42, 6370816
s_mov_b32 s43, 0x20000
s_mov_b32 s8, s32
s_mov_b32 s9, s33
s_mov_b32 s10, 0
s_mov_b32 s11, 0x20000
s_mov_b32 s44, s34
s_mov_b32 s45, s35
s_mov_b32 s46, 256
s_mov_b32 s47, 0x20000
s_cmp_lt_u32 s2, 12
s_cbranch_scc1 L_prod
s_sub_u32 s39, s2, 12
s_cmp_ge_u32 s39, 144
s_cbranch_scc1 L_noprep
s_cmp_ge_u32 s39, 72
s_cselect_b32 s20, 1, 0
s_mul_i32 s23, s20, 72
s_sub_u32 s23, s39, s23
s_mul_i32 s21, s23, 10923
s_lshr_b32 s21, s21, 16
s_mul_i32 s22, s21, 6
s_sub_u32 s22, s23, s22
v_and_b32 v1, 15, v0
v_lshrrev_b32 v2, 4, v0
s_lshl_b32 s23, s16, 2
v_add_u32 v3, s23, v2
v_xor_b32 v3, v3, v1
v_lshlrev_b32 v3, 4, v3
s_lshl_b32 s23, s21, 5
s_lshl_b32 s24, s16, 3
s_add_u32 s23, s23, s24
v_add_u32 v4, s23, v2
v_mul_u32_u24 v4, 2304, v4
v_add_u32 v4, v4, v3
s_mul_i32 s24, s20, 1536
s_lshl_b32 s25, s16, 11
s_add_u32 m0, s25, 0
s_nop 0
buffer_load_dwordx4 v4, s[76:79], s24 offen offset:0 lds
s_add_u32 m0, s25, 7936
s_nop 0
buffer_load_dwordx4 v4, s[76:79], s24 offen offset:256 lds
s_add_u32 m0, s25, 15872
s_nop 0
buffer_load_dwordx4 v4, s[76:79], s24 offen offset:512 lds
s_add_u32 s24, s24, 9216
s_add_u32 m0, s25, 1024
s_nop 0
buffer_load_dwordx4 v4, s[76:79], s24 offen offset:0 lds
s_add_u32 m0, s25, 8960
s_nop 0
buffer_load_dwordx4 v4, s[76:79], s24 offen offset:256 lds
s_add_u32 m0, s25, 16896
s_nop 0
buffer_load_dwordx4 v4, s[76:79], s24 offen offset:512 lds
v_lshrrev_b32 v5, 2, v1
v_lshlrev_b32 v5, 3, v5
v_and_b32 v6, 3, v1
v_add_u32 v5, v5, v6
v_lshlrev_b32 v7, 8, v5
v_add_u32 v6, 0, v2
v_xor_b32 v6, v6, v1
v_lshlrev_b32 v8, 4, v6
v_add_u32 v12, v8, v7
v_add_u32 v12, 0, v12
v_add_u32 v6, 4, v2
v_xor_b32 v6, v6, v1
v_lshlrev_b32 v9, 4, v6
v_add_u32 v13, v9, v7
v_add_u32 v13, 0, v13
v_add_u32 v6, 8, v2
v_xor_b32 v6, v6, v1
v_lshlrev_b32 v10, 4, v6
v_add_u32 v14, v10, v7
v_add_u32 v14, 0, v14
v_add_u32 v6, 12, v2
v_xor_b32 v6, v6, v1
v_lshlrev_b32 v11, 4, v6
v_add_u32 v15, v11, v7
v_add_u32 v15, 0, v15
s_cmp_eq_u32 s20, 1
s_cbranch_scc1 L_prep_m1
s_lshl_b32 s23, s22, 2
s_add_u32 s23, s23, s16
s_lshr_b32 s24, s23, 1
s_lshl_b32 s24, s24, 5
s_and_b32 s26, s23, 1
s_lshl_b32 s26, s26, 2
s_add_u32 s24, s24, s26
s_mul_i32 s25, s16, 12288
v_add_u32 v16, 0, v2
v_xor_b32 v16, v16, v1
v_lshlrev_b32 v16, 4, v16
v_add_u32 v17, s24, v2
v_add_u32 v17, 0, v17
v_mul_u32_u24 v17, 2304, v17
v_add_u32 v16, v16, v17
v_add_u32 v16, 768, v16
s_add_u32 m0, s25, 24576
s_nop 0
buffer_load_dwordx4 v16, s[76:79], 0 offen offset:0 lds
s_add_u32 m0, s25, 28416
s_nop 0
buffer_load_dwordx4 v16, s[76:79], 0 offen offset:256 lds
s_add_u32 m0, s25, 32256
s_nop 0
buffer_load_dwordx4 v16, s[76:79], 0 offen offset:512 lds
v_add_u32 v16, 4, v2
v_xor_b32 v16, v16, v1
v_lshlrev_b32 v16, 4, v16
v_add_u32 v17, s24, v2
v_add_u32 v17, 8, v17
v_mul_u32_u24 v17, 2304, v17
v_add_u32 v16, v16, v17
v_add_u32 v16, 768, v16
s_add_u32 m0, s25, 25600
s_nop 0
buffer_load_dwordx4 v16, s[76:79], 0 offen offset:0 lds
s_add_u32 m0, s25, 29440
s_nop 0
buffer_load_dwordx4 v16, s[76:79], 0 offen offset:256 lds
s_add_u32 m0, s25, 33280
s_nop 0
buffer_load_dwordx4 v16, s[76:79], 0 offen offset:512 lds
v_add_u32 v16, 8, v2
v_xor_b32 v16, v16, v1
v_lshlrev_b32 v16, 4, v16
v_add_u32 v17, s24, v2
v_add_u32 v17, 16, v17
v_mul_u32_u24 v17, 2304, v17
v_add_u32 v16, v16, v17
v_add_u32 v16, 768, v16
s_add_u32 m0, s25, 26624
s_nop 0
buffer_load_dwordx4 v16, s[76:79], 0 offen offset:0 lds
s_add_u32 m0, s25, 30464
s_nop 0
buffer_load_dwordx4 v16, s[76:79], 0 offen offset:256 lds
s_add_u32 m0, s25, 34304
s_nop 0
buffer_load_dwordx4 v16, s[76:79], 0 offen offset:512 lds
v_add_u32 v16, 12, v2
v_xor_b32 v16, v16, v1
v_lshlrev_b32 v16, 4, v16
v_add_u32 v17, s24, v2
v_add_u32 v17, 24, v17
v_mul_u32_u24 v17, 2304, v17
v_add_u32 v16, v16, v17
v_add_u32 v16, 768, v16
s_add_u32 m0, s25, 27648
s_nop 0
buffer_load_dwordx4 v16, s[76:79], 0 offen offset:0 lds
s_add_u32 m0, s25, 31488
s_nop 0
buffer_load_dwordx4 v16, s[76:79], 0 offen offset:256 lds
s_add_u32 m0, s25, 35328
s_nop 0
buffer_load_dwordx4 v16, s[76:79], 0 offen offset:512 lds
v_lshl_add_u32 v16, v1, 8, v8
v_add_u32 v16, s25, v16
v_add_u32 v16, 24576, v16
v_lshl_add_u32 v17, v1, 8, v9
v_add_u32 v17, s25, v17
v_add_u32 v17, 24576, v17
v_lshl_add_u32 v18, v1, 8, v10
v_add_u32 v18, s25, v18
v_add_u32 v18, 24576, v18
v_lshl_add_u32 v19, v1, 8, v11
v_add_u32 v19, s25, v19
v_add_u32 v19, 24576, v19
s_mul_i32 s23, s23, 12
s_add_u32 s23, s23, s21
s_lshl_b32 s23, s23, 10
v_lshlrev_b32 v20, 4, v0
s_waitcnt vmcnt(0)
s_barrier
ds_read_b128 v[128:131], v16 offset:0
ds_read_b128 v[132:135], v17 offset:0
ds_read_b128 v[136:139], v18 offset:0
ds_read_b128 v[140:143], v19 offset:0
ds_read_b128 v[144:147], v16 offset:4096
ds_read_b128 v[148:151], v17 offset:4096
ds_read_b128 v[152:155], v18 offset:4096
ds_read_b128 v[156:159], v19 offset:4096
ds_read_b128 v[160:163], v16 offset:8192
ds_read_b128 v[164:167], v17 offset:8192
ds_read_b128 v[168:171], v18 offset:8192
ds_read_b128 v[172:175], v19 offset:8192
ds_read_b128 v[32:35], v12 offset:0
ds_read_b128 v[36:39], v13 offset:0
ds_read_b128 v[40:43], v14 offset:0
s_waitcnt lgkmcnt(14)
ds_read_b128 v[44:47], v15 offset:0
s_waitcnt lgkmcnt(14)
ds_read_b128 v[48:51], v12 offset:8192
s_waitcnt lgkmcnt(14)
ds_read_b128 v[52:55], v13 offset:8192
s_waitcnt lgkmcnt(14)
ds_read_b128 v[56:59], v14 offset:8192
s_waitcnt lgkmcnt(14)
ds_read_b128 v[60:63], v15 offset:8192
s_waitcnt lgkmcnt(14)
ds_read_b128 v[64:67], v12 offset:16384
s_waitcnt lgkmcnt(14)
ds_read_b128 v[68:71], v13 offset:16384
s_waitcnt lgkmcnt(14)
ds_read_b128 v[72:75], v14 offset:16384
s_waitcnt lgkmcnt(14)
ds_read_b128 v[76:79], v15 offset:16384
s_waitcnt lgkmcnt(14)
ds_read_b128 v[80:83], v12 offset:1024
s_waitcnt lgkmcnt(14)
ds_read_b128 v[84:87], v13 offset:1024
s_waitcnt lgkmcnt(14)
ds_read_b128 v[88:91], v14 offset:1024
s_waitcnt lgkmcnt(14)
ds_read_b128 v[92:95], v15 offset:1024
s_waitcnt lgkmcnt(14)
ds_read_b128 v[96:99], v12 offset:9216
s_waitcnt lgkmcnt(14)
ds_read_b128 v[100:103], v13 offset:9216
s_waitcnt lgkmcnt(14)
ds_read_b128 v[104:107], v14 offset:9216
s_waitcnt lgkmcnt(14)
ds_read_b128 v[108:111], v15 offset:9216
s_waitcnt lgkmcnt(14)
ds_read_b128 v[112:115], v12 offset:17408
s_waitcnt lgkmcnt(14)
ds_read_b128 v[116:119], v13 offset:17408
s_waitcnt lgkmcnt(14)
ds_read_b128 v[120:123], v14 offset:17408
s_waitcnt lgkmcnt(14)
ds_read_b128 v[124:127], v15 offset:17408
v_mfma_f32_16x16x32_bf16 v[176:179], v[32:35], v[128:131], 0
s_waitcnt lgkmcnt(11)
v_mfma_f32_16x16x32_bf16 v[180:183], v[80:83], v[128:131], 0
v_mfma_f32_16x16x32_bf16 v[176:179], v[36:39], v[132:135], v[176:179]
s_waitcnt lgkmcnt(10)
v_mfma_f32_16x16x32_bf16 v[180:183], v[84:87], v[132:135], v[180:183]
v_mfma_f32_16x16x32_bf16 v[176:179], v[40:43], v[136:139], v[176:179]
s_waitcnt lgkmcnt(9)
v_mfma_f32_16x16x32_bf16 v[180:183], v[88:91], v[136:139], v[180:183]
v_mfma_f32_16x16x32_bf16 v[176:179], v[44:47], v[140:143], v[176:179]
s_waitcnt lgkmcnt(8)
v_mfma_f32_16x16x32_bf16 v[180:183], v[92:95], v[140:143], v[180:183]
v_mfma_f32_16x16x32_bf16 v[176:179], v[48:51], v[144:147], v[176:179]
s_waitcnt lgkmcnt(7)
v_mfma_f32_16x16x32_bf16 v[180:183], v[96:99], v[144:147], v[180:183]
v_mfma_f32_16x16x32_bf16 v[176:179], v[52:55], v[148:151], v[176:179]
s_waitcnt lgkmcnt(6)
v_mfma_f32_16x16x32_bf16 v[180:183], v[100:103], v[148:151], v[180:183]
v_mfma_f32_16x16x32_bf16 v[176:179], v[56:59], v[152:155], v[176:179]
s_waitcnt lgkmcnt(5)
v_mfma_f32_16x16x32_bf16 v[180:183], v[104:107], v[152:155], v[180:183]
v_mfma_f32_16x16x32_bf16 v[176:179], v[60:63], v[156:159], v[176:179]
s_waitcnt lgkmcnt(4)
v_mfma_f32_16x16x32_bf16 v[180:183], v[108:111], v[156:159], v[180:183]
v_mfma_f32_16x16x32_bf16 v[176:179], v[64:67], v[160:163], v[176:179]
s_waitcnt lgkmcnt(3)
v_mfma_f32_16x16x32_bf16 v[180:183], v[112:115], v[160:163], v[180:183]
v_mfma_f32_16x16x32_bf16 v[176:179], v[68:71], v[164:167], v[176:179]
s_waitcnt lgkmcnt(2)
v_mfma_f32_16x16x32_bf16 v[180:183], v[116:119], v[164:167], v[180:183]
v_mfma_f32_16x16x32_bf16 v[176:179], v[72:75], v[168:171], v[176:179]
s_waitcnt lgkmcnt(1)
v_mfma_f32_16x16x32_bf16 v[180:183], v[120:123], v[168:171], v[180:183]
v_mfma_f32_16x16x32_bf16 v[176:179], v[76:79], v[172:175], v[176:179]
s_waitcnt lgkmcnt(0)
v_mfma_f32_16x16x32_bf16 v[180:183], v[124:127], v[172:175], v[180:183]
s_nop 5
v_cvt_pk_bf16_f32 v24, v176, v177
v_cvt_pk_bf16_f32 v25, v178, v179
v_cvt_pk_bf16_f32 v26, v180, v181
v_cvt_pk_bf16_f32 v27, v182, v183
buffer_store_dwordx4 v[24:27], v20, s[12:15], s23 offen sc1
s_branch L_prep_done
L_prep_m1:
v_lshrrev_b32 v16, 3, v0
v_mul_u32_u24 v16, 768, v16
v_and_b32 v17, 7, v0
v_lshl_add_u32 v16, v17, 4, v16
s_lshl_b32 s23, s22, 7
v_add_u32 v16, s23, v16
s_mul_i32 s24, s16, 73728
s_mul_i32 s25, s16, 12288
s_add_u32 m0, s25, 24576
s_nop 0
buffer_load_dwordx4 v16, s[80:83], s24 offen lds
s_add_u32 s24, s24, 6144
s_add_u32 m0, s25, 25600
s_nop 0
buffer_load_dwordx4 v16, s[80:83], s24 offen lds
s_add_u32 s24, s24, 6144
s_add_u32 m0, s25, 26624
s_nop 0
buffer_load_dwordx4 v16, s[80:83], s24 offen lds
s_add_u32 s24, s24, 6144
s_add_u32 m0, s25, 27648
s_nop 0
buffer_load_dwordx4 v16, s[80:83], s24 offen lds
s_add_u32 s24, s24, 6144
s_add_u32 m0, s25, 28672
s_nop 0
buffer_load_dwordx4 v16, s[80:83], s24 offen lds
s_add_u32 s24, s24, 6144
s_add_u32 m0, s25, 29696
s_nop 0
buffer_load_dwordx4 v16, s[80:83], s24 offen lds
s_add_u32 s24, s24, 6144
s_add_u32 m0, s25, 30720
s_nop 0
buffer_load_dwordx4 v16, s[80:83], s24 offen lds
s_add_u32 s24, s24, 6144
s_add_u32 m0, s25, 31744
s_nop 0
buffer_load_dwordx4 v16, s[80:83], s24 offen lds
s_add_u32 s24, s24, 6144
s_add_u32 m0, s25, 32768
s_nop 0
buffer_load_dwordx4 v16, s[80:83], s24 offen lds
s_add_u32 s24, s24, 6144
s_add_u32 m0, s25, 33792
s_nop 0
buffer_load_dwordx4 v16, s[80:83], s24 offen lds
s_add_u32 s24, s24, 6144
s_add_u32 m0, s25, 34816
s_nop 0
buffer_load_dwordx4 v16, s[80:83], s24 offen lds
s_add_u32 s24, s24, 6144
s_add_u32 m0, s25, 35840
s_nop 0
buffer_load_dwordx4 v16, s[80:83], s24 offen lds
v_lshrrev_b32 v17, 2, v1
v_lshl_add_u32 v17, v2, 3, v17
v_lshlrev_b32 v17, 7, v17
v_and_b32 v18, 3, v1
v_lshl_add_u32 v17, v18, 3, v17
s_lshl_b32 s23, s16, 5
v_add_u32 v17, s23, v17
v_add_u32 v17, 24576, v17
v_and_b32 v18, 3, v1
v_mul_u32_u24 v18, 12288, v18
v_lshl_add_u32 v18, v2, 8, v18
v_lshrrev_b32 v19, 2, v1
v_lshl_add_u32 v20, v19, 4, v18
s_lshl_b32 s23, s22, 2
s_add_u32 s23, s23, 24
s_mul_i32 s23, s23, 12
s_add_u32 s23, s23, s21
s_lshl_b32 s23, s23, 10
s_lshl_b32 s24, s16, 6
s_add_u32 s23, s23, s24
s_waitcnt vmcnt(0)
s_barrier
ds_read_b64_tr_b16 v[128:129], v17 offset:0
ds_read_b64_tr_b16 v[130:131], v17 offset:512
ds_read_b64_tr_b16 v[132:133], v17 offset:4096
ds_read_b64_tr_b16 v[134:135], v17 offset:4608
ds_read_b64_tr_b16 v[136:137], v17 offset:8192
ds_read_b64_tr_b16 v[138:139], v17 offset:8704
ds_read_b64_tr_b16 v[140:141], v17 offset:12288
ds_read_b64_tr_b16 v[142:143], v17 offset:12800
ds_read_b64_tr_b16 v[144:145], v17 offset:16384
ds_read_b64_tr_b16 v[146:147], v17 offset:16896
ds_read_b64_tr_b16 v[148:149], v17 offset:20480
ds_read_b64_tr_b16 v[150:151], v17 offset:20992
ds_read_b64_tr_b16 v[152:153], v17 offset:24576
ds_read_b64_tr_b16 v[154:155], v17 offset:25088
ds_read_b64_tr_b16 v[156:157], v17 offset:28672
s_waitcnt lgkmcnt(14)
ds_read_b64_tr_b16 v[158:159], v17 offset:29184
s_waitcnt lgkmcnt(14)
ds_read_b64_tr_b16 v[160:161], v17 offset:32768
s_waitcnt lgkmcnt(14)
ds_read_b64_tr_b16 v[162:163], v17 offset:33280
s_waitcnt lgkmcnt(14)
ds_read_b64_tr_b16 v[164:165], v17 offset:36864
s_waitcnt lgkmcnt(14)
ds_read_b64_tr_b16 v[166:167], v17 offset:37376
s_waitcnt lgkmcnt(14)
ds_read_b64_tr_b16 v[168:169], v17 offset:40960
s_waitcnt lgkmcnt(14)
ds_read_b64_tr_b16 v[170:171], v17 offset:41472
s_waitcnt lgkmcnt(14)
ds_read_b64_tr_b16 v[172:173], v17 offset:45056
s_waitcnt lgkmcnt(14)
ds_read_b64_tr_b16 v[174:175], v17 offset:45568
s_waitcnt lgkmcnt(14)
ds_read_b128 v[32:35], v12 offset:0
s_waitcnt lgkmcnt(14)
ds_read_b128 v[36:39], v13 offset:0
s_waitcnt lgkmcnt(14)
ds_read_b128 v[40:43], v14 offset:0
s_waitcnt lgkmcnt(14)
ds_read_b128 v[44:47], v15 offset:0
s_waitcnt lgkmcnt(14)
ds_read_b128 v[48:51], v12 offset:8192
s_waitcnt lgkmcnt(14)
ds_read_b128 v[52:55], v13 offset:8192
s_waitcnt lgkmcnt(14)
ds_read_b128 v[56:59], v14 offset:8192
s_waitcnt lgkmcnt(14)
ds_read_b128 v[60:63], v15 offset:8192
s_waitcnt lgkmcnt(14)
ds_read_b128 v[64:67], v12 offset:16384
s_waitcnt lgkmcnt(14)
ds_read_b128 v[68:71], v13 offset:16384
s_waitcnt lgkmcnt(14)
ds_read_b128 v[72:75], v14 offset:16384
s_waitcnt lgkmcnt(14)
ds_read_b128 v[76:79], v15 offset:16384
s_waitcnt lgkmcnt(14)
ds_read_b128 v[80:83], v12 offset:1024
s_waitcnt lgkmcnt(14)
ds_read_b128 v[84:87], v13 offset:1024
s_waitcnt lgkmcnt(14)
ds_read_b128 v[88:91], v14 offset:1024
s_waitcnt lgkmcnt(14)
ds_read_b128 v[92:95], v15 offset:1024
s_waitcnt lgkmcnt(14)
ds_read_b128 v[96:99], v12 offset:9216
s_waitcnt lgkmcnt(14)
ds_read_b128 v[100:103], v13 offset:9216
s_waitcnt lgkmcnt(14)
ds_read_b128 v[104:107], v14 offset:9216
s_waitcnt lgkmcnt(14)
ds_read_b128 v[108:111], v15 offset:9216
s_waitcnt lgkmcnt(14)
ds_read_b128 v[112:115], v12 offset:17408
s_waitcnt lgkmcnt(14)
ds_read_b128 v[116:119], v13 offset:17408
s_waitcnt lgkmcnt(14)
ds_read_b128 v[120:123], v14 offset:17408
s_waitcnt lgkmcnt(14)
ds_read_b128 v[124:127], v15 offset:17408
v_mfma_f32_16x16x32_bf16 v[176:179], v[32:35], v[128:131], 0
s_waitcnt lgkmcnt(11)
v_mfma_f32_16x16x32_bf16 v[180:183], v[80:83], v[128:131], 0
v_mfma_f32_16x16x32_bf16 v[176:179], v[36:39], v[132:135], v[176:179]
s_waitcnt lgkmcnt(10)
v_mfma_f32_16x16x32_bf16 v[180:183], v[84:87], v[132:135], v[180:183]
v_mfma_f32_16x16x32_bf16 v[176:179], v[40:43], v[136:139], v[176:179]
s_waitcnt lgkmcnt(9)
v_mfma_f32_16x16x32_bf16 v[180:183], v[88:91], v[136:139], v[180:183]
v_mfma_f32_16x16x32_bf16 v[176:179], v[44:47], v[140:143], v[176:179]
s_waitcnt lgkmcnt(8)
v_mfma_f32_16x16x32_bf16 v[180:183], v[92:95], v[140:143], v[180:183]
v_mfma_f32_16x16x32_bf16 v[176:179], v[48:51], v[144:147], v[176:179]
s_waitcnt lgkmcnt(7)
v_mfma_f32_16x16x32_bf16 v[180:183], v[96:99], v[144:147], v[180:183]
v_mfma_f32_16x16x32_bf16 v[176:179], v[52:55], v[148:151], v[176:179]
s_waitcnt lgkmcnt(6)
v_mfma_f32_16x16x32_bf16 v[180:183], v[100:103], v[148:151], v[180:183]
v_mfma_f32_16x16x32_bf16 v[176:179], v[56:59], v[152:155], v[176:179]
s_waitcnt lgkmcnt(5)
v_mfma_f32_16x16x32_bf16 v[180:183], v[104:107], v[152:155], v[180:183]
v_mfma_f32_16x16x32_bf16 v[176:179], v[60:63], v[156:159], v[176:179]
s_waitcnt lgkmcnt(4)
v_mfma_f32_16x16x32_bf16 v[180:183], v[108:111], v[156:159], v[180:183]
v_mfma_f32_16x16x32_bf16 v[176:179], v[64:67], v[160:163], v[176:179]
s_waitcnt lgkmcnt(3)
v_mfma_f32_16x16x32_bf16 v[180:183], v[112:115], v[160:163], v[180:183]
v_mfma_f32_16x16x32_bf16 v[176:179], v[68:71], v[164:167], v[176:179]
s_waitcnt lgkmcnt(2)
v_mfma_f32_16x16x32_bf16 v[180:183], v[116:119], v[164:167], v[180:183]
v_mfma_f32_16x16x32_bf16 v[176:179], v[72:75], v[168:171], v[176:179]
s_waitcnt lgkmcnt(1)
v_mfma_f32_16x16x32_bf16 v[180:183], v[120:123], v[168:171], v[180:183]
v_mfma_f32_16x16x32_bf16 v[176:179], v[76:79], v[172:175], v[176:179]
s_waitcnt lgkmcnt(0)
v_mfma_f32_16x16x32_bf16 v[180:183], v[124:127], v[172:175], v[180:183]
s_nop 5
v_cvt_pk_bf16_f32 v24, v176, v177
v_cvt_pk_bf16_f32 v25, v178, v179
v_cvt_pk_bf16_f32 v26, v180, v181
v_cvt_pk_bf16_f32 v27, v182, v183
buffer_store_dwordx4 v[24:27], v20, s[12:15], s23 offen sc1
L_prep_done:
s_waitcnt vmcnt(0)
s_barrier
s_cmp_lg_u32 s16, 0
s_cbranch_scc1 L_noprep
v_mov_b32 v115, 1
s_mov_b64 exec, 1
buffer_atomic_add v115, off, s[44:47], 0 offset:24 sc1
s_mov_b64 exec, -1
L_noprep:
v_mov_b32 v112, v0
v_and_b32 v113, 15, v0
v_lshrrev_b32 v114, 4, v0
v_lshlrev_b32 v252, 4, v0
v_add_u32 v251, s17, v252
s_mov_b32 s38, s39
s_mov_b32 s30, s39
s_mul_i32 s33, s30, 12
s_add_u32 s23, s33, s16
s_mul_hi_u32 s31, s23, 79536432
s_mul_i32 s32, s31, 54
s_sub_u32 s32, s23, s32
s_mul_i32 s31, s31, 2032128
s_mul_i32 s32, s32, 5376
s_add_u32 s21, s31, s32
s_mul_i32 s35, s16, 12288
s_cmp_lt_u32 s16, 2
s_cselect_b32 s34, 0, 49152
s_add_u32 s34, s34, s35
v_add_u32 v115, 0, v114
v_xor_b32 v120, v115, v113
v_lshlrev_b32 v120, 4, v120
v_add_u32 v115, 0, v115
v_mul_u32_u24 v116, 37, v115
v_lshrrev_b32 v116, 8, v116
v_mul_u32_u24 v116, 284928, v116
v_add_u32 v120, v120, v116
v_mul_u32_u24 v115, 768, v115
v_add_u32 v120, v120, v115
v_add_u32 v115, 4, v114
v_xor_b32 v121, v115, v113
v_lshlrev_b32 v121, 4, v121
v_add_u32 v115, 0, v115
v_mul_u32_u24 v116, 37, v115
v_lshrrev_b32 v116, 8, v116
v_mul_u32_u24 v116, 284928, v116
v_add_u32 v121, v121, v116
v_mul_u32_u24 v115, 768, v115
v_add_u32 v121, v121, v115
v_add_u32 v115, 8, v114
v_xor_b32 v122, v115, v113
v_lshlrev_b32 v122, 4, v122
v_add_u32 v115, 0, v115
v_mul_u32_u24 v116, 37, v115
v_lshrrev_b32 v116, 8, v116
v_mul_u32_u24 v116, 284928, v116
v_add_u32 v122, v122, v116
v_mul_u32_u24 v115, 768, v115
v_add_u32 v122, v122, v115
v_add_u32 v115, 12, v114
v_xor_b32 v123, v115, v113
v_lshlrev_b32 v123, 4, v123
v_add_u32 v115, 0, v115
v_mul_u32_u24 v116, 37, v115
v_lshrrev_b32 v116, 8, v116
v_mul_u32_u24 v116, 284928, v116
v_add_u32 v123, v123, v116
v_mul_u32_u24 v115, 768, v115
v_add_u32 v123, v123, v115
s_add_u32 m0, s35, 24576
s_nop 0
buffer_load_dwordx4 v120, s[4:7], s21 offen offset:0 nt lds
s_add_u32 m0, s35, 25600
s_nop 0
buffer_load_dwordx4 v121, s[4:7], s21 offen offset:0 nt lds
s_add_u32 m0, s35, 26624
s_nop 0
buffer_load_dwordx4 v122, s[4:7], s21 offen offset:0 nt lds
s_add_u32 m0, s35, 27648
s_nop 0
buffer_load_dwordx4 v123, s[4:7], s21 offen offset:0 nt lds
v_add_u32 v115, 0, v114
v_xor_b32 v124, v115, v113
v_lshlrev_b32 v124, 4, v124
v_add_u32 v115, 16, v115
v_mul_u32_u24 v116, 37, v115
v_lshrrev_b32 v116, 8, v116
v_mul_u32_u24 v116, 284928, v116
v_add_u32 v124, v124, v116
v_mul_u32_u24 v115, 768, v115
v_add_u32 v124, v124, v115
v_add_u32 v115, 4, v114
v_xor_b32 v125, v115, v113
v_lshlrev_b32 v125, 4, v125
v_add_u32 v115, 16, v115
v_mul_u32_u24 v116, 37, v115
v_lshrrev_b32 v116, 8, v116
v_mul_u32_u24 v116, 284928, v116
v_add_u32 v125, v125, v116
v_mul_u32_u24 v115, 768, v115
v_add_u32 v125, v125, v115
v_add_u32 v115, 8, v114
v_xor_b32 v126, v115, v113
v_lshlrev_b32 v126, 4, v126
v_add_u32 v115, 16, v115
v_mul_u32_u24 v116, 37, v115
v_lshrrev_b32 v116, 8, v116
v_mul_u32_u24 v116, 284928, v116
v_add_u32 v126, v126, v116
v_mul_u32_u24 v115, 768, v115
v_add_u32 v126, v126, v115
v_add_u32 v115, 12, v114
v_xor_b32 v127, v115, v113
v_lshlrev_b32 v127, 4, v127
v_add_u32 v115, 16, v115
v_mul_u32_u24 v116, 37, v115
v_lshrrev_b32 v116, 8, v116
v_mul_u32_u24 v116, 284928, v116
v_add_u32 v127, v127, v116
v_mul_u32_u24 v115, 768, v115
v_add_u32 v127, v127, v115
s_add_u32 m0, s35, 28672
s_nop 0
buffer_load_dwordx4 v124, s[4:7], s21 offen offset:0 nt lds
s_add_u32 m0, s35, 29696
s_nop 0
buffer_load_dwordx4 v125, s[4:7], s21 offen offset:0 nt lds
s_add_u32 m0, s35, 30720
s_nop 0
buffer_load_dwordx4 v126, s[4:7], s21 offen offset:0 nt lds
s_add_u32 m0, s35, 31744
s_nop 0
buffer_load_dwordx4 v127, s[4:7], s21 offen offset:0 nt lds
v_add_u32 v115, 0, v114
v_xor_b32 v128, v115, v113
v_lshlrev_b32 v128, 4, v128
v_add_u32 v115, 32, v115
v_mul_u32_u24 v116, 37, v115
v_lshrrev_b32 v116, 8, v116
v_mul_u32_u24 v116, 284928, v116
v_add_u32 v128, v128, v116
v_mul_u32_u24 v115, 768, v115
v_add_u32 v128, v128, v115
v_add_u32 v115, 4, v114
v_xor_b32 v129, v115, v113
v_lshlrev_b32 v129, 4, v129
v_add_u32 v115, 32, v115
v_mul_u32_u24 v116, 37, v115
v_lshrrev_b32 v116, 8, v116
v_mul_u32_u24 v116, 284928, v116
v_add_u32 v129, v129, v116
v_mul_u32_u24 v115, 768, v115
v_add_u32 v129, v129, v115
v_add_u32 v115, 8, v114
v_xor_b32 v130, v115, v113
v_lshlrev_b32 v130, 4, v130
v_add_u32 v115, 32, v115
v_mul_u32_u24 v116, 37, v115
v_lshrrev_b32 v116, 8, v116
v_mul_u32_u24 v116, 284928, v116
v_add_u32 v130, v130, v116
v_mul_u32_u24 v115, 768, v115
v_add_u32 v130, v130, v115
v_add_u32 v115, 12, v114
v_xor_b32 v131, v115, v113
v_lshlrev_b32 v131, 4, v131
v_add_u32 v115, 32, v115
v_mul_u32_u24 v116, 37, v115
v_lshrrev_b32 v116, 8, v116
v_mul_u32_u24 v116, 284928, v116
v_add_u32 v131, v131, v116
v_mul_u32_u24 v115, 768, v115
v_add_u32 v131, v131, v115
s_add_u32 m0, s35, 32768
s_nop 0
buffer_load_dwordx4 v128, s[4:7], s21 offen offset:0 nt lds
s_add_u32 m0, s35, 33792
s_nop 0
buffer_load_dwordx4 v129, s[4:7], s21 offen offset:0 nt lds
s_add_u32 m0, s35, 34816
s_nop 0
buffer_load_dwordx4 v130, s[4:7], s21 offen offset:0 nt lds
s_add_u32 m0, s35, 35840
s_nop 0
buffer_load_dwordx4 v131, s[4:7], s21 offen offset:0 nt lds
s_add_u32 s30, s21, 256
s_add_u32 m0, s34, 0
s_nop 0
buffer_load_dwordx4 v120, s[4:7], s30 offen nt lds
s_add_u32 m0, s34, 1024
s_nop 0
buffer_load_dwordx4 v121, s[4:7], s30 offen nt lds
s_add_u32 m0, s34, 2048
s_nop 0
buffer_load_dwordx4 v122, s[4:7], s30 offen nt lds
s_add_u32 m0, s34, 3072
s_nop 0
buffer_load_dwordx4 v123, s[4:7], s30 offen nt lds
s_add_u32 m0, s34, 4096
s_nop 0
buffer_load_dwordx4 v124, s[4:7], s30 offen nt lds
s_add_u32 m0, s34, 5120
s_nop 0
buffer_load_dwordx4 v125, s[4:7], s30 offen nt lds
s_add_u32 m0, s34, 6144
s_nop 0
buffer_load_dwordx4 v126, s[4:7], s30 offen nt lds
s_add_u32 m0, s34, 7168
s_nop 0
buffer_load_dwordx4 v127, s[4:7], s30 offen nt lds
s_add_u32 m0, s34, 8192
s_nop 0
buffer_load_dwordx4 v128, s[4:7], s30 offen nt lds
s_add_u32 m0, s34, 9216
s_nop 0
buffer_load_dwordx4 v129, s[4:7], s30 offen nt lds
s_add_u32 m0, s34, 10240
s_nop 0
buffer_load_dwordx4 v130, s[4:7], s30 offen nt lds
s_add_u32 m0, s34, 11264
s_nop 0
buffer_load_dwordx4 v131, s[4:7], s30 offen nt lds
s_add_u32 m0, s35, 97792
s_nop 0
buffer_load_dwordx4 v120, s[4:7], s21 offen offset:512 nt lds
s_add_u32 m0, s35, 98816
s_nop 0
buffer_load_dwordx4 v121, s[4:7], s21 offen offset:512 nt lds
s_add_u32 m0, s35, 99840
s_nop 0
buffer_load_dwordx4 v122, s[4:7], s21 offen offset:512 nt lds
s_add_u32 m0, s35, 100864
s_nop 0
buffer_load_dwordx4 v123, s[4:7], s21 offen offset:512 nt lds
s_add_u32 m0, s35, 101888
s_nop 0
buffer_load_dwordx4 v124, s[4:7], s21 offen offset:512 nt lds
s_add_u32 m0, s35, 102912
s_nop 0
buffer_load_dwordx4 v125, s[4:7], s21 offen offset:512 nt lds
s_add_u32 m0, s35, 103936
s_nop 0
buffer_load_dwordx4 v126, s[4:7], s21 offen offset:512 nt lds
s_add_u32 m0, s35, 104960
s_nop 0
buffer_load_dwordx4 v127, s[4:7], s21 offen offset:512 nt lds
s_add_u32 m0, s35, 105984
s_nop 0
buffer_load_dwordx4 v128, s[4:7], s21 offen offset:512 nt lds
s_add_u32 m0, s35, 107008
s_nop 0
buffer_load_dwordx4 v129, s[4:7], s21 offen offset:512 nt lds
s_add_u32 m0, s35, 108032
s_nop 0
buffer_load_dwordx4 v130, s[4:7], s21 offen offset:512 nt lds
s_add_u32 m0, s35, 109056
s_nop 0
buffer_load_dwordx4 v131, s[4:7], s21 offen offset:512 nt lds
s_add_u32 s25, s21, 1746432
s_sub_u32 s25, s25, s17
s_lshl_b32 m0, s16, 10
s_add_u32 m0, m0, 147456
s_nop 0
buffer_load_dwordx4 v251, s[4:7], s25 offen lds
s_getpc_b64 s[30:31]
L_pc:
s_add_u32 s30, s30, L_round-L_pc
s_addc_u32 s31, s31, 0
s_mul_i32 s32, s16, 8192
v_lshl_add_u32 v200, v0, 7, s32
v_cmp_gt_u32 vcc, L_end-L_round, v200
v_mov_b32 v203, s31
s_nop 2
s_and_saveexec_b64 s[28:29], vcc
s_cbranch_execz L_pfskip0
v_add_co_u32 v202, vcc, s30, v200
s_nop 1
v_addc_co_u32 v203, vcc, 0, v203, vcc
global_load_dword v68, v[202:203], off
L_pfskip0:
s_mov_b64 exec, s[28:29]
v_add_u32 v200, 32768, v200
v_cmp_gt_u32 vcc, L_end-L_round, v200
v_mov_b32 v205, s31
s_nop 2
s_and_saveexec_b64 s[28:29], vcc
s_cbranch_execz L_pfskip1
v_add_co_u32 v204, vcc, s30, v200
s_nop 1
v_addc_co_u32 v205, vcc, 0, v205, vcc
global_load_dword v69, v[204:205], off
L_pfskip1:
s_mov_b64 exec, s[28:29]
s_mov_b32 s30, s39
s_lshl_b32 s30, s30, 2
s_add_u32 s30, s30, s16
s_lshr_b32 s31, s30, 4
s_mul_i32 s31, s31, 12288
s_bfe_u32 s32, s30, 0x20002
s_lshl_b32 s32, s32, 8
s_add_u32 s31, s31, s32
s_mul_i32 s32, s16, 3072
s_add_u32 s31, s31, s32
s_add_u32 s29, s31, 1048576
s_lshl_b32 s38, s30, 2
s_add_u32 s38, s38, 6356992
s_mov_b32 s39, 0
v_lshlrev_b32 v236, 4, v114
s_add_u32 s23, s23, 4
s_mul_hi_u32 s31, s23, 79536432
s_mul_i32 s32, s31, 54
s_sub_u32 s32, s23, s32
s_mul_i32 s31, s31, 2032128
s_mul_i32 s32, s32, 5376
s_add_u32 s22, s31, s32
s_mov_b32 s20, 0
s_mov_b32 s36, 0
s_mul_i32 s18, s16, 12288
s_mov_b32 s26, 0x3d96c740
s_mov_b32 s27, 0xbd96c740
s_mov_b32 vcc_lo, 0x00010001
s_mov_b32 vcc_hi, 0x00010001
v_lshlrev_b32 v115, 2, v114
v_add_u32 v115, 0, v115
v_mul_u32_u24 v116, 37, v115
v_lshrrev_b32 v116, 8, v116
v_mul_u32_u24 v116, 284928, v116
v_mul_u32_u24 v239, 768, v115
v_add_u32 v239, v239, v116
v_lshl_add_u32 v239, v113, 3, v239
v_lshlrev_b32 v115, 2, v114
v_add_u32 v115, 1, v115
v_mul_u32_u24 v116, 37, v115
v_lshrrev_b32 v116, 8, v116
v_mul_u32_u24 v116, 284928, v116
v_mul_u32_u24 v240, 768, v115
v_add_u32 v240, v240, v116
v_lshl_add_u32 v240, v113, 3, v240
v_lshlrev_b32 v115, 2, v114
v_add_u32 v115, 2, v115
v_mul_u32_u24 v116, 37, v115
v_lshrrev_b32 v116, 8, v116
v_mul_u32_u24 v116, 284928, v116
v_mul_u32_u24 v241, 768, v115
v_add_u32 v241, v241, v116
v_lshl_add_u32 v241, v113, 3, v241
v_lshlrev_b32 v115, 2, v114
v_add_u32 v115, 3, v115
v_mul_u32_u24 v116, 37, v115
v_lshrrev_b32 v116, 8, v116
v_mul_u32_u24 v116, 284928, v116
v_mul_u32_u24 v242, 768, v115
v_add_u32 v242, v242, v116
v_lshl_add_u32 v242, v113, 3, v242
v_lshlrev_b32 v115, 2, v114
v_add_u32 v115, 16, v115
v_mul_u32_u24 v116, 37, v115
v_lshrrev_b32 v116, 8, v116
v_mul_u32_u24 v116, 284928, v116
v_mul_u32_u24 v243, 768, v115
v_add_u32 v243, v243, v116
v_lshl_add_u32 v243, v113, 3, v243
v_lshlrev_b32 v115, 2, v114
v_add_u32 v115, 17, v115
v_mul_u32_u24 v116, 37, v115
v_lshrrev_b32 v116, 8, v116
v_mul_u32_u24 v116, 284928, v116
v_mul_u32_u24 v244, 768, v115
v_add_u32 v244, v244, v116
v_lshl_add_u32 v244, v113, 3, v244
v_lshlrev_b32 v115, 2, v114
v_add_u32 v115, 18, v115
v_mul_u32_u24 v116, 37, v115
v_lshrrev_b32 v116, 8, v116
v_mul_u32_u24 v116, 284928, v116
v_mul_u32_u24 v245, 768, v115
v_add_u32 v245, v245, v116
v_lshl_add_u32 v245, v113, 3, v245
v_lshlrev_b32 v115, 2, v114
v_add_u32 v115, 19, v115
v_mul_u32_u24 v116, 37, v115
v_lshrrev_b32 v116, 8, v116
v_mul_u32_u24 v116, 284928, v116
v_mul_u32_u24 v246, 768, v115
v_add_u32 v246, v246, v116
v_lshl_add_u32 v246, v113, 3, v246
v_lshlrev_b32 v115, 2, v114
v_add_u32 v115, 32, v115
v_mul_u32_u24 v116, 37, v115
v_lshrrev_b32 v116, 8, v116
v_mul_u32_u24 v116, 284928, v116
v_mul_u32_u24 v247, 768, v115
v_add_u32 v247, v247, v116
v_lshl_add_u32 v247, v113, 3, v247
v_lshlrev_b32 v115, 2, v114
v_add_u32 v115, 33, v115
v_mul_u32_u24 v116, 37, v115
v_lshrrev_b32 v116, 8, v116
v_mul_u32_u24 v116, 284928, v116
v_mul_u32_u24 v248, 768, v115
v_add_u32 v248, v248, v116
v_lshl_add_u32 v248, v113, 3, v248
v_lshlrev_b32 v115, 2, v114
v_add_u32 v115, 34, v115
v_mul_u32_u24 v116, 37, v115
v_lshrrev_b32 v116, 8, v116
v_mul_u32_u24 v116, 284928, v116
v_mul_u32_u24 v249, 768, v115
v_add_u32 v249, v249, v116
v_lshl_add_u32 v249, v113, 3, v249
v_lshlrev_b32 v115, 2, v114
v_add_u32 v115, 35, v115
v_mul_u32_u24 v116, 37, v115
v_lshrrev_b32 v116, 8, v116
v_mul_u32_u24 v116, 284928, v116
v_mul_u32_u24 v250, 768, v115
v_add_u32 v250, v250, v116
v_lshl_add_u32 v250, v113, 3, v250
s_lshl_b32 s30, s16, 10
s_add_u32 s30, s30, 147456
v_add_u32 v115, s30, v236
v_mov_b32 v116, 159744
v_cndmask_b32 v253, v116, v115, vcc
s_lshl_b32 s30, s16, 10
s_add_u32 s30, s30, 151552
v_lshrrev_b32 v115, 2, v113
v_lshlrev_b32 v115, 4, v115
v_and_b32 v116, 3, v113
v_lshl_add_u32 v115, v116, 1, v115
v_add_u32 v254, s30, v115
s_add_u32 s33, s30, 4096
s_mul_i32 s3, s16, 192
s_add_u32 s3, s3, 151552
v_mov_b32 v64, 0
v_mov_b32 v65, 0
v_mov_b32 v66, 0
v_mov_b32 v67, 0
v_lshlrev_b32 v115, 4, v112
v_add_u32 v115, 159744, v115
ds_write_b128 v115, v[64:67]
s_sub_u32 s19, 160768, s17
v_add_u32 v115, s19, v251
ds_write_b128 v115, v[120:123] offset:0
ds_write_b128 v115, v[124:127] offset:1024
ds_write_b128 v115, v[128:131] offset:2048
v_xor_b32 v115, v114, v113
v_lshlrev_b32 v115, 4, v115
v_lshl_add_u32 v115, v113, 8, v115
v_add_u32 v115, s35, v115
v_add_u32 v237, 98304, v115
v_add_u32 v115, 0, v114
v_xor_b32 v115, v115, v113
v_lshlrev_b32 v115, 4, v115
v_lshl_add_u32 v115, v113, 8, v115
v_add_u32 v115, s35, v115
v_add_u32 v108, 24576, v115
v_add_u32 v115, 4, v114
v_xor_b32 v115, v115, v113
v_lshlrev_b32 v115, 4, v115
v_lshl_add_u32 v115, v113, 8, v115
v_add_u32 v115, s35, v115
v_add_u32 v109, 24576, v115
v_add_u32 v115, 8, v114
v_xor_b32 v115, v115, v113
v_lshlrev_b32 v115, 4, v115
v_lshl_add_u32 v115, v113, 8, v115
v_add_u32 v115, s35, v115
v_add_u32 v110, 24576, v115
v_add_u32 v115, 12, v114
v_xor_b32 v115, v115, v113
v_lshlrev_b32 v115, 4, v115
v_lshl_add_u32 v115, v113, 8, v115
v_add_u32 v115, s35, v115
v_add_u32 v111, 24576, v115
s_waitcnt vmcnt(25)
ds_read_b128 a[0:3], v108 offset:0
ds_read_b128 a[4:7], v109 offset:0
ds_read_b128 a[8:11], v110 offset:0
ds_read_b128 a[12:15], v111 offset:0
ds_read_b128 a[48:51], v108 offset:4096
ds_read_b128 a[52:55], v109 offset:4096
ds_read_b128 a[56:59], v110 offset:4096
ds_read_b128 a[60:63], v111 offset:4096
ds_read_b128 a[96:99], v108 offset:8192
ds_read_b128 a[100:103], v109 offset:8192
ds_read_b128 a[104:107], v110 offset:8192
s_waitcnt lgkmcnt(14)
ds_read_b128 a[108:111], v111 offset:8192
v_add_u32 v115, 0, v114
v_xor_b32 v115, v115, v113
v_lshlrev_b32 v115, 4, v115
v_lshl_add_u32 v115, v113, 8, v115
v_add_u32 v115, s34, v115
v_add_u32 v108, 0, v115
v_add_u32 v115, 4, v114
v_xor_b32 v115, v115, v113
v_lshlrev_b32 v115, 4, v115
v_lshl_add_u32 v115, v113, 8, v115
v_add_u32 v115, s34, v115
v_add_u32 v109, 0, v115
v_add_u32 v115, 8, v114
v_xor_b32 v115, v115, v113
v_lshlrev_b32 v115, 4, v115
v_lshl_add_u32 v115, v113, 8, v115
v_add_u32 v115, s34, v115
v_add_u32 v110, 0, v115
v_add_u32 v115, 12, v114
v_xor_b32 v115, v115, v113
v_lshlrev_b32 v115, 4, v115
v_lshl_add_u32 v115, v113, 8, v115
v_add_u32 v115, s34, v115
v_add_u32 v111, 0, v115
s_waitcnt vmcnt(13)
s_waitcnt lgkmcnt(14)
ds_read_b128 a[16:19], v108 offset:0
s_waitcnt lgkmcnt(14)
ds_read_b128 a[20:23], v109 offset:0
s_waitcnt lgkmcnt(14)
ds_read_b128 a[24:27], v110 offset:0
s_waitcnt lgkmcnt(14)
ds_read_b128 a[28:31], v111 offset:0
s_waitcnt lgkmcnt(14)
ds_read_b128 a[64:67], v108 offset:4096
s_waitcnt lgkmcnt(14)
ds_read_b128 a[68:71], v109 offset:4096
s_waitcnt lgkmcnt(14)
ds_read_b128 a[72:75], v110 offset:4096
s_waitcnt lgkmcnt(14)
ds_read_b128 a[76:79], v111 offset:4096
s_waitcnt lgkmcnt(14)
ds_read_b128 a[112:115], v108 offset:8192
s_waitcnt lgkmcnt(14)
ds_read_b128 a[116:119], v109 offset:8192
s_waitcnt lgkmcnt(14)
ds_read_b128 a[120:123], v110 offset:8192
s_waitcnt lgkmcnt(14)
ds_read_b128 a[124:127], v111 offset:8192
s_cmp_lg_u32 s16, 0
s_cbranch_scc1 L_cw_ok
s_mov_b32 s32, 0
L_cw:
buffer_load_dword v115, off, s[44:47], 0 offset:128 sc1
s_waitcnt vmcnt(0)
v_readfirstlane_b32 s31, v115
s_nop 3
s_cmp_ge_u32 s31, 1
s_cbranch_scc1 L_cw_ok
s_sleep 8
s_add_u32 s32, s32, 1
s_cmp_lt_u32 s32, 10000
s_cbranch_scc1 L_cw
L_cw_ok:
s_waitcnt lgkmcnt(0)
s_barrier
s_add_u32 m0, s17, 0
s_mov_b32 s24, 0
buffer_load_dwordx4 v251, s[12:15], s24 offen offset:0  lds
buffer_load_dwordx4 v251, s[12:15], s24 offen offset:1024  lds
buffer_load_dwordx4 v251, s[12:15], s24 offen offset:2048  lds
buffer_load_dwordx4 v251, s[12:15], s24 offen offset:3072  lds
s_add_u32 m0, s17, 4096
s_mov_b32 s24, 4096
buffer_load_dwordx4 v251, s[12:15], s24 offen offset:0  lds
buffer_load_dwordx4 v251, s[12:15], s24 offen offset:1024  lds
s_add_u32 m0, s17, 24576
s_mov_b32 s24, 24576
buffer_load_dwordx4 v251, s[12:15], s24 offen offset:0  lds
buffer_load_dwordx4 v251, s[12:15], s24 offen offset:1024  lds
buffer_load_dwordx4 v251, s[12:15], s24 offen offset:2048  lds
buffer_load_dwordx4 v251, s[12:15], s24 offen offset:3072  lds
s_add_u32 m0, s17, 28672
s_mov_b32 s24, 28672
buffer_load_dwordx4 v251, s[12:15], s24 offen offset:0  lds
buffer_load_dwordx4 v251, s[12:15], s24 offen offset:1024  lds
s_add_u32 m0, s17, 49152
s_mov_b32 s24, 49152
buffer_load_dwordx4 v251, s[12:15], s24 offen offset:0  lds
buffer_load_dwordx4 v251, s[12:15], s24 offen offset:1024  lds
buffer_load_dwordx4 v251, s[12:15], s24 offen offset:2048  lds
buffer_load_dwordx4 v251, s[12:15], s24 offen offset:3072  lds
s_add_u32 m0, s17, 53248
s_mov_b32 s24, 53248
buffer_load_dwordx4 v251, s[12:15], s24 offen offset:0  lds
buffer_load_dwordx4 v251, s[12:15], s24 offen offset:1024  lds
s_add_u32 m0, s17, 73728
s_mov_b32 s24, 73728
buffer_load_dwordx4 v251, s[12:15], s24 offen offset:0  lds
buffer_load_dwordx4 v251, s[12:15], s24 offen offset:1024  lds
buffer_load_dwordx4 v251, s[12:15], s24 offen offset:2048  lds
buffer_load_dwordx4 v251, s[12:15], s24 offen offset:3072  lds
s_add_u32 m0, s17, 77824
s_mov_b32 s24, 77824
buffer_load_dwordx4 v251, s[12:15], s24 offen offset:0  lds
buffer_load_dwordx4 v251, s[12:15], s24 offen offset:1024  lds
s_waitcnt vmcnt(18)
s_barrier
ds_read_b128 v[172:175], v252 offset:0
ds_read_b128 v[176:179], v252 offset:1024
ds_read_b128 v[180:183], v252 offset:2048
ds_read_b128 v[184:187], v252 offset:3072
ds_read_b128 v[188:191], v252 offset:4096
ds_read_b128 v[192:195], v252 offset:5120
L_round:
s_waitcnt lgkmcnt(5)
v_mfma_f32_16x16x32_bf16 v[64:67], v[172:175], a[0:3], 0
ds_read_b128 a[32:35], v237 offset:0
s_cmp_eq_u32 s36, 2
s_cselect_b32 s6, 0, 109734912
ds_read_b128 v[196:199], v252 offset:6144
s_waitcnt lgkmcnt(6)
v_mfma_f32_16x16x32_bf16 v[64:67], v[176:179], a[4:7], v[64:67]
ds_read_b128 a[80:83], v237 offset:4096
v_cvt_pk_bf16_f32 v147, v8, v12
v_cvt_pk_bf16_f32 v149, v9, v13
s_waitcnt lgkmcnt(6)
v_mfma_f32_16x16x32_bf16 v[64:67], v[180:183], a[8:11], v[64:67]
ds_read_b128 a[128:131], v237 offset:8192
v_cvt_pk_bf16_f32 v151, v10, v14
v_cvt_pk_bf16_f32 v153, v11, v15
ds_read_b128 v[200:203], v252 offset:7168
s_waitcnt lgkmcnt(7)
v_mfma_f32_16x16x32_bf16 v[64:67], v[184:187], a[12:15], v[64:67]
v_xor_b32 v238, 64, v237
ds_read_b128 a[36:39], v238 offset:0
v_cvt_pk_bf16_f32 v155, v24, v28
v_cvt_pk_bf16_f32 v157, v25, v29
s_waitcnt lgkmcnt(7)
v_mfma_f32_16x16x32_bf16 v[64:67], v[188:191], a[16:19], v[64:67]
ds_read_b128 a[84:87], v238 offset:4096
v_cvt_pk_bf16_f32 v159, v26, v30
v_cvt_pk_bf16_f32 v161, v27, v31
ds_read_b128 v[204:207], v252 offset:8192
s_waitcnt lgkmcnt(8)
v_mfma_f32_16x16x32_bf16 v[64:67], v[192:195], a[20:23], v[64:67]
ds_read_b128 a[132:135], v238 offset:8192
v_cvt_pk_bf16_f32 v163, v40, v44
v_cvt_pk_bf16_f32 v165, v41, v45
v_mfma_f32_16x16x32_bf16 v[68:71], v[172:175], a[48:51], 0
v_xor_b32 v238, 128, v237
ds_read_b128 a[40:43], v238 offset:0
v_cvt_pk_bf16_f32 v167, v42, v46
v_cvt_pk_bf16_f32 v169, v43, v47
ds_read_b128 v[208:211], v252 offset:9216
v_mfma_f32_16x16x32_bf16 v[68:71], v[176:179], a[52:55], v[68:71]
ds_read_b128 a[88:91], v238 offset:4096
v_cvt_pk_bf16_f32 v171, v56, v60
v_mfma_f32_16x16x32_bf16 v[68:71], v[180:183], a[56:59], v[68:71]
ds_read_b128 a[136:139], v238 offset:8192
ds_read_b128 v[212:215], v252 offset:10240
v_mfma_f32_16x16x32_bf16 v[68:71], v[184:187], a[60:63], v[68:71]
v_xor_b32 v238, 192, v237
ds_read_b128 a[44:47], v238 offset:0
buffer_store_dwordx2 v[146:147], v239, s[8:11], s20 offen offset:640 sc1
v_mfma_f32_16x16x32_bf16 v[68:71], v[188:191], a[64:67], v[68:71]
s_waitcnt lgkmcnt(14)
ds_read_b128 a[92:95], v238 offset:4096
s_waitcnt lgkmcnt(14)
ds_read_b128 v[216:219], v252 offset:11264
v_mfma_f32_16x16x32_bf16 v[68:71], v[192:195], a[68:71], v[68:71]
s_waitcnt lgkmcnt(14)
ds_read_b128 a[140:143], v238 offset:8192
v_mfma_f32_16x16x32_bf16 v[72:75], v[172:175], a[96:99], 0
v_mfma_f32_16x16x32_bf16 v[72:75], v[176:179], a[100:103], v[72:75]
v_mfma_f32_16x16x32_bf16 v[72:75], v[180:183], a[104:107], v[72:75]
v_mfma_f32_16x16x32_bf16 v[72:75], v[184:187], a[108:111], v[72:75]
v_mfma_f32_16x16x32_bf16 v[72:75], v[188:191], a[112:115], v[72:75]
v_mfma_f32_16x16x32_bf16 v[72:75], v[192:195], a[116:119], v[72:75]
s_waitcnt lgkmcnt(1)
v_mfma_f32_16x16x32_bf16 v[64:67], v[196:199], a[24:27], v[64:67]
ds_read_b128 v[172:175], v252 offset:12288
v_mfma_f32_16x16x32_bf16 v[64:67], v[200:203], a[28:31], v[64:67]
v_mfma_f32_16x16x32_bf16 v[64:67], v[204:207], a[32:35], v[64:67]
ds_read_b128 v[176:179], v252 offset:13312
v_mfma_f32_16x16x32_bf16 v[64:67], v[208:211], a[36:39], v[64:67]
v_mfma_f32_16x16x32_bf16 v[64:67], v[212:215], a[40:43], v[64:67]
ds_read_b128 v[180:183], v252 offset:14336
v_mfma_f32_16x16x32_bf16 v[64:67], v[216:219], a[44:47], v[64:67]
v_mfma_f32_16x16x32_bf16 v[68:71], v[196:199], a[72:75], v[68:71]
ds_read_b128 v[184:187], v252 offset:15360
v_mfma_f32_16x16x32_bf16 v[68:71], v[200:203], a[76:79], v[68:71]
v_mfma_f32_16x16x32_bf16 v[68:71], v[204:207], a[80:83], v[68:71]
ds_read_b128 v[188:191], v252 offset:16384
v_mfma_f32_16x16x32_bf16 v[68:71], v[208:211], a[84:87], v[68:71]
buffer_store_dwordx2 v[148:149], v240, s[8:11], s20 offen offset:640 sc1
v_mfma_f32_16x16x32_bf16 v[68:71], v[212:215], a[88:91], v[68:71]
ds_read_b128 v[192:195], v252 offset:17408
v_mfma_f32_16x16x32_bf16 v[68:71], v[216:219], a[92:95], v[68:71]
ds_read_b128 v[100:103], v253 offset:0
v_mfma_f32_16x16x32_bf16 v[72:75], v[196:199], a[120:123], v[72:75]
v_mfma_f32_16x16x32_bf16 v[72:75], v[200:203], a[124:127], v[72:75]
v_cvt_pk_bf16_f32 v88, v64, v65
v_cvt_pk_bf16_f32 v89, v66, v67
v_mfma_f32_16x16x32_bf16 v[72:75], v[204:207], a[128:131], v[72:75]
v_mfma_f32_16x16x32_bf16 v[72:75], v[208:211], a[132:135], v[72:75]
v_mfma_f32_16x16x32_bf16 v[72:75], v[212:215], a[136:139], v[72:75]
s_waitcnt lgkmcnt(7)
v_mfma_f32_16x16x32_bf16 v[72:75], v[216:219], a[140:143], v[72:75]
s_waitcnt lgkmcnt(1)
v_mfma_f32_16x16x32_bf16 v[76:79], v[172:175], a[0:3], 0
ds_read_b128 v[196:199], v252 offset:18432
v_mfma_f32_16x16x32_bf16 v[76:79], v[176:179], a[4:7], v[76:79]
v_cvt_pk_bf16_f32 v92, v68, v69
v_cvt_pk_bf16_f32 v93, v70, v71
v_mfma_f32_16x16x32_bf16 v[76:79], v[180:183], a[8:11], v[76:79]
ds_read_b128 v[200:203], v252 offset:19456
v_mfma_f32_16x16x32_bf16 v[76:79], v[184:187], a[12:15], v[76:79]
v_mfma_f32_16x16x32_bf16 v[76:79], v[188:191], a[16:19], v[76:79]
ds_read_b128 v[204:207], v252 offset:20480
v_mfma_f32_16x16x32_bf16 v[76:79], v[192:195], a[20:23], v[76:79]
v_mfma_f32_16x16x32_bf16 v[80:83], v[172:175], a[48:51], 0
ds_read_b128 v[208:211], v252 offset:21504
v_mfma_f32_16x16x32_bf16 v[80:83], v[176:179], a[52:55], v[80:83]
v_cvt_pk_bf16_f32 v96, v72, v73
v_cvt_pk_bf16_f32 v97, v74, v75
v_mfma_f32_16x16x32_bf16 v[80:83], v[180:183], a[56:59], v[80:83]
ds_read_b128 v[212:215], v252 offset:22528
v_mfma_f32_16x16x32_bf16 v[80:83], v[184:187], a[60:63], v[80:83]
buffer_store_dwordx2 v[150:151], v241, s[8:11], s20 offen offset:640 sc1
v_mfma_f32_16x16x32_bf16 v[80:83], v[188:191], a[64:67], v[80:83]
ds_read_b128 v[216:219], v252 offset:23552
v_mfma_f32_16x16x32_bf16 v[80:83], v[192:195], a[68:71], v[80:83]
v_mfma_f32_16x16x32_bf16 v[84:87], v[172:175], a[96:99], 0
v_mfma_f32_16x16x32_bf16 v[84:87], v[176:179], a[100:103], v[84:87]
v_mfma_f32_16x16x32_bf16 v[84:87], v[180:183], a[104:107], v[84:87]
v_mfma_f32_16x16x32_bf16 v[84:87], v[184:187], a[108:111], v[84:87]
v_mfma_f32_16x16x32_bf16 v[84:87], v[188:191], a[112:115], v[84:87]
v_mfma_f32_16x16x32_bf16 v[84:87], v[192:195], a[116:119], v[84:87]
s_waitcnt vmcnt(15) lgkmcnt(0)
s_barrier
v_add_u32 v252, 24576, v252
v_mfma_f32_16x16x32_bf16 v[76:79], v[196:199], a[24:27], v[76:79]
s_add_u32 m0, s17, 0
s_mov_b32 s24, 98304
v_mfma_f32_16x16x32_bf16 v[76:79], v[200:203], a[28:31], v[76:79]
ds_read_b128 v[172:175], v252 offset:0
v_mfma_f32_16x16x32_bf16 v[76:79], v[204:207], a[32:35], v[76:79]
buffer_load_dwordx4 v251, s[12:15], s24 offen offset:0  lds
v_mfma_f32_16x16x32_bf16 v[76:79], v[208:211], a[36:39], v[76:79]
ds_read_b128 v[176:179], v252 offset:1024
v_mfma_f32_16x16x32_bf16 v[76:79], v[212:215], a[40:43], v[76:79]
v_mfma_f32_16x16x32_bf16 v[76:79], v[216:219], a[44:47], v[76:79]
ds_read_b128 v[180:183], v252 offset:2048
v_mfma_f32_16x16x32_bf16 v[80:83], v[196:199], a[72:75], v[80:83]
buffer_load_dwordx4 v251, s[12:15], s24 offen offset:1024  lds
v_mfma_f32_16x16x32_bf16 v[80:83], v[200:203], a[76:79], v[80:83]
ds_read_b128 v[184:187], v252 offset:3072
v_mfma_f32_16x16x32_bf16 v[80:83], v[204:207], a[80:83], v[80:83]
v_mfma_f32_16x16x32_bf16 v[80:83], v[208:211], a[84:87], v[80:83]
buffer_store_dwordx2 v[152:153], v242, s[8:11], s20 offen offset:640 sc1
ds_read_b128 v[188:191], v252 offset:4096
v_mfma_f32_16x16x32_bf16 v[80:83], v[212:215], a[88:91], v[80:83]
buffer_load_dwordx4 v251, s[12:15], s24 offen offset:2048  lds
v_mfma_f32_16x16x32_bf16 v[80:83], v[216:219], a[92:95], v[80:83]
ds_read_b128 v[192:195], v252 offset:5120
v_mfma_f32_16x16x32_bf16 v[84:87], v[196:199], a[120:123], v[84:87]
v_mfma_f32_16x16x32_bf16 v[84:87], v[200:203], a[124:127], v[84:87]
v_cvt_pk_bf16_f32 v90, v76, v77
v_cvt_pk_bf16_f32 v91, v78, v79
v_mfma_f32_16x16x32_bf16 v[84:87], v[204:207], a[128:131], v[84:87]
buffer_load_dwordx4 v251, s[12:15], s24 offen offset:3072  lds
v_mfma_f32_16x16x32_bf16 v[84:87], v[208:211], a[132:135], v[84:87]
v_mfma_f32_16x16x32_bf16 v[84:87], v[212:215], a[136:139], v[84:87]
s_add_u32 m0, s17, 4096
s_mov_b32 s24, 102400
v_mfma_f32_16x16x32_bf16 v[84:87], v[216:219], a[140:143], v[84:87]
s_waitcnt lgkmcnt(0)
v_mfma_f32_16x16x32_bf16 v[64:67], v[172:175], a[0:3], 0
buffer_load_dwordx4 v251, s[12:15], s24 offen offset:0  lds
ds_read_b128 v[196:199], v252 offset:6144
v_mfma_f32_16x16x32_bf16 v[64:67], v[176:179], a[4:7], v[64:67]
v_cvt_pk_bf16_f32 v94, v80, v81
v_cvt_pk_bf16_f32 v95, v82, v83
v_mfma_f32_16x16x32_bf16 v[64:67], v[180:183], a[8:11], v[64:67]
ds_read_b128 v[200:203], v252 offset:7168
v_mfma_f32_16x16x32_bf16 v[64:67], v[184:187], a[12:15], v[64:67]
v_mfma_f32_16x16x32_bf16 v[64:67], v[188:191], a[16:19], v[64:67]
buffer_load_dwordx4 v251, s[12:15], s24 offen offset:1024  lds
ds_read_b128 v[204:207], v252 offset:8192
v_mfma_f32_16x16x32_bf16 v[64:67], v[192:195], a[20:23], v[64:67]
v_mfma_f32_16x16x32_bf16 v[68:71], v[172:175], a[48:51], 0
ds_read_b128 v[208:211], v252 offset:9216
v_mfma_f32_16x16x32_bf16 v[68:71], v[176:179], a[52:55], v[68:71]
v_cvt_pk_bf16_f32 v98, v84, v85
v_cvt_pk_bf16_f32 v99, v86, v87
v_mfma_f32_16x16x32_bf16 v[68:71], v[180:183], a[56:59], v[68:71]
ds_read_b128 v[212:215], v252 offset:10240
v_add_u32 v238, s19, v251
v_mfma_f32_16x16x32_bf16 v[68:71], v[184:187], a[60:63], v[68:71]
buffer_store_dwordx2 v[154:155], v243, s[8:11], s20 offen offset:640 sc1
ds_read_b128 v[108:111], v238 offset:0
v_mfma_f32_16x16x32_bf16 v[68:71], v[188:191], a[64:67], v[68:71]
ds_read_b128 v[216:219], v252 offset:11264
v_mfma_f32_16x16x32_bf16 v[68:71], v[192:195], a[68:71], v[68:71]
v_mfma_f32_16x16x32_bf16 v[72:75], v[172:175], a[96:99], 0
v_mfma_f32_16x16x32_bf16 v[72:75], v[176:179], a[100:103], v[72:75]
v_mfma_f32_16x16x32_bf16 v[72:75], v[180:183], a[104:107], v[72:75]
v_mfma_f32_16x16x32_bf16 v[72:75], v[184:187], a[108:111], v[72:75]
v_mfma_f32_16x16x32_bf16 v[72:75], v[188:191], a[112:115], v[72:75]
v_mfma_f32_16x16x32_bf16 v[72:75], v[192:195], a[116:119], v[72:75]
v_mfma_f32_16x16x32_bf16 v[0:3], a[0:3], v[88:91], 0
v_mfma_f32_16x16x32_bf16 v[4:7], a[48:51], v[88:91], 0
v_mfma_f32_16x16x32_bf16 v[8:11], a[96:99], v[88:91], 0
v_mfma_f32_16x16x32_bf16 v[12:15], v[100:103], v[88:91], 0
v_mfma_f32_16x16x32_bf16 v[16:19], a[0:3], v[92:95], 0
v_mfma_f32_16x16x32_bf16 v[20:23], a[48:51], v[92:95], 0
v_mfma_f32_16x16x32_bf16 v[24:27], a[96:99], v[92:95], 0
v_mfma_f32_16x16x32_bf16 v[28:31], v[100:103], v[92:95], 0
v_mfma_f32_16x16x32_bf16 v[32:35], a[0:3], v[96:99], 0
v_mfma_f32_16x16x32_bf16 v[36:39], a[48:51], v[96:99], 0
buffer_store_dwordx2 v[156:157], v244, s[8:11], s20 offen offset:640 sc1
v_mfma_f32_16x16x32_bf16 v[40:43], a[96:99], v[96:99], 0
v_mfma_f32_16x16x32_bf16 v[44:47], v[100:103], v[96:99], 0
s_waitcnt lgkmcnt(0)
v_mfma_f32_16x16x32_bf16 v[64:67], v[196:199], a[24:27], v[64:67]
ds_read_b128 v[172:175], v252 offset:12288
v_mfma_f32_16x16x32_bf16 v[64:67], v[200:203], a[28:31], v[64:67]
v_mfma_f32_16x16x32_bf16 v[64:67], v[204:207], a[32:35], v[64:67]
ds_read_b128 v[176:179], v252 offset:13312
v_mfma_f32_16x16x32_bf16 v[64:67], v[208:211], a[36:39], v[64:67]
v_mfma_f32_16x16x32_bf16 v[64:67], v[212:215], a[40:43], v[64:67]
ds_read_b128 v[180:183], v252 offset:14336
v_mfma_f32_16x16x32_bf16 v[64:67], v[216:219], a[44:47], v[64:67]
v_mfma_f32_16x16x32_bf16 v[68:71], v[196:199], a[72:75], v[68:71]
ds_read_b128 v[184:187], v252 offset:15360
v_mfma_f32_16x16x32_bf16 v[68:71], v[200:203], a[76:79], v[68:71]
s_add_u32 m0, s18, 98304
v_mfma_f32_16x16x32_bf16 v[68:71], v[204:207], a[80:83], v[68:71]
ds_read_b128 v[188:191], v252 offset:16384
buffer_load_dwordx4 v108, s[4:7], s22 offen offset:0 nt lds
v_mfma_f32_16x16x32_bf16 v[68:71], v[208:211], a[84:87], v[68:71]
v_mfma_f32_16x16x32_bf16 v[68:71], v[212:215], a[88:91], v[68:71]
ds_read_b128 v[192:195], v252 offset:17408
v_mfma_f32_16x16x32_bf16 v[68:71], v[216:219], a[92:95], v[68:71]
ds_read_b128 v[100:103], v253 offset:64
v_mfma_f32_16x16x32_bf16 v[72:75], v[196:199], a[120:123], v[72:75]
v_mfma_f32_16x16x32_bf16 v[72:75], v[200:203], a[124:127], v[72:75]
v_cvt_pk_bf16_f32 v88, v64, v65
v_cvt_pk_bf16_f32 v89, v66, v67
v_mfma_f32_16x16x32_bf16 v[72:75], v[204:207], a[128:131], v[72:75]
v_mfma_f32_16x16x32_bf16 v[72:75], v[208:211], a[132:135], v[72:75]
buffer_store_dwordx2 v[158:159], v245, s[8:11], s20 offen offset:640 sc1
s_add_u32 m0, s18, 99328
v_mfma_f32_16x16x32_bf16 v[72:75], v[212:215], a[136:139], v[72:75]
buffer_load_dwordx4 v109, s[4:7], s22 offen offset:0 nt lds
v_mfma_f32_16x16x32_bf16 v[72:75], v[216:219], a[140:143], v[72:75]
s_waitcnt lgkmcnt(1)
v_mfma_f32_16x16x32_bf16 v[76:79], v[172:175], a[0:3], 0
ds_read_b128 v[196:199], v252 offset:18432
v_mfma_f32_16x16x32_bf16 v[76:79], v[176:179], a[4:7], v[76:79]
v_cvt_pk_bf16_f32 v92, v68, v69
v_cvt_pk_bf16_f32 v93, v70, v71
v_mfma_f32_16x16x32_bf16 v[76:79], v[180:183], a[8:11], v[76:79]
ds_read_b128 v[200:203], v252 offset:19456
v_mfma_f32_16x16x32_bf16 v[76:79], v[184:187], a[12:15], v[76:79]
v_mfma_f32_16x16x32_bf16 v[76:79], v[188:191], a[16:19], v[76:79]
ds_read_b128 v[204:207], v252 offset:20480
v_mfma_f32_16x16x32_bf16 v[76:79], v[192:195], a[20:23], v[76:79]
s_add_u32 m0, s18, 100352
v_mfma_f32_16x16x32_bf16 v[80:83], v[172:175], a[48:51], 0
ds_read_b128 v[208:211], v252 offset:21504
buffer_load_dwordx4 v110, s[4:7], s22 offen offset:0 nt lds
v_mfma_f32_16x16x32_bf16 v[80:83], v[176:179], a[52:55], v[80:83]
v_cvt_pk_bf16_f32 v96, v72, v73
v_cvt_pk_bf16_f32 v97, v74, v75
v_mfma_f32_16x16x32_bf16 v[80:83], v[180:183], a[56:59], v[80:83]
ds_read_b128 v[212:215], v252 offset:22528
v_mfma_f32_16x16x32_bf16 v[80:83], v[184:187], a[60:63], v[80:83]
v_mfma_f32_16x16x32_bf16 v[80:83], v[188:191], a[64:67], v[80:83]
ds_read_b128 v[216:219], v252 offset:23552
v_mfma_f32_16x16x32_bf16 v[80:83], v[192:195], a[68:71], v[80:83]
v_mfma_f32_16x16x32_bf16 v[84:87], v[172:175], a[96:99], 0
v_mfma_f32_16x16x32_bf16 v[84:87], v[176:179], a[100:103], v[84:87]
s_add_u32 m0, s18, 101376
v_mfma_f32_16x16x32_bf16 v[84:87], v[180:183], a[104:107], v[84:87]
buffer_load_dwordx4 v111, s[4:7], s22 offen offset:0 nt lds
v_mfma_f32_16x16x32_bf16 v[84:87], v[184:187], a[108:111], v[84:87]
buffer_store_dwordx2 v[160:161], v246, s[8:11], s20 offen offset:640 sc1
v_mfma_f32_16x16x32_bf16 v[84:87], v[188:191], a[112:115], v[84:87]
v_mfma_f32_16x16x32_bf16 v[84:87], v[192:195], a[116:119], v[84:87]
s_waitcnt vmcnt(24) lgkmcnt(0)
s_barrier
v_add_u32 v252, 24576, v252
v_mfma_f32_16x16x32_bf16 v[76:79], v[196:199], a[24:27], v[76:79]
s_add_u32 m0, s17, 24576
s_mov_b32 s24, 122880
v_mfma_f32_16x16x32_bf16 v[76:79], v[200:203], a[28:31], v[76:79]
ds_read_b128 v[172:175], v252 offset:0
v_mfma_f32_16x16x32_bf16 v[76:79], v[204:207], a[32:35], v[76:79]
buffer_load_dwordx4 v251, s[12:15], s24 offen offset:0  lds
v_mfma_f32_16x16x32_bf16 v[76:79], v[208:211], a[36:39], v[76:79]
ds_read_b128 v[176:179], v252 offset:1024
v_mfma_f32_16x16x32_bf16 v[76:79], v[212:215], a[40:43], v[76:79]
v_mfma_f32_16x16x32_bf16 v[76:79], v[216:219], a[44:47], v[76:79]
ds_read_b128 v[180:183], v252 offset:2048
v_mfma_f32_16x16x32_bf16 v[80:83], v[196:199], a[72:75], v[80:83]
buffer_load_dwordx4 v251, s[12:15], s24 offen offset:1024  lds
v_mfma_f32_16x16x32_bf16 v[80:83], v[200:203], a[76:79], v[80:83]
ds_read_b128 v[184:187], v252 offset:3072
v_mfma_f32_16x16x32_bf16 v[80:83], v[204:207], a[80:83], v[80:83]
v_mfma_f32_16x16x32_bf16 v[80:83], v[208:211], a[84:87], v[80:83]
ds_read_b128 v[188:191], v252 offset:4096
v_mfma_f32_16x16x32_bf16 v[80:83], v[212:215], a[88:91], v[80:83]
buffer_load_dwordx4 v251, s[12:15], s24 offen offset:2048  lds
v_mfma_f32_16x16x32_bf16 v[80:83], v[216:219], a[92:95], v[80:83]
ds_read_b128 v[192:195], v252 offset:5120
v_mfma_f32_16x16x32_bf16 v[84:87], v[196:199], a[120:123], v[84:87]
v_mfma_f32_16x16x32_bf16 v[84:87], v[200:203], a[124:127], v[84:87]
v_cvt_pk_bf16_f32 v90, v76, v77
v_cvt_pk_bf16_f32 v91, v78, v79
v_mfma_f32_16x16x32_bf16 v[84:87], v[204:207], a[128:131], v[84:87]
buffer_load_dwordx4 v251, s[12:15], s24 offen offset:3072  lds
v_mfma_f32_16x16x32_bf16 v[84:87], v[208:211], a[132:135], v[84:87]
buffer_store_dwordx2 v[162:163], v247, s[8:11], s20 offen offset:640 sc1
v_mfma_f32_16x16x32_bf16 v[84:87], v[212:215], a[136:139], v[84:87]
s_add_u32 m0, s17, 28672
s_mov_b32 s24, 126976
v_mfma_f32_16x16x32_bf16 v[84:87], v[216:219], a[140:143], v[84:87]
s_waitcnt lgkmcnt(0)
v_mfma_f32_16x16x32_bf16 v[64:67], v[172:175], a[0:3], 0
buffer_load_dwordx4 v251, s[12:15], s24 offen offset:0  lds
ds_read_b128 v[196:199], v252 offset:6144
v_mfma_f32_16x16x32_bf16 v[64:67], v[176:179], a[4:7], v[64:67]
v_cvt_pk_bf16_f32 v94, v80, v81
v_cvt_pk_bf16_f32 v95, v82, v83
v_mfma_f32_16x16x32_bf16 v[64:67], v[180:183], a[8:11], v[64:67]
ds_read_b128 v[200:203], v252 offset:7168
v_mfma_f32_16x16x32_bf16 v[64:67], v[184:187], a[12:15], v[64:67]
v_mfma_f32_16x16x32_bf16 v[64:67], v[188:191], a[16:19], v[64:67]
buffer_load_dwordx4 v251, s[12:15], s24 offen offset:1024  lds
ds_read_b128 v[204:207], v252 offset:8192
v_mfma_f32_16x16x32_bf16 v[64:67], v[192:195], a[20:23], v[64:67]
v_mfma_f32_16x16x32_bf16 v[68:71], v[172:175], a[48:51], 0
ds_read_b128 v[208:211], v252 offset:9216
v_mfma_f32_16x16x32_bf16 v[68:71], v[176:179], a[52:55], v[68:71]
v_cvt_pk_bf16_f32 v98, v84, v85
v_cvt_pk_bf16_f32 v99, v86, v87
v_mfma_f32_16x16x32_bf16 v[68:71], v[180:183], a[56:59], v[68:71]
ds_read_b128 v[212:215], v252 offset:10240
v_add_u32 v238, s19, v251
v_mfma_f32_16x16x32_bf16 v[68:71], v[184:187], a[60:63], v[68:71]
ds_read_b128 v[108:111], v238 offset:1024
v_mfma_f32_16x16x32_bf16 v[68:71], v[188:191], a[64:67], v[68:71]
ds_read_b128 v[216:219], v252 offset:11264
v_mfma_f32_16x16x32_bf16 v[68:71], v[192:195], a[68:71], v[68:71]
v_mfma_f32_16x16x32_bf16 v[72:75], v[172:175], a[96:99], 0
v_mfma_f32_16x16x32_bf16 v[72:75], v[176:179], a[100:103], v[72:75]
v_mfma_f32_16x16x32_bf16 v[72:75], v[180:183], a[104:107], v[72:75]
v_mfma_f32_16x16x32_bf16 v[72:75], v[184:187], a[108:111], v[72:75]
buffer_store_dwordx2 v[164:165], v248, s[8:11], s20 offen offset:640 sc1
v_mfma_f32_16x16x32_bf16 v[72:75], v[188:191], a[112:115], v[72:75]
v_mfma_f32_16x16x32_bf16 v[72:75], v[192:195], a[116:119], v[72:75]
v_mfma_f32_16x16x32_bf16 v[0:3], a[4:7], v[88:91], v[0:3]
v_mfma_f32_16x16x32_bf16 v[4:7], a[52:55], v[88:91], v[4:7]
v_mfma_f32_16x16x32_bf16 v[8:11], a[100:103], v[88:91], v[8:11]
v_mfma_f32_16x16x32_bf16 v[12:15], v[100:103], v[88:91], v[12:15]
v_mfma_f32_16x16x32_bf16 v[16:19], a[4:7], v[92:95], v[16:19]
v_mfma_f32_16x16x32_bf16 v[20:23], a[52:55], v[92:95], v[20:23]
v_mfma_f32_16x16x32_bf16 v[24:27], a[100:103], v[92:95], v[24:27]
v_mfma_f32_16x16x32_bf16 v[28:31], v[100:103], v[92:95], v[28:31]
v_mfma_f32_16x16x32_bf16 v[32:35], a[4:7], v[96:99], v[32:35]
v_mfma_f32_16x16x32_bf16 v[36:39], a[52:55], v[96:99], v[36:39]
v_mfma_f32_16x16x32_bf16 v[40:43], a[100:103], v[96:99], v[40:43]
v_mfma_f32_16x16x32_bf16 v[44:47], v[100:103], v[96:99], v[44:47]
s_waitcnt lgkmcnt(0)
v_mfma_f32_16x16x32_bf16 v[64:67], v[196:199], a[24:27], v[64:67]
ds_read_b128 v[172:175], v252 offset:12288
v_mfma_f32_16x16x32_bf16 v[64:67], v[200:203], a[28:31], v[64:67]
v_mfma_f32_16x16x32_bf16 v[64:67], v[204:207], a[32:35], v[64:67]
ds_read_b128 v[176:179], v252 offset:13312
v_mfma_f32_16x16x32_bf16 v[64:67], v[208:211], a[36:39], v[64:67]
buffer_store_dwordx2 v[166:167], v249, s[8:11], s20 offen offset:640 sc1
v_mfma_f32_16x16x32_bf16 v[64:67], v[212:215], a[40:43], v[64:67]
ds_read_b128 v[180:183], v252 offset:14336
v_mfma_f32_16x16x32_bf16 v[64:67], v[216:219], a[44:47], v[64:67]
v_mfma_f32_16x16x32_bf16 v[68:71], v[196:199], a[72:75], v[68:71]
ds_read_b128 v[184:187], v252 offset:15360
v_mfma_f32_16x16x32_bf16 v[68:71], v[200:203], a[76:79], v[68:71]
s_add_u32 m0, s18, 102400
v_mfma_f32_16x16x32_bf16 v[68:71], v[204:207], a[80:83], v[68:71]
ds_read_b128 v[188:191], v252 offset:16384
buffer_load_dwordx4 v108, s[4:7], s22 offen offset:0 nt lds
v_mfma_f32_16x16x32_bf16 v[68:71], v[208:211], a[84:87], v[68:71]
v_mfma_f32_16x16x32_bf16 v[68:71], v[212:215], a[88:91], v[68:71]
ds_read_b128 v[192:195], v252 offset:17408
v_mfma_f32_16x16x32_bf16 v[68:71], v[216:219], a[92:95], v[68:71]
ds_read_b128 v[100:103], v253 offset:128
v_mfma_f32_16x16x32_bf16 v[72:75], v[196:199], a[120:123], v[72:75]
v_mfma_f32_16x16x32_bf16 v[72:75], v[200:203], a[124:127], v[72:75]
v_cvt_pk_bf16_f32 v88, v64, v65
v_cvt_pk_bf16_f32 v89, v66, v67
v_mfma_f32_16x16x32_bf16 v[72:75], v[204:207], a[128:131], v[72:75]
v_mfma_f32_16x16x32_bf16 v[72:75], v[208:211], a[132:135], v[72:75]
s_add_u32 m0, s18, 103424
v_mfma_f32_16x16x32_bf16 v[72:75], v[212:215], a[136:139], v[72:75]
buffer_load_dwordx4 v109, s[4:7], s22 offen offset:0 nt lds
v_mfma_f32_16x16x32_bf16 v[72:75], v[216:219], a[140:143], v[72:75]
s_waitcnt lgkmcnt(1)
v_mfma_f32_16x16x32_bf16 v[76:79], v[172:175], a[0:3], 0
ds_read_b128 v[196:199], v252 offset:18432
v_mfma_f32_16x16x32_bf16 v[76:79], v[176:179], a[4:7], v[76:79]
v_cvt_pk_bf16_f32 v92, v68, v69
v_cvt_pk_bf16_f32 v93, v70, v71
v_mfma_f32_16x16x32_bf16 v[76:79], v[180:183], a[8:11], v[76:79]
ds_read_b128 v[200:203], v252 offset:19456
v_mfma_f32_16x16x32_bf16 v[76:79], v[184:187], a[12:15], v[76:79]
buffer_store_dwordx2 v[168:169], v250, s[8:11], s20 offen offset:640 sc1
v_mfma_f32_16x16x32_bf16 v[76:79], v[188:191], a[16:19], v[76:79]
ds_read_b128 v[204:207], v252 offset:20480
v_mfma_f32_16x16x32_bf16 v[76:79], v[192:195], a[20:23], v[76:79]
s_add_u32 m0, s18, 104448
v_mfma_f32_16x16x32_bf16 v[80:83], v[172:175], a[48:51], 0
ds_read_b128 v[208:211], v252 offset:21504
buffer_load_dwordx4 v110, s[4:7], s22 offen offset:0 nt lds
v_mfma_f32_16x16x32_bf16 v[80:83], v[176:179], a[52:55], v[80:83]
v_cvt_pk_bf16_f32 v96, v72, v73
v_cvt_pk_bf16_f32 v97, v74, v75
v_mfma_f32_16x16x32_bf16 v[80:83], v[180:183], a[56:59], v[80:83]
ds_read_b128 v[212:215], v252 offset:22528
v_mfma_f32_16x16x32_bf16 v[80:83], v[184:187], a[60:63], v[80:83]
v_mfma_f32_16x16x32_bf16 v[80:83], v[188:191], a[64:67], v[80:83]
ds_read_b128 v[216:219], v252 offset:23552
v_mfma_f32_16x16x32_bf16 v[80:83], v[192:195], a[68:71], v[80:83]
v_mfma_f32_16x16x32_bf16 v[84:87], v[172:175], a[96:99], 0
v_mfma_f32_16x16x32_bf16 v[84:87], v[176:179], a[100:103], v[84:87]
s_add_u32 m0, s18, 105472
v_mfma_f32_16x16x32_bf16 v[84:87], v[180:183], a[104:107], v[84:87]
buffer_load_dwordx4 v111, s[4:7], s22 offen offset:0 nt lds
v_mfma_f32_16x16x32_bf16 v[84:87], v[184:187], a[108:111], v[84:87]
v_mfma_f32_16x16x32_bf16 v[84:87], v[188:191], a[112:115], v[84:87]
v_mfma_f32_16x16x32_bf16 v[84:87], v[192:195], a[116:119], v[84:87]
s_waitcnt vmcnt(32) lgkmcnt(0)
s_barrier
v_add_u32 v252, 24576, v252
v_mfma_f32_16x16x32_bf16 v[76:79], v[196:199], a[24:27], v[76:79]
s_add_u32 m0, s17, 49152
s_mov_b32 s24, 147456
v_mfma_f32_16x16x32_bf16 v[76:79], v[200:203], a[28:31], v[76:79]
ds_read_b128 v[172:175], v252 offset:0
v_mfma_f32_16x16x32_bf16 v[76:79], v[204:207], a[32:35], v[76:79]
buffer_load_dwordx4 v251, s[12:15], s24 offen offset:0  lds
v_mfma_f32_16x16x32_bf16 v[76:79], v[208:211], a[36:39], v[76:79]
s_add_u32 s25, s20, 1746432
s_mov_b64 exec, 0xffff
buffer_store_dwordx2 v[170:171], v239, s[8:11], s25 offen offset:640 sc1
s_mov_b64 exec, -1
ds_read_b128 v[176:179], v252 offset:1024
v_mfma_f32_16x16x32_bf16 v[76:79], v[212:215], a[40:43], v[76:79]
s_mov_b32 s10, 109734912
v_mfma_f32_16x16x32_bf16 v[76:79], v[216:219], a[44:47], v[76:79]
ds_read_b128 v[180:183], v252 offset:2048
v_mfma_f32_16x16x32_bf16 v[80:83], v[196:199], a[72:75], v[80:83]
buffer_load_dwordx4 v251, s[12:15], s24 offen offset:1024  lds
v_mfma_f32_16x16x32_bf16 v[80:83], v[200:203], a[76:79], v[80:83]
ds_read_b128 v[184:187], v252 offset:3072
v_mfma_f32_16x16x32_bf16 v[80:83], v[204:207], a[80:83], v[80:83]
v_mfma_f32_16x16x32_bf16 v[80:83], v[208:211], a[84:87], v[80:83]
ds_read_b128 v[188:191], v252 offset:4096
v_mfma_f32_16x16x32_bf16 v[80:83], v[212:215], a[88:91], v[80:83]
buffer_load_dwordx4 v251, s[12:15], s24 offen offset:2048  lds
v_mfma_f32_16x16x32_bf16 v[80:83], v[216:219], a[92:95], v[80:83]
ds_read_b128 v[192:195], v252 offset:5120
v_mfma_f32_16x16x32_bf16 v[84:87], v[196:199], a[120:123], v[84:87]
v_mfma_f32_16x16x32_bf16 v[84:87], v[200:203], a[124:127], v[84:87]
v_cvt_pk_bf16_f32 v90, v76, v77
v_cvt_pk_bf16_f32 v91, v78, v79
v_mfma_f32_16x16x32_bf16 v[84:87], v[204:207], a[128:131], v[84:87]
buffer_load_dwordx4 v251, s[12:15], s24 offen offset:3072  lds
v_mfma_f32_16x16x32_bf16 v[84:87], v[208:211], a[132:135], v[84:87]
v_mfma_f32_16x16x32_bf16 v[84:87], v[212:215], a[136:139], v[84:87]
s_add_u32 m0, s17, 53248
s_mov_b32 s24, 151552
v_mfma_f32_16x16x32_bf16 v[84:87], v[216:219], a[140:143], v[84:87]
s_waitcnt lgkmcnt(0)
v_mfma_f32_16x16x32_bf16 v[64:67], v[172:175], a[0:3], 0
buffer_load_dwordx4 v251, s[12:15], s24 offen offset:0  lds
ds_read_b128 v[196:199], v252 offset:6144
v_mfma_f32_16x16x32_bf16 v[64:67], v[176:179], a[4:7], v[64:67]
v_cvt_pk_bf16_f32 v94, v80, v81
v_cvt_pk_bf16_f32 v95, v82, v83
v_mfma_f32_16x16x32_bf16 v[64:67], v[180:183], a[8:11], v[64:67]
ds_read_b128 v[200:203], v252 offset:7168
v_mfma_f32_16x16x32_bf16 v[64:67], v[184:187], a[12:15], v[64:67]
v_mfma_f32_16x16x32_bf16 v[64:67], v[188:191], a[16:19], v[64:67]
buffer_load_dwordx4 v251, s[12:15], s24 offen offset:1024  lds
ds_read_b128 v[204:207], v252 offset:8192
v_mfma_f32_16x16x32_bf16 v[64:67], v[192:195], a[20:23], v[64:67]
v_mfma_f32_16x16x32_bf16 v[68:71], v[172:175], a[48:51], 0
ds_read_b128 v[208:211], v252 offset:9216
v_mfma_f32_16x16x32_bf16 v[68:71], v[176:179], a[52:55], v[68:71]
v_cvt_pk_bf16_f32 v98, v84, v85
v_cvt_pk_bf16_f32 v99, v86, v87
v_mfma_f32_16x16x32_bf16 v[68:71], v[180:183], a[56:59], v[68:71]
ds_read_b128 v[212:215], v252 offset:10240
v_add_u32 v238, s19, v251
v_mfma_f32_16x16x32_bf16 v[68:71], v[184:187], a[60:63], v[68:71]
ds_read_b128 v[108:111], v238 offset:2048
v_mfma_f32_16x16x32_bf16 v[68:71], v[188:191], a[64:67], v[68:71]
ds_read_b128 v[216:219], v252 offset:11264
v_mfma_f32_16x16x32_bf16 v[68:71], v[192:195], a[68:71], v[68:71]
v_mfma_f32_16x16x32_bf16 v[72:75], v[172:175], a[96:99], 0
v_mfma_f32_16x16x32_bf16 v[72:75], v[176:179], a[100:103], v[72:75]
v_mfma_f32_16x16x32_bf16 v[72:75], v[180:183], a[104:107], v[72:75]
v_mfma_f32_16x16x32_bf16 v[72:75], v[184:187], a[108:111], v[72:75]
v_mfma_f32_16x16x32_bf16 v[72:75], v[188:191], a[112:115], v[72:75]
v_mfma_f32_16x16x32_bf16 v[72:75], v[192:195], a[116:119], v[72:75]
v_mfma_f32_16x16x32_bf16 v[0:3], a[8:11], v[88:91], v[0:3]
v_mfma_f32_16x16x32_bf16 v[4:7], a[56:59], v[88:91], v[4:7]
v_mfma_f32_16x16x32_bf16 v[8:11], a[104:107], v[88:91], v[8:11]
v_mfma_f32_16x16x32_bf16 v[12:15], v[100:103], v[88:91], v[12:15]
v_mfma_f32_16x16x32_bf16 v[16:19], a[8:11], v[92:95], v[16:19]
v_mfma_f32_16x16x32_bf16 v[20:23], a[56:59], v[92:95], v[20:23]
v_mfma_f32_16x16x32_bf16 v[24:27], a[104:107], v[92:95], v[24:27]
v_mfma_f32_16x16x32_bf16 v[28:31], v[100:103], v[92:95], v[28:31]
v_mfma_f32_16x16x32_bf16 v[32:35], a[8:11], v[96:99], v[32:35]
v_mfma_f32_16x16x32_bf16 v[36:39], a[56:59], v[96:99], v[36:39]
v_mfma_f32_16x16x32_bf16 v[40:43], a[104:107], v[96:99], v[40:43]
v_mfma_f32_16x16x32_bf16 v[44:47], v[100:103], v[96:99], v[44:47]
s_waitcnt lgkmcnt(0)
v_mfma_f32_16x16x32_bf16 v[64:67], v[196:199], a[24:27], v[64:67]
ds_read_b128 v[172:175], v252 offset:12288
v_mfma_f32_16x16x32_bf16 v[64:67], v[200:203], a[28:31], v[64:67]
v_mfma_f32_16x16x32_bf16 v[64:67], v[204:207], a[32:35], v[64:67]
ds_read_b128 v[176:179], v252 offset:13312
v_mfma_f32_16x16x32_bf16 v[64:67], v[208:211], a[36:39], v[64:67]
v_mfma_f32_16x16x32_bf16 v[64:67], v[212:215], a[40:43], v[64:67]
ds_read_b128 v[180:183], v252 offset:14336
v_mfma_f32_16x16x32_bf16 v[64:67], v[216:219], a[44:47], v[64:67]
v_mfma_f32_16x16x32_bf16 v[68:71], v[196:199], a[72:75], v[68:71]
ds_read_b128 v[184:187], v252 offset:15360
v_mfma_f32_16x16x32_bf16 v[68:71], v[200:203], a[76:79], v[68:71]
s_add_u32 m0, s18, 106496
v_mfma_f32_16x16x32_bf16 v[68:71], v[204:207], a[80:83], v[68:71]
ds_read_b128 v[188:191], v252 offset:16384
buffer_load_dwordx4 v108, s[4:7], s22 offen offset:0 nt lds
v_mfma_f32_16x16x32_bf16 v[68:71], v[208:211], a[84:87], v[68:71]
v_mfma_f32_16x16x32_bf16 v[68:71], v[212:215], a[88:91], v[68:71]
ds_read_b128 v[192:195], v252 offset:17408
v_mfma_f32_16x16x32_bf16 v[68:71], v[216:219], a[92:95], v[68:71]
ds_read_b128 v[100:103], v253 offset:192
v_mfma_f32_16x16x32_bf16 v[72:75], v[196:199], a[120:123], v[72:75]
v_mfma_f32_16x16x32_bf16 v[72:75], v[200:203], a[124:127], v[72:75]
v_cvt_pk_bf16_f32 v88, v64, v65
v_cvt_pk_bf16_f32 v89, v66, v67
v_mfma_f32_16x16x32_bf16 v[72:75], v[204:207], a[128:131], v[72:75]
v_mfma_f32_16x16x32_bf16 v[72:75], v[208:211], a[132:135], v[72:75]
s_add_u32 m0, s18, 107520
v_mfma_f32_16x16x32_bf16 v[72:75], v[212:215], a[136:139], v[72:75]
buffer_load_dwordx4 v109, s[4:7], s22 offen offset:0 nt lds
v_mfma_f32_16x16x32_bf16 v[72:75], v[216:219], a[140:143], v[72:75]
s_waitcnt lgkmcnt(1)
v_mfma_f32_16x16x32_bf16 v[76:79], v[172:175], a[0:3], 0
ds_read_b128 v[196:199], v252 offset:18432
v_mfma_f32_16x16x32_bf16 v[76:79], v[176:179], a[4:7], v[76:79]
v_cvt_pk_bf16_f32 v92, v68, v69
v_cvt_pk_bf16_f32 v93, v70, v71
v_mfma_f32_16x16x32_bf16 v[76:79], v[180:183], a[8:11], v[76:79]
ds_read_b128 v[200:203], v252 offset:19456
v_mfma_f32_16x16x32_bf16 v[76:79], v[184:187], a[12:15], v[76:79]
v_mfma_f32_16x16x32_bf16 v[76:79], v[188:191], a[16:19], v[76:79]
ds_read_b128 v[204:207], v252 offset:20480
v_mfma_f32_16x16x32_bf16 v[76:79], v[192:195], a[20:23], v[76:79]
s_add_u32 m0, s18, 108544
v_mfma_f32_16x16x32_bf16 v[80:83], v[172:175], a[48:51], 0
ds_read_b128 v[208:211], v252 offset:21504
buffer_load_dwordx4 v110, s[4:7], s22 offen offset:0 nt lds
v_mfma_f32_16x16x32_bf16 v[80:83], v[176:179], a[52:55], v[80:83]
v_cvt_pk_bf16_f32 v96, v72, v73
v_cvt_pk_bf16_f32 v97, v74, v75
v_mfma_f32_16x16x32_bf16 v[80:83], v[180:183], a[56:59], v[80:83]
ds_read_b128 v[212:215], v252 offset:22528
v_mfma_f32_16x16x32_bf16 v[80:83], v[184:187], a[60:63], v[80:83]
v_mfma_f32_16x16x32_bf16 v[80:83], v[188:191], a[64:67], v[80:83]
ds_read_b128 v[216:219], v252 offset:23552
v_mfma_f32_16x16x32_bf16 v[80:83], v[192:195], a[68:71], v[80:83]
v_mfma_f32_16x16x32_bf16 v[84:87], v[172:175], a[96:99], 0
v_mfma_f32_16x16x32_bf16 v[84:87], v[176:179], a[100:103], v[84:87]
s_add_u32 m0, s18, 109568
v_mfma_f32_16x16x32_bf16 v[84:87], v[180:183], a[104:107], v[84:87]
buffer_load_dwordx4 v111, s[4:7], s22 offen offset:0 nt lds
v_mfma_f32_16x16x32_bf16 v[84:87], v[184:187], a[108:111], v[84:87]
v_mfma_f32_16x16x32_bf16 v[84:87], v[188:191], a[112:115], v[84:87]
v_mfma_f32_16x16x32_bf16 v[84:87], v[192:195], a[116:119], v[84:87]
s_waitcnt vmcnt(33) lgkmcnt(0)
s_barrier
v_add_u32 v252, 4294893568, v252
v_mfma_f32_16x16x32_bf16 v[76:79], v[196:199], a[24:27], v[76:79]
s_add_u32 m0, s17, 73728
s_mov_b32 s24, 172032
v_mfma_f32_16x16x32_bf16 v[76:79], v[200:203], a[28:31], v[76:79]
ds_read_b128 v[172:175], v252 offset:0
v_mfma_f32_16x16x32_bf16 v[76:79], v[204:207], a[32:35], v[76:79]
buffer_load_dwordx4 v251, s[12:15], s24 offen offset:0  lds
v_mfma_f32_16x16x32_bf16 v[76:79], v[208:211], a[36:39], v[76:79]
ds_read_b128 v[176:179], v252 offset:1024
v_mfma_f32_16x16x32_bf16 v[76:79], v[212:215], a[40:43], v[76:79]
v_mfma_f32_16x16x32_bf16 v[76:79], v[216:219], a[44:47], v[76:79]
ds_read_b128 v[180:183], v252 offset:2048
v_mfma_f32_16x16x32_bf16 v[80:83], v[196:199], a[72:75], v[80:83]
buffer_load_dwordx4 v251, s[12:15], s24 offen offset:1024  lds
v_mfma_f32_16x16x32_bf16 v[80:83], v[200:203], a[76:79], v[80:83]
ds_read_b128 v[184:187], v252 offset:3072
v_mfma_f32_16x16x32_bf16 v[80:83], v[204:207], a[80:83], v[80:83]
v_mfma_f32_16x16x32_bf16 v[80:83], v[208:211], a[84:87], v[80:83]
ds_read_b128 v[188:191], v252 offset:4096
v_mfma_f32_16x16x32_bf16 v[80:83], v[212:215], a[88:91], v[80:83]
buffer_load_dwordx4 v251, s[12:15], s24 offen offset:2048  lds
v_mfma_f32_16x16x32_bf16 v[80:83], v[216:219], a[92:95], v[80:83]
ds_read_b128 v[192:195], v252 offset:5120
v_mfma_f32_16x16x32_bf16 v[84:87], v[196:199], a[120:123], v[84:87]
v_mfma_f32_16x16x32_bf16 v[84:87], v[200:203], a[124:127], v[84:87]
v_cvt_pk_bf16_f32 v90, v76, v77
v_cvt_pk_bf16_f32 v91, v78, v79
v_mfma_f32_16x16x32_bf16 v[84:87], v[204:207], a[128:131], v[84:87]
buffer_load_dwordx4 v251, s[12:15], s24 offen offset:3072  lds
v_mfma_f32_16x16x32_bf16 v[84:87], v[208:211], a[132:135], v[84:87]
v_mfma_f32_16x16x32_bf16 v[84:87], v[212:215], a[136:139], v[84:87]
s_add_u32 m0, s17, 77824
s_mov_b32 s24, 176128
v_mfma_f32_16x16x32_bf16 v[84:87], v[216:219], a[140:143], v[84:87]
s_waitcnt lgkmcnt(0)
v_mfma_f32_16x16x32_bf16 v[64:67], v[172:175], a[0:3], 0
buffer_load_dwordx4 v251, s[12:15], s24 offen offset:0  lds
ds_read_b128 v[196:199], v252 offset:6144
v_mfma_f32_16x16x32_bf16 v[64:67], v[176:179], a[4:7], v[64:67]
v_cvt_pk_bf16_f32 v94, v80, v81
v_cvt_pk_bf16_f32 v95, v82, v83
v_mfma_f32_16x16x32_bf16 v[64:67], v[180:183], a[8:11], v[64:67]
ds_read_b128 v[200:203], v252 offset:7168
v_mfma_f32_16x16x32_bf16 v[64:67], v[184:187], a[12:15], v[64:67]
v_mfma_f32_16x16x32_bf16 v[64:67], v[188:191], a[16:19], v[64:67]
buffer_load_dwordx4 v251, s[12:15], s24 offen offset:1024  lds
ds_read_b128 v[204:207], v252 offset:8192
v_mfma_f32_16x16x32_bf16 v[64:67], v[192:195], a[20:23], v[64:67]
v_mfma_f32_16x16x32_bf16 v[68:71], v[172:175], a[48:51], 0
ds_read_b128 v[208:211], v252 offset:9216
v_mfma_f32_16x16x32_bf16 v[68:71], v[176:179], a[52:55], v[68:71]
v_cvt_pk_bf16_f32 v98, v84, v85
v_cvt_pk_bf16_f32 v99, v86, v87
v_mfma_f32_16x16x32_bf16 v[68:71], v[180:183], a[56:59], v[68:71]
ds_read_b128 v[212:215], v252 offset:10240
v_mfma_f32_16x16x32_bf16 v[68:71], v[184:187], a[60:63], v[68:71]
v_mfma_f32_16x16x32_bf16 v[68:71], v[188:191], a[64:67], v[68:71]
ds_read_b128 v[216:219], v252 offset:11264
v_mfma_f32_16x16x32_bf16 v[68:71], v[192:195], a[68:71], v[68:71]
v_mfma_f32_16x16x32_bf16 v[72:75], v[172:175], a[96:99], 0
s_waitcnt vmcnt(32)
ds_read_b128 a[144:147], v237 offset:0
v_mfma_f32_16x16x32_bf16 v[72:75], v[176:179], a[100:103], v[72:75]
v_mfma_f32_16x16x32_bf16 v[72:75], v[180:183], a[104:107], v[72:75]
v_xor_b32 v238, 64, v237
ds_read_b128 a[148:151], v238 offset:0
v_mfma_f32_16x16x32_bf16 v[72:75], v[184:187], a[108:111], v[72:75]
v_mfma_f32_16x16x32_bf16 v[72:75], v[188:191], a[112:115], v[72:75]
v_xor_b32 v238, 128, v237
ds_read_b128 a[152:155], v238 offset:0
v_mfma_f32_16x16x32_bf16 v[72:75], v[192:195], a[116:119], v[72:75]
v_mfma_f32_16x16x32_bf16 v[0:3], a[12:15], v[88:91], v[0:3]
v_xor_b32 v238, 192, v237
ds_read_b128 a[156:159], v238 offset:0
v_mfma_f32_16x16x32_bf16 v[4:7], a[60:63], v[88:91], v[4:7]
v_mfma_f32_16x16x32_bf16 v[8:11], a[108:111], v[88:91], v[8:11]
v_mfma_f32_16x16x32_bf16 v[12:15], v[100:103], v[88:91], v[12:15]
v_mfma_f32_16x16x32_bf16 v[16:19], a[12:15], v[92:95], v[16:19]
v_mfma_f32_16x16x32_bf16 v[20:23], a[60:63], v[92:95], v[20:23]
v_mfma_f32_16x16x32_bf16 v[24:27], a[108:111], v[92:95], v[24:27]
v_mfma_f32_16x16x32_bf16 v[28:31], v[100:103], v[92:95], v[28:31]
v_mfma_f32_16x16x32_bf16 v[32:35], a[12:15], v[96:99], v[32:35]
v_mfma_f32_16x16x32_bf16 v[36:39], a[60:63], v[96:99], v[36:39]
v_mfma_f32_16x16x32_bf16 v[40:43], a[108:111], v[96:99], v[40:43]
v_mfma_f32_16x16x32_bf16 v[44:47], v[100:103], v[96:99], v[44:47]
s_waitcnt lgkmcnt(4)
v_mfma_f32_16x16x32_bf16 v[64:67], v[196:199], a[24:27], v[64:67]
ds_read_b128 v[172:175], v252 offset:12288
v_mfma_f32_16x16x32_bf16 v[64:67], v[200:203], a[28:31], v[64:67]
v_mfma_f32_16x16x32_bf16 v[64:67], v[204:207], a[32:35], v[64:67]
ds_read_b128 v[176:179], v252 offset:13312
v_mfma_f32_16x16x32_bf16 v[64:67], v[208:211], a[36:39], v[64:67]
v_mfma_f32_16x16x32_bf16 v[64:67], v[212:215], a[40:43], v[64:67]
ds_read_b128 v[180:183], v252 offset:14336
v_mfma_f32_16x16x32_bf16 v[64:67], v[216:219], a[44:47], v[64:67]
v_mfma_f32_16x16x32_bf16 v[68:71], v[196:199], a[72:75], v[68:71]
ds_read_b128 v[184:187], v252 offset:15360
v_mfma_f32_16x16x32_bf16 v[68:71], v[200:203], a[76:79], v[68:71]
v_mfma_f32_16x16x32_bf16 v[68:71], v[204:207], a[80:83], v[68:71]
ds_read_b128 v[188:191], v252 offset:16384
v_mfma_f32_16x16x32_bf16 v[68:71], v[208:211], a[84:87], v[68:71]
v_mfma_f32_16x16x32_bf16 v[68:71], v[212:215], a[88:91], v[68:71]
ds_read_b128 v[192:195], v252 offset:17408
v_mfma_f32_16x16x32_bf16 v[68:71], v[216:219], a[92:95], v[68:71]
ds_read_b128 v[100:103], v253 offset:256
v_mfma_f32_16x16x32_bf16 v[72:75], v[196:199], a[120:123], v[72:75]
v_mfma_f32_16x16x32_bf16 v[72:75], v[200:203], a[124:127], v[72:75]
v_cvt_pk_bf16_f32 v88, v64, v65
v_cvt_pk_bf16_f32 v89, v66, v67
v_mfma_f32_16x16x32_bf16 v[72:75], v[204:207], a[128:131], v[72:75]
v_mfma_f32_16x16x32_bf16 v[72:75], v[208:211], a[132:135], v[72:75]
v_mfma_f32_16x16x32_bf16 v[72:75], v[212:215], a[136:139], v[72:75]
v_mfma_f32_16x16x32_bf16 v[72:75], v[216:219], a[140:143], v[72:75]
s_waitcnt lgkmcnt(1)
v_mfma_f32_16x16x32_bf16 v[76:79], v[172:175], a[0:3], 0
ds_read_b128 v[196:199], v252 offset:18432
v_mfma_f32_16x16x32_bf16 v[76:79], v[176:179], a[4:7], v[76:79]
v_cvt_pk_bf16_f32 v92, v68, v69
v_cvt_pk_bf16_f32 v93, v70, v71
v_mfma_f32_16x16x32_bf16 v[76:79], v[180:183], a[8:11], v[76:79]
ds_read_b128 v[200:203], v252 offset:19456
v_mfma_f32_16x16x32_bf16 v[76:79], v[184:187], a[12:15], v[76:79]
v_mfma_f32_16x16x32_bf16 v[76:79], v[188:191], a[16:19], v[76:79]
ds_read_b128 v[204:207], v252 offset:20480
v_mfma_f32_16x16x32_bf16 v[76:79], v[192:195], a[20:23], v[76:79]
v_mfma_f32_16x16x32_bf16 v[80:83], v[172:175], a[48:51], 0
ds_read_b128 v[208:211], v252 offset:21504
v_mfma_f32_16x16x32_bf16 v[80:83], v[176:179], a[52:55], v[80:83]
v_cvt_pk_bf16_f32 v96, v72, v73
v_cvt_pk_bf16_f32 v97, v74, v75
v_mfma_f32_16x16x32_bf16 v[80:83], v[180:183], a[56:59], v[80:83]
ds_read_b128 v[212:215], v252 offset:22528
v_mfma_f32_16x16x32_bf16 v[80:83], v[184:187], a[60:63], v[80:83]
v_mfma_f32_16x16x32_bf16 v[80:83], v[188:191], a[64:67], v[80:83]
ds_read_b128 v[216:219], v252 offset:23552
v_mfma_f32_16x16x32_bf16 v[80:83], v[192:195], a[68:71], v[80:83]
v_mfma_f32_16x16x32_bf16 v[84:87], v[172:175], a[96:99], 0
v_mfma_f32_16x16x32_bf16 v[84:87], v[176:179], a[100:103], v[84:87]
v_mfma_f32_16x16x32_bf16 v[84:87], v[180:183], a[104:107], v[84:87]
v_mfma_f32_16x16x32_bf16 v[84:87], v[184:187], a[108:111], v[84:87]
v_mfma_f32_16x16x32_bf16 v[84:87], v[188:191], a[112:115], v[84:87]
v_mfma_f32_16x16x32_bf16 v[84:87], v[192:195], a[116:119], v[84:87]
s_waitcnt vmcnt(24) lgkmcnt(0)
s_barrier
v_add_u32 v252, 24576, v252
v_mfma_f32_16x16x32_bf16 v[76:79], v[196:199], a[24:27], v[76:79]
s_add_u32 m0, s17, 0
s_mov_b32 s24, 196608
v_mfma_f32_16x16x32_bf16 v[76:79], v[200:203], a[28:31], v[76:79]
ds_read_b128 v[172:175], v252 offset:0
v_mfma_f32_16x16x32_bf16 v[76:79], v[204:207], a[32:35], v[76:79]
buffer_load_dwordx4 v251, s[12:15], s24 offen offset:0  lds
v_mfma_f32_16x16x32_bf16 v[76:79], v[208:211], a[36:39], v[76:79]
ds_read_b128 v[176:179], v252 offset:1024
v_mfma_f32_16x16x32_bf16 v[76:79], v[212:215], a[40:43], v[76:79]
v_mfma_f32_16x16x32_bf16 v[76:79], v[216:219], a[44:47], v[76:79]
ds_read_b128 v[180:183], v252 offset:2048
v_mfma_f32_16x16x32_bf16 v[80:83], v[196:199], a[72:75], v[80:83]
buffer_load_dwordx4 v251, s[12:15], s24 offen offset:1024  lds
v_mfma_f32_16x16x32_bf16 v[80:83], v[200:203], a[76:79], v[80:83]
ds_read_b128 v[184:187], v252 offset:3072
v_mfma_f32_16x16x32_bf16 v[80:83], v[204:207], a[80:83], v[80:83]
v_mfma_f32_16x16x32_bf16 v[80:83], v[208:211], a[84:87], v[80:83]
ds_read_b128 v[188:191], v252 offset:4096
v_mfma_f32_16x16x32_bf16 v[80:83], v[212:215], a[88:91], v[80:83]
buffer_load_dwordx4 v251, s[12:15], s24 offen offset:2048  lds
v_mfma_f32_16x16x32_bf16 v[80:83], v[216:219], a[92:95], v[80:83]
ds_read_b128 v[192:195], v252 offset:5120
v_mfma_f32_16x16x32_bf16 v[84:87], v[196:199], a[120:123], v[84:87]
v_mfma_f32_16x16x32_bf16 v[84:87], v[200:203], a[124:127], v[84:87]
v_cvt_pk_bf16_f32 v90, v76, v77
v_cvt_pk_bf16_f32 v91, v78, v79
v_mfma_f32_16x16x32_bf16 v[84:87], v[204:207], a[128:131], v[84:87]
buffer_load_dwordx4 v251, s[12:15], s24 offen offset:3072  lds
v_mfma_f32_16x16x32_bf16 v[84:87], v[208:211], a[132:135], v[84:87]
v_mfma_f32_16x16x32_bf16 v[84:87], v[212:215], a[136:139], v[84:87]
s_add_u32 m0, s17, 4096
s_mov_b32 s24, 200704
v_mfma_f32_16x16x32_bf16 v[84:87], v[216:219], a[140:143], v[84:87]
s_waitcnt lgkmcnt(0)
v_mfma_f32_16x16x32_bf16 v[64:67], v[172:175], a[0:3], 0
buffer_load_dwordx4 v251, s[12:15], s24 offen offset:0  lds
ds_read_b128 v[196:199], v252 offset:6144
v_mfma_f32_16x16x32_bf16 v[64:67], v[176:179], a[4:7], v[64:67]
v_cvt_pk_bf16_f32 v94, v80, v81
v_cvt_pk_bf16_f32 v95, v82, v83
v_mfma_f32_16x16x32_bf16 v[64:67], v[180:183], a[8:11], v[64:67]
ds_read_b128 v[200:203], v252 offset:7168
v_mfma_f32_16x16x32_bf16 v[64:67], v[184:187], a[12:15], v[64:67]
v_mfma_f32_16x16x32_bf16 v[64:67], v[188:191], a[16:19], v[64:67]
buffer_load_dwordx4 v251, s[12:15], s24 offen offset:1024  lds
ds_read_b128 v[204:207], v252 offset:8192
v_mfma_f32_16x16x32_bf16 v[64:67], v[192:195], a[20:23], v[64:67]
v_mfma_f32_16x16x32_bf16 v[68:71], v[172:175], a[48:51], 0
ds_read_b128 v[208:211], v252 offset:9216
v_mfma_f32_16x16x32_bf16 v[68:71], v[176:179], a[52:55], v[68:71]
v_cvt_pk_bf16_f32 v98, v84, v85
v_cvt_pk_bf16_f32 v99, v86, v87
v_mfma_f32_16x16x32_bf16 v[68:71], v[180:183], a[56:59], v[68:71]
ds_read_b128 v[212:215], v252 offset:10240
v_add_u32 v238, s19, v251
v_mfma_f32_16x16x32_bf16 v[68:71], v[184:187], a[60:63], v[68:71]
ds_read_b128 v[108:111], v238 offset:0
v_mfma_f32_16x16x32_bf16 v[68:71], v[188:191], a[64:67], v[68:71]
ds_read_b128 v[216:219], v252 offset:11264
v_mfma_f32_16x16x32_bf16 v[68:71], v[192:195], a[68:71], v[68:71]
v_mfma_f32_16x16x32_bf16 v[72:75], v[172:175], a[96:99], 0
s_waitcnt vmcnt(23)
ds_read_b128 a[176:179], v237 offset:4096
v_mfma_f32_16x16x32_bf16 v[72:75], v[176:179], a[100:103], v[72:75]
v_mfma_f32_16x16x32_bf16 v[72:75], v[180:183], a[104:107], v[72:75]
v_xor_b32 v238, 64, v237
ds_read_b128 a[180:183], v238 offset:4096
v_mfma_f32_16x16x32_bf16 v[72:75], v[184:187], a[108:111], v[72:75]
v_mfma_f32_16x16x32_bf16 v[72:75], v[188:191], a[112:115], v[72:75]
v_xor_b32 v238, 128, v237
ds_read_b128 a[184:187], v238 offset:4096
v_mfma_f32_16x16x32_bf16 v[72:75], v[192:195], a[116:119], v[72:75]
v_mfma_f32_16x16x32_bf16 v[0:3], a[16:19], v[88:91], v[0:3]
v_xor_b32 v238, 192, v237
ds_read_b128 a[188:191], v238 offset:4096
v_mfma_f32_16x16x32_bf16 v[4:7], a[64:67], v[88:91], v[4:7]
v_mfma_f32_16x16x32_bf16 v[8:11], a[112:115], v[88:91], v[8:11]
v_mfma_f32_16x16x32_bf16 v[12:15], v[100:103], v[88:91], v[12:15]
v_mfma_f32_16x16x32_bf16 v[16:19], a[16:19], v[92:95], v[16:19]
v_mfma_f32_16x16x32_bf16 v[20:23], a[64:67], v[92:95], v[20:23]
v_mfma_f32_16x16x32_bf16 v[24:27], a[112:115], v[92:95], v[24:27]
v_mfma_f32_16x16x32_bf16 v[28:31], v[100:103], v[92:95], v[28:31]
v_mfma_f32_16x16x32_bf16 v[32:35], a[16:19], v[96:99], v[32:35]
v_mfma_f32_16x16x32_bf16 v[36:39], a[64:67], v[96:99], v[36:39]
v_mfma_f32_16x16x32_bf16 v[40:43], a[112:115], v[96:99], v[40:43]
v_mfma_f32_16x16x32_bf16 v[44:47], v[100:103], v[96:99], v[44:47]
s_waitcnt lgkmcnt(4)
v_mfma_f32_16x16x32_bf16 v[64:67], v[196:199], a[24:27], v[64:67]
ds_read_b128 v[172:175], v252 offset:12288
v_mfma_f32_16x16x32_bf16 v[64:67], v[200:203], a[28:31], v[64:67]
v_mfma_f32_16x16x32_bf16 v[64:67], v[204:207], a[32:35], v[64:67]
ds_read_b128 v[176:179], v252 offset:13312
v_mfma_f32_16x16x32_bf16 v[64:67], v[208:211], a[36:39], v[64:67]
v_mfma_f32_16x16x32_bf16 v[64:67], v[212:215], a[40:43], v[64:67]
ds_read_b128 v[180:183], v252 offset:14336
v_mfma_f32_16x16x32_bf16 v[64:67], v[216:219], a[44:47], v[64:67]
v_mfma_f32_16x16x32_bf16 v[68:71], v[196:199], a[72:75], v[68:71]
ds_read_b128 v[184:187], v252 offset:15360
v_mfma_f32_16x16x32_bf16 v[68:71], v[200:203], a[76:79], v[68:71]
s_add_u32 m0, s18, 98048
v_mfma_f32_16x16x32_bf16 v[68:71], v[204:207], a[80:83], v[68:71]
ds_read_b128 v[188:191], v252 offset:16384
buffer_load_dwordx4 v108, s[4:7], s22 offen offset:256 nt lds
v_mfma_f32_16x16x32_bf16 v[68:71], v[208:211], a[84:87], v[68:71]
v_mfma_f32_16x16x32_bf16 v[68:71], v[212:215], a[88:91], v[68:71]
ds_read_b128 v[192:195], v252 offset:17408
v_mfma_f32_16x16x32_bf16 v[68:71], v[216:219], a[92:95], v[68:71]
ds_read_b128 v[100:103], v253 offset:320
v_mfma_f32_16x16x32_bf16 v[72:75], v[196:199], a[120:123], v[72:75]
v_mfma_f32_16x16x32_bf16 v[72:75], v[200:203], a[124:127], v[72:75]
v_cvt_pk_bf16_f32 v88, v64, v65
v_cvt_pk_bf16_f32 v89, v66, v67
v_mfma_f32_16x16x32_bf16 v[72:75], v[204:207], a[128:131], v[72:75]
v_mfma_f32_16x16x32_bf16 v[72:75], v[208:211], a[132:135], v[72:75]
s_add_u32 m0, s18, 99072
v_mfma_f32_16x16x32_bf16 v[72:75], v[212:215], a[136:139], v[72:75]
buffer_load_dwordx4 v109, s[4:7], s22 offen offset:256 nt lds
v_mfma_f32_16x16x32_bf16 v[72:75], v[216:219], a[140:143], v[72:75]
s_waitcnt lgkmcnt(1)
v_mfma_f32_16x16x32_bf16 v[76:79], v[172:175], a[0:3], 0
ds_read_b128 v[196:199], v252 offset:18432
v_mfma_f32_16x16x32_bf16 v[76:79], v[176:179], a[4:7], v[76:79]
v_cvt_pk_bf16_f32 v92, v68, v69
v_cvt_pk_bf16_f32 v93, v70, v71
v_mfma_f32_16x16x32_bf16 v[76:79], v[180:183], a[8:11], v[76:79]
ds_read_b128 v[200:203], v252 offset:19456
v_mfma_f32_16x16x32_bf16 v[76:79], v[184:187], a[12:15], v[76:79]
v_mfma_f32_16x16x32_bf16 v[76:79], v[188:191], a[16:19], v[76:79]
ds_read_b128 v[204:207], v252 offset:20480
v_mfma_f32_16x16x32_bf16 v[76:79], v[192:195], a[20:23], v[76:79]
s_add_u32 m0, s18, 100096
v_mfma_f32_16x16x32_bf16 v[80:83], v[172:175], a[48:51], 0
ds_read_b128 v[208:211], v252 offset:21504
buffer_load_dwordx4 v110, s[4:7], s22 offen offset:256 nt lds
v_mfma_f32_16x16x32_bf16 v[80:83], v[176:179], a[52:55], v[80:83]
v_cvt_pk_bf16_f32 v96, v72, v73
v_cvt_pk_bf16_f32 v97, v74, v75
v_mfma_f32_16x16x32_bf16 v[80:83], v[180:183], a[56:59], v[80:83]
ds_read_b128 v[212:215], v252 offset:22528
v_mfma_f32_16x16x32_bf16 v[80:83], v[184:187], a[60:63], v[80:83]
v_mfma_f32_16x16x32_bf16 v[80:83], v[188:191], a[64:67], v[80:83]
ds_read_b128 v[216:219], v252 offset:23552
v_mfma_f32_16x16x32_bf16 v[80:83], v[192:195], a[68:71], v[80:83]
v_mfma_f32_16x16x32_bf16 v[84:87], v[172:175], a[96:99], 0
v_mfma_f32_16x16x32_bf16 v[84:87], v[176:179], a[100:103], v[84:87]
s_add_u32 m0, s18, 101120
v_mfma_f32_16x16x32_bf16 v[84:87], v[180:183], a[104:107], v[84:87]
buffer_load_dwordx4 v111, s[4:7], s22 offen offset:256 nt lds
v_mfma_f32_16x16x32_bf16 v[84:87], v[184:187], a[108:111], v[84:87]
v_mfma_f32_16x16x32_bf16 v[84:87], v[188:191], a[112:115], v[84:87]
v_mfma_f32_16x16x32_bf16 v[84:87], v[192:195], a[116:119], v[84:87]
s_waitcnt vmcnt(20) lgkmcnt(0)
s_barrier
v_add_u32 v252, 24576, v252
v_mfma_f32_16x16x32_bf16 v[76:79], v[196:199], a[24:27], v[76:79]
s_add_u32 m0, s17, 24576
s_mov_b32 s24, 221184
v_mfma_f32_16x16x32_bf16 v[76:79], v[200:203], a[28:31], v[76:79]
ds_read_b128 v[172:175], v252 offset:0
v_mfma_f32_16x16x32_bf16 v[76:79], v[204:207], a[32:35], v[76:79]
buffer_load_dwordx4 v251, s[12:15], s24 offen offset:0  lds
v_mfma_f32_16x16x32_bf16 v[76:79], v[208:211], a[36:39], v[76:79]
ds_read_b128 v[176:179], v252 offset:1024
v_mfma_f32_16x16x32_bf16 v[76:79], v[212:215], a[40:43], v[76:79]
v_mfma_f32_16x16x32_bf16 v[76:79], v[216:219], a[44:47], v[76:79]
ds_read_b128 v[180:183], v252 offset:2048
v_mfma_f32_16x16x32_bf16 v[80:83], v[196:199], a[72:75], v[80:83]
buffer_load_dwordx4 v251, s[12:15], s24 offen offset:1024  lds
v_mfma_f32_16x16x32_bf16 v[80:83], v[200:203], a[76:79], v[80:83]
ds_read_b128 v[184:187], v252 offset:3072
v_mfma_f32_16x16x32_bf16 v[80:83], v[204:207], a[80:83], v[80:83]
v_mfma_f32_16x16x32_bf16 v[80:83], v[208:211], a[84:87], v[80:83]
ds_read_b128 v[188:191], v252 offset:4096
v_mfma_f32_16x16x32_bf16 v[80:83], v[212:215], a[88:91], v[80:83]
buffer_load_dwordx4 v251, s[12:15], s24 offen offset:2048  lds
v_mfma_f32_16x16x32_bf16 v[80:83], v[216:219], a[92:95], v[80:83]
ds_read_b128 v[192:195], v252 offset:5120
v_mfma_f32_16x16x32_bf16 v[84:87], v[196:199], a[120:123], v[84:87]
v_mfma_f32_16x16x32_bf16 v[84:87], v[200:203], a[124:127], v[84:87]
v_cvt_pk_bf16_f32 v90, v76, v77
v_cvt_pk_bf16_f32 v91, v78, v79
v_mfma_f32_16x16x32_bf16 v[84:87], v[204:207], a[128:131], v[84:87]
buffer_load_dwordx4 v251, s[12:15], s24 offen offset:3072  lds
v_mfma_f32_16x16x32_bf16 v[84:87], v[208:211], a[132:135], v[84:87]
v_mfma_f32_16x16x32_bf16 v[84:87], v[212:215], a[136:139], v[84:87]
s_add_u32 m0, s17, 28672
s_mov_b32 s24, 225280
v_mfma_f32_16x16x32_bf16 v[84:87], v[216:219], a[140:143], v[84:87]
s_waitcnt lgkmcnt(0)
v_mfma_f32_16x16x32_bf16 v[64:67], v[172:175], a[0:3], 0
buffer_load_dwordx4 v251, s[12:15], s24 offen offset:0  lds
ds_read_b128 v[196:199], v252 offset:6144
v_mfma_f32_16x16x32_bf16 v[64:67], v[176:179], a[4:7], v[64:67]
v_cvt_pk_bf16_f32 v94, v80, v81
v_cvt_pk_bf16_f32 v95, v82, v83
v_mfma_f32_16x16x32_bf16 v[64:67], v[180:183], a[8:11], v[64:67]
ds_read_b128 v[200:203], v252 offset:7168
v_mfma_f32_16x16x32_bf16 v[64:67], v[184:187], a[12:15], v[64:67]
v_mfma_f32_16x16x32_bf16 v[64:67], v[188:191], a[16:19], v[64:67]
buffer_load_dwordx4 v251, s[12:15], s24 offen offset:1024  lds
ds_read_b128 v[204:207], v252 offset:8192
v_mfma_f32_16x16x32_bf16 v[64:67], v[192:195], a[20:23], v[64:67]
v_mfma_f32_16x16x32_bf16 v[68:71], v[172:175], a[48:51], 0
ds_read_b128 v[208:211], v252 offset:9216
v_mfma_f32_16x16x32_bf16 v[68:71], v[176:179], a[52:55], v[68:71]
v_cvt_pk_bf16_f32 v98, v84, v85
v_cvt_pk_bf16_f32 v99, v86, v87
v_mfma_f32_16x16x32_bf16 v[68:71], v[180:183], a[56:59], v[68:71]
ds_read_b128 v[212:215], v252 offset:10240
v_add_u32 v238, s19, v251
v_mfma_f32_16x16x32_bf16 v[68:71], v[184:187], a[60:63], v[68:71]
ds_read_b128 v[108:111], v238 offset:1024
v_mfma_f32_16x16x32_bf16 v[68:71], v[188:191], a[64:67], v[68:71]
ds_read_b128 v[216:219], v252 offset:11264
v_mfma_f32_16x16x32_bf16 v[68:71], v[192:195], a[68:71], v[68:71]
v_mfma_f32_16x16x32_bf16 v[72:75], v[172:175], a[96:99], 0
s_waitcnt vmcnt(22)
ds_read_b128 a[208:211], v237 offset:8192
v_mfma_f32_16x16x32_bf16 v[72:75], v[176:179], a[100:103], v[72:75]
v_mfma_f32_16x16x32_bf16 v[72:75], v[180:183], a[104:107], v[72:75]
v_xor_b32 v238, 64, v237
ds_read_b128 a[212:215], v238 offset:8192
v_mfma_f32_16x16x32_bf16 v[72:75], v[184:187], a[108:111], v[72:75]
v_mfma_f32_16x16x32_bf16 v[72:75], v[188:191], a[112:115], v[72:75]
v_xor_b32 v238, 128, v237
ds_read_b128 a[216:219], v238 offset:8192
v_mfma_f32_16x16x32_bf16 v[72:75], v[192:195], a[116:119], v[72:75]
v_mfma_f32_16x16x32_bf16 v[0:3], a[20:23], v[88:91], v[0:3]
v_xor_b32 v238, 192, v237
ds_read_b128 a[220:223], v238 offset:8192
v_mfma_f32_16x16x32_bf16 v[4:7], a[68:71], v[88:91], v[4:7]
v_mfma_f32_16x16x32_bf16 v[8:11], a[116:119], v[88:91], v[8:11]
v_mfma_f32_16x16x32_bf16 v[12:15], v[100:103], v[88:91], v[12:15]
v_mfma_f32_16x16x32_bf16 v[16:19], a[20:23], v[92:95], v[16:19]
v_mfma_f32_16x16x32_bf16 v[20:23], a[68:71], v[92:95], v[20:23]
v_mfma_f32_16x16x32_bf16 v[24:27], a[116:119], v[92:95], v[24:27]
v_mfma_f32_16x16x32_bf16 v[28:31], v[100:103], v[92:95], v[28:31]
v_mfma_f32_16x16x32_bf16 v[32:35], a[20:23], v[96:99], v[32:35]
v_mfma_f32_16x16x32_bf16 v[36:39], a[68:71], v[96:99], v[36:39]
v_mfma_f32_16x16x32_bf16 v[40:43], a[116:119], v[96:99], v[40:43]
v_mfma_f32_16x16x32_bf16 v[44:47], v[100:103], v[96:99], v[44:47]
s_waitcnt lgkmcnt(4)
v_mfma_f32_16x16x32_bf16 v[64:67], v[196:199], a[24:27], v[64:67]
ds_read_b128 v[172:175], v252 offset:12288
v_mfma_f32_16x16x32_bf16 v[64:67], v[200:203], a[28:31], v[64:67]
v_mfma_f32_16x16x32_bf16 v[64:67], v[204:207], a[32:35], v[64:67]
ds_read_b128 v[176:179], v252 offset:13312
v_mfma_f32_16x16x32_bf16 v[64:67], v[208:211], a[36:39], v[64:67]
v_mfma_f32_16x16x32_bf16 v[64:67], v[212:215], a[40:43], v[64:67]
ds_read_b128 v[180:183], v252 offset:14336
v_mfma_f32_16x16x32_bf16 v[64:67], v[216:219], a[44:47], v[64:67]
v_mfma_f32_16x16x32_bf16 v[68:71], v[196:199], a[72:75], v[68:71]
ds_read_b128 v[184:187], v252 offset:15360
v_mfma_f32_16x16x32_bf16 v[68:71], v[200:203], a[76:79], v[68:71]
s_add_u32 m0, s18, 102144
v_mfma_f32_16x16x32_bf16 v[68:71], v[204:207], a[80:83], v[68:71]
ds_read_b128 v[188:191], v252 offset:16384
buffer_load_dwordx4 v108, s[4:7], s22 offen offset:256 nt lds
v_mfma_f32_16x16x32_bf16 v[68:71], v[208:211], a[84:87], v[68:71]
v_mfma_f32_16x16x32_bf16 v[68:71], v[212:215], a[88:91], v[68:71]
ds_read_b128 v[192:195], v252 offset:17408
v_mfma_f32_16x16x32_bf16 v[68:71], v[216:219], a[92:95], v[68:71]
ds_read_b128 v[100:103], v253 offset:384
v_mfma_f32_16x16x32_bf16 v[72:75], v[196:199], a[120:123], v[72:75]
v_mfma_f32_16x16x32_bf16 v[72:75], v[200:203], a[124:127], v[72:75]
v_cvt_pk_bf16_f32 v88, v64, v65
v_cvt_pk_bf16_f32 v89, v66, v67
v_mfma_f32_16x16x32_bf16 v[72:75], v[204:207], a[128:131], v[72:75]
v_mfma_f32_16x16x32_bf16 v[72:75], v[208:211], a[132:135], v[72:75]
s_add_u32 m0, s18, 103168
v_mfma_f32_16x16x32_bf16 v[72:75], v[212:215], a[136:139], v[72:75]
buffer_load_dwordx4 v109, s[4:7], s22 offen offset:256 nt lds
v_mfma_f32_16x16x32_bf16 v[72:75], v[216:219], a[140:143], v[72:75]
s_waitcnt lgkmcnt(1)
v_mfma_f32_16x16x32_bf16 v[76:79], v[172:175], a[0:3], 0
ds_read_b128 v[196:199], v252 offset:18432
v_mfma_f32_16x16x32_bf16 v[76:79], v[176:179], a[4:7], v[76:79]
v_cvt_pk_bf16_f32 v92, v68, v69
v_cvt_pk_bf16_f32 v93, v70, v71
v_mfma_f32_16x16x32_bf16 v[76:79], v[180:183], a[8:11], v[76:79]
ds_read_b128 v[200:203], v252 offset:19456
v_mfma_f32_16x16x32_bf16 v[76:79], v[184:187], a[12:15], v[76:79]
v_mfma_f32_16x16x32_bf16 v[76:79], v[188:191], a[16:19], v[76:79]
ds_read_b128 v[204:207], v252 offset:20480
v_mfma_f32_16x16x32_bf16 v[76:79], v[192:195], a[20:23], v[76:79]
s_add_u32 m0, s18, 104192
v_mfma_f32_16x16x32_bf16 v[80:83], v[172:175], a[48:51], 0
ds_read_b128 v[208:211], v252 offset:21504
buffer_load_dwordx4 v110, s[4:7], s22 offen offset:256 nt lds
v_mfma_f32_16x16x32_bf16 v[80:83], v[176:179], a[52:55], v[80:83]
v_cvt_pk_bf16_f32 v96, v72, v73
v_cvt_pk_bf16_f32 v97, v74, v75
v_mfma_f32_16x16x32_bf16 v[80:83], v[180:183], a[56:59], v[80:83]
ds_read_b128 v[212:215], v252 offset:22528
v_mfma_f32_16x16x32_bf16 v[80:83], v[184:187], a[60:63], v[80:83]
v_mfma_f32_16x16x32_bf16 v[80:83], v[188:191], a[64:67], v[80:83]
ds_read_b128 v[216:219], v252 offset:23552
v_mfma_f32_16x16x32_bf16 v[80:83], v[192:195], a[68:71], v[80:83]
v_mfma_f32_16x16x32_bf16 v[84:87], v[172:175], a[96:99], 0
v_mfma_f32_16x16x32_bf16 v[84:87], v[176:179], a[100:103], v[84:87]
s_add_u32 m0, s18, 105216
v_mfma_f32_16x16x32_bf16 v[84:87], v[180:183], a[104:107], v[84:87]
buffer_load_dwordx4 v111, s[4:7], s22 offen offset:256 nt lds
v_mfma_f32_16x16x32_bf16 v[84:87], v[184:187], a[108:111], v[84:87]
v_mfma_f32_16x16x32_bf16 v[84:87], v[188:191], a[112:115], v[84:87]
v_mfma_f32_16x16x32_bf16 v[84:87], v[192:195], a[116:119], v[84:87]
s_waitcnt vmcnt(20) lgkmcnt(0)
s_barrier
v_add_u32 v252, 24576, v252
v_mfma_f32_16x16x32_bf16 v[76:79], v[196:199], a[24:27], v[76:79]
s_add_u32 m0, s17, 49152
s_mov_b32 s24, 245760
v_mfma_f32_16x16x32_bf16 v[76:79], v[200:203], a[28:31], v[76:79]
ds_read_b128 v[172:175], v252 offset:0
v_mfma_f32_16x16x32_bf16 v[76:79], v[204:207], a[32:35], v[76:79]
buffer_load_dwordx4 v251, s[12:15], s24 offen offset:0  lds
v_mfma_f32_16x16x32_bf16 v[76:79], v[208:211], a[36:39], v[76:79]
ds_read_b128 v[176:179], v252 offset:1024
v_mfma_f32_16x16x32_bf16 v[76:79], v[212:215], a[40:43], v[76:79]
v_mfma_f32_16x16x32_bf16 v[76:79], v[216:219], a[44:47], v[76:79]
ds_read_b128 v[180:183], v252 offset:2048
v_mfma_f32_16x16x32_bf16 v[80:83], v[196:199], a[72:75], v[80:83]
buffer_load_dwordx4 v251, s[12:15], s24 offen offset:1024  lds
v_mfma_f32_16x16x32_bf16 v[80:83], v[200:203], a[76:79], v[80:83]
ds_read_b128 v[184:187], v252 offset:3072
v_mfma_f32_16x16x32_bf16 v[80:83], v[204:207], a[80:83], v[80:83]
v_mfma_f32_16x16x32_bf16 v[80:83], v[208:211], a[84:87], v[80:83]
ds_read_b128 v[188:191], v252 offset:4096
v_mfma_f32_16x16x32_bf16 v[80:83], v[212:215], a[88:91], v[80:83]
buffer_load_dwordx4 v251, s[12:15], s24 offen offset:2048  lds
v_mfma_f32_16x16x32_bf16 v[80:83], v[216:219], a[92:95], v[80:83]
ds_read_b128 v[192:195], v252 offset:5120
v_mfma_f32_16x16x32_bf16 v[84:87], v[196:199], a[120:123], v[84:87]
v_mfma_f32_16x16x32_bf16 v[84:87], v[200:203], a[124:127], v[84:87]
v_cvt_pk_bf16_f32 v90, v76, v77
v_cvt_pk_bf16_f32 v91, v78, v79
v_mfma_f32_16x16x32_bf16 v[84:87], v[204:207], a[128:131], v[84:87]
buffer_load_dwordx4 v251, s[12:15], s24 offen offset:3072  lds
v_mfma_f32_16x16x32_bf16 v[84:87], v[208:211], a[132:135], v[84:87]
v_mfma_f32_16x16x32_bf16 v[84:87], v[212:215], a[136:139], v[84:87]
s_add_u32 m0, s17, 53248
s_mov_b32 s24, 249856
v_mfma_f32_16x16x32_bf16 v[84:87], v[216:219], a[140:143], v[84:87]
s_waitcnt lgkmcnt(0)
v_mfma_f32_16x16x32_bf16 v[64:67], v[172:175], a[0:3], 0
buffer_load_dwordx4 v251, s[12:15], s24 offen offset:0  lds
ds_read_b128 v[196:199], v252 offset:6144
v_mfma_f32_16x16x32_bf16 v[64:67], v[176:179], a[4:7], v[64:67]
v_cvt_pk_bf16_f32 v94, v80, v81
v_cvt_pk_bf16_f32 v95, v82, v83
v_mfma_f32_16x16x32_bf16 v[64:67], v[180:183], a[8:11], v[64:67]
ds_read_b128 v[200:203], v252 offset:7168
v_mfma_f32_16x16x32_bf16 v[64:67], v[184:187], a[12:15], v[64:67]
v_mfma_f32_16x16x32_bf16 v[64:67], v[188:191], a[16:19], v[64:67]
buffer_load_dwordx4 v251, s[12:15], s24 offen offset:1024  lds
ds_read_b128 v[204:207], v252 offset:8192
v_mfma_f32_16x16x32_bf16 v[64:67], v[192:195], a[20:23], v[64:67]
v_mfma_f32_16x16x32_bf16 v[68:71], v[172:175], a[48:51], 0
ds_read_b128 v[208:211], v252 offset:9216
v_mfma_f32_16x16x32_bf16 v[68:71], v[176:179], a[52:55], v[68:71]
v_cvt_pk_bf16_f32 v98, v84, v85
v_cvt_pk_bf16_f32 v99, v86, v87
v_mfma_f32_16x16x32_bf16 v[68:71], v[180:183], a[56:59], v[68:71]
ds_read_b128 v[212:215], v252 offset:10240
v_add_u32 v238, s19, v251
v_mfma_f32_16x16x32_bf16 v[68:71], v[184:187], a[60:63], v[68:71]
ds_read_b128 v[108:111], v238 offset:2048
v_mfma_f32_16x16x32_bf16 v[68:71], v[188:191], a[64:67], v[68:71]
ds_read_b128 v[216:219], v252 offset:11264
v_mfma_f32_16x16x32_bf16 v[68:71], v[192:195], a[68:71], v[68:71]
v_mfma_f32_16x16x32_bf16 v[72:75], v[172:175], a[96:99], 0
v_mfma_f32_16x16x32_bf16 v[72:75], v[176:179], a[100:103], v[72:75]
v_mfma_f32_16x16x32_bf16 v[72:75], v[180:183], a[104:107], v[72:75]
v_mfma_f32_16x16x32_bf16 v[72:75], v[184:187], a[108:111], v[72:75]
buffer_load_dwordx2 v[104:105], off, s[44:47], s39 sc1
v_mfma_f32_16x16x32_bf16 v[72:75], v[188:191], a[112:115], v[72:75]
v_mfma_f32_16x16x32_bf16 v[72:75], v[192:195], a[116:119], v[72:75]
v_mfma_f32_16x16x32_bf16 v[0:3], a[24:27], v[88:91], v[0:3]
v_mfma_f32_16x16x32_bf16 v[4:7], a[72:75], v[88:91], v[4:7]
v_mfma_f32_16x16x32_bf16 v[8:11], a[120:123], v[88:91], v[8:11]
v_mfma_f32_16x16x32_bf16 v[12:15], v[100:103], v[88:91], v[12:15]
v_mfma_f32_16x16x32_bf16 v[16:19], a[24:27], v[92:95], v[16:19]
v_mfma_f32_16x16x32_bf16 v[20:23], a[72:75], v[92:95], v[20:23]
v_mfma_f32_16x16x32_bf16 v[24:27], a[120:123], v[92:95], v[24:27]
v_mfma_f32_16x16x32_bf16 v[28:31], v[100:103], v[92:95], v[28:31]
v_mfma_f32_16x16x32_bf16 v[32:35], a[24:27], v[96:99], v[32:35]
v_mfma_f32_16x16x32_bf16 v[36:39], a[72:75], v[96:99], v[36:39]
v_mfma_f32_16x16x32_bf16 v[40:43], a[120:123], v[96:99], v[40:43]
v_mfma_f32_16x16x32_bf16 v[44:47], v[100:103], v[96:99], v[44:47]
s_waitcnt lgkmcnt(0)
v_mfma_f32_16x16x32_bf16 v[64:67], v[196:199], a[24:27], v[64:67]
ds_read_b128 v[172:175], v252 offset:12288
v_mfma_f32_16x16x32_bf16 v[64:67], v[200:203], a[28:31], v[64:67]
v_mfma_f32_16x16x32_bf16 v[64:67], v[204:207], a[32:35], v[64:67]
ds_read_b128 v[176:179], v252 offset:13312
v_mfma_f32_16x16x32_bf16 v[64:67], v[208:211], a[36:39], v[64:67]
v_mfma_f32_16x16x32_bf16 v[64:67], v[212:215], a[40:43], v[64:67]
ds_read_b128 v[180:183], v252 offset:14336
v_mfma_f32_16x16x32_bf16 v[64:67], v[216:219], a[44:47], v[64:67]
v_mfma_f32_16x16x32_bf16 v[68:71], v[196:199], a[72:75], v[68:71]
ds_read_b128 v[184:187], v252 offset:15360
v_mfma_f32_16x16x32_bf16 v[68:71], v[200:203], a[76:79], v[68:71]
s_add_u32 m0, s18, 106240
v_mfma_f32_16x16x32_bf16 v[68:71], v[204:207], a[80:83], v[68:71]
ds_read_b128 v[188:191], v252 offset:16384
buffer_load_dwordx4 v108, s[4:7], s22 offen offset:256 nt lds
v_mfma_f32_16x16x32_bf16 v[68:71], v[208:211], a[84:87], v[68:71]
v_mfma_f32_16x16x32_bf16 v[68:71], v[212:215], a[88:91], v[68:71]
ds_read_b128 v[192:195], v252 offset:17408
v_mfma_f32_16x16x32_bf16 v[68:71], v[216:219], a[92:95], v[68:71]
ds_read_b128 v[100:103], v253 offset:448
v_mfma_f32_16x16x32_bf16 v[72:75], v[196:199], a[120:123], v[72:75]
v_mfma_f32_16x16x32_bf16 v[72:75], v[200:203], a[124:127], v[72:75]
v_cvt_pk_bf16_f32 v88, v64, v65
v_cvt_pk_bf16_f32 v89, v66, v67
v_mfma_f32_16x16x32_bf16 v[72:75], v[204:207], a[128:131], v[72:75]
v_mfma_f32_16x16x32_bf16 v[72:75], v[208:211], a[132:135], v[72:75]
s_add_u32 m0, s18, 107264
v_mfma_f32_16x16x32_bf16 v[72:75], v[212:215], a[136:139], v[72:75]
buffer_load_dwordx4 v109, s[4:7], s22 offen offset:256 nt lds
v_mfma_f32_16x16x32_bf16 v[72:75], v[216:219], a[140:143], v[72:75]
s_waitcnt lgkmcnt(1)
v_mfma_f32_16x16x32_bf16 v[76:79], v[172:175], a[0:3], 0
ds_read_b128 v[196:199], v252 offset:18432
v_mfma_f32_16x16x32_bf16 v[76:79], v[176:179], a[4:7], v[76:79]
v_cvt_pk_bf16_f32 v92, v68, v69
v_cvt_pk_bf16_f32 v93, v70, v71
v_mfma_f32_16x16x32_bf16 v[76:79], v[180:183], a[8:11], v[76:79]
ds_read_b128 v[200:203], v252 offset:19456
v_mfma_f32_16x16x32_bf16 v[76:79], v[184:187], a[12:15], v[76:79]
v_mfma_f32_16x16x32_bf16 v[76:79], v[188:191], a[16:19], v[76:79]
ds_read_b128 v[204:207], v252 offset:20480
v_mfma_f32_16x16x32_bf16 v[76:79], v[192:195], a[20:23], v[76:79]
s_add_u32 m0, s18, 108288
v_mfma_f32_16x16x32_bf16 v[80:83], v[172:175], a[48:51], 0
ds_read_b128 v[208:211], v252 offset:21504
buffer_load_dwordx4 v110, s[4:7], s22 offen offset:256 nt lds
v_mfma_f32_16x16x32_bf16 v[80:83], v[176:179], a[52:55], v[80:83]
v_cvt_pk_bf16_f32 v96, v72, v73
v_cvt_pk_bf16_f32 v97, v74, v75
v_mfma_f32_16x16x32_bf16 v[80:83], v[180:183], a[56:59], v[80:83]
ds_read_b128 v[212:215], v252 offset:22528
v_mfma_f32_16x16x32_bf16 v[80:83], v[184:187], a[60:63], v[80:83]
v_mfma_f32_16x16x32_bf16 v[80:83], v[188:191], a[64:67], v[80:83]
ds_read_b128 v[216:219], v252 offset:23552
v_mfma_f32_16x16x32_bf16 v[80:83], v[192:195], a[68:71], v[80:83]
v_mfma_f32_16x16x32_bf16 v[84:87], v[172:175], a[96:99], 0
v_mfma_f32_16x16x32_bf16 v[84:87], v[176:179], a[100:103], v[84:87]
s_add_u32 m0, s18, 109312
v_mfma_f32_16x16x32_bf16 v[84:87], v[180:183], a[104:107], v[84:87]
buffer_load_dwordx4 v111, s[4:7], s22 offen offset:256 nt lds
v_mfma_f32_16x16x32_bf16 v[84:87], v[184:187], a[108:111], v[84:87]
v_mfma_f32_16x16x32_bf16 v[84:87], v[188:191], a[112:115], v[84:87]
v_mfma_f32_16x16x32_bf16 v[84:87], v[192:195], a[116:119], v[84:87]
s_waitcnt vmcnt(25) lgkmcnt(0)
s_barrier
v_add_u32 v252, 4294893568, v252
v_mfma_f32_16x16x32_bf16 v[76:79], v[196:199], a[24:27], v[76:79]
s_add_u32 m0, s17, 73728
s_mov_b32 s24, 270336
v_mfma_f32_16x16x32_bf16 v[76:79], v[200:203], a[28:31], v[76:79]
ds_read_b128 v[172:175], v252 offset:0
v_mfma_f32_16x16x32_bf16 v[76:79], v[204:207], a[32:35], v[76:79]
buffer_load_dwordx4 v251, s[12:15], s24 offen offset:0  lds
v_mfma_f32_16x16x32_bf16 v[76:79], v[208:211], a[36:39], v[76:79]
ds_read_b128 v[176:179], v252 offset:1024
v_mfma_f32_16x16x32_bf16 v[76:79], v[212:215], a[40:43], v[76:79]
v_mfma_f32_16x16x32_bf16 v[76:79], v[216:219], a[44:47], v[76:79]
ds_read_b128 v[180:183], v252 offset:2048
v_mfma_f32_16x16x32_bf16 v[80:83], v[196:199], a[72:75], v[80:83]
buffer_load_dwordx4 v251, s[12:15], s24 offen offset:1024  lds
v_mfma_f32_16x16x32_bf16 v[80:83], v[200:203], a[76:79], v[80:83]
ds_read_b128 v[184:187], v252 offset:3072
v_mfma_f32_16x16x32_bf16 v[80:83], v[204:207], a[80:83], v[80:83]
v_mfma_f32_16x16x32_bf16 v[80:83], v[208:211], a[84:87], v[80:83]
ds_read_b128 v[188:191], v252 offset:4096
v_mfma_f32_16x16x32_bf16 v[80:83], v[212:215], a[88:91], v[80:83]
buffer_load_dwordx4 v251, s[12:15], s24 offen offset:2048  lds
v_mfma_f32_16x16x32_bf16 v[80:83], v[216:219], a[92:95], v[80:83]
ds_read_b128 v[192:195], v252 offset:5120
v_mfma_f32_16x16x32_bf16 v[84:87], v[196:199], a[120:123], v[84:87]
v_mfma_f32_16x16x32_bf16 v[84:87], v[200:203], a[124:127], v[84:87]
v_cvt_pk_bf16_f32 v90, v76, v77
v_cvt_pk_bf16_f32 v91, v78, v79
v_mfma_f32_16x16x32_bf16 v[84:87], v[204:207], a[128:131], v[84:87]
buffer_load_dwordx4 v251, s[12:15], s24 offen offset:3072  lds
v_mfma_f32_16x16x32_bf16 v[84:87], v[208:211], a[132:135], v[84:87]
v_mfma_f32_16x16x32_bf16 v[84:87], v[212:215], a[136:139], v[84:87]
s_add_u32 m0, s17, 77824
s_mov_b32 s24, 274432
v_mfma_f32_16x16x32_bf16 v[84:87], v[216:219], a[140:143], v[84:87]
s_waitcnt lgkmcnt(0)
v_mfma_f32_16x16x32_bf16 v[64:67], v[172:175], a[0:3], 0
buffer_load_dwordx4 v251, s[12:15], s24 offen offset:0  lds
ds_read_b128 v[196:199], v252 offset:6144
v_mfma_f32_16x16x32_bf16 v[64:67], v[176:179], a[4:7], v[64:67]
v_cvt_pk_bf16_f32 v94, v80, v81
v_cvt_pk_bf16_f32 v95, v82, v83
v_mfma_f32_16x16x32_bf16 v[64:67], v[180:183], a[8:11], v[64:67]
ds_read_b128 v[200:203], v252 offset:7168
v_mfma_f32_16x16x32_bf16 v[64:67], v[184:187], a[12:15], v[64:67]
v_mfma_f32_16x16x32_bf16 v[64:67], v[188:191], a[16:19], v[64:67]
buffer_load_dwordx4 v251, s[12:15], s24 offen offset:1024  lds
ds_read_b128 v[204:207], v252 offset:8192
v_mfma_f32_16x16x32_bf16 v[64:67], v[192:195], a[20:23], v[64:67]
v_mfma_f32_16x16x32_bf16 v[68:71], v[172:175], a[48:51], 0
ds_read_b128 v[208:211], v252 offset:9216
v_mfma_f32_16x16x32_bf16 v[68:71], v[176:179], a[52:55], v[68:71]
v_cvt_pk_bf16_f32 v98, v84, v85
v_cvt_pk_bf16_f32 v99, v86, v87
v_mfma_f32_16x16x32_bf16 v[68:71], v[180:183], a[56:59], v[68:71]
ds_read_b128 v[212:215], v252 offset:10240
v_mfma_f32_16x16x32_bf16 v[68:71], v[184:187], a[60:63], v[68:71]
v_mfma_f32_16x16x32_bf16 v[68:71], v[188:191], a[64:67], v[68:71]
ds_read_b128 v[216:219], v252 offset:11264
v_mfma_f32_16x16x32_bf16 v[68:71], v[192:195], a[68:71], v[68:71]
v_mfma_f32_16x16x32_bf16 v[72:75], v[172:175], a[96:99], 0
s_waitcnt vmcnt(27)
ds_read_b128 a[160:163], v237 offset:0
v_mfma_f32_16x16x32_bf16 v[72:75], v[176:179], a[100:103], v[72:75]
v_mfma_f32_16x16x32_bf16 v[72:75], v[180:183], a[104:107], v[72:75]
v_xor_b32 v238, 64, v237
ds_read_b128 a[164:167], v238 offset:0
v_mfma_f32_16x16x32_bf16 v[72:75], v[184:187], a[108:111], v[72:75]
v_mfma_f32_16x16x32_bf16 v[72:75], v[188:191], a[112:115], v[72:75]
v_xor_b32 v238, 128, v237
ds_read_b128 a[168:171], v238 offset:0
v_mfma_f32_16x16x32_bf16 v[72:75], v[192:195], a[116:119], v[72:75]
v_mfma_f32_16x16x32_bf16 v[0:3], a[28:31], v[88:91], v[0:3]
v_xor_b32 v238, 192, v237
ds_read_b128 a[172:175], v238 offset:0
v_mfma_f32_16x16x32_bf16 v[4:7], a[76:79], v[88:91], v[4:7]
v_mfma_f32_16x16x32_bf16 v[8:11], a[124:127], v[88:91], v[8:11]
v_mfma_f32_16x16x32_bf16 v[12:15], v[100:103], v[88:91], v[12:15]
v_mfma_f32_16x16x32_bf16 v[16:19], a[28:31], v[92:95], v[16:19]
v_mfma_f32_16x16x32_bf16 v[20:23], a[76:79], v[92:95], v[20:23]
v_mfma_f32_16x16x32_bf16 v[24:27], a[124:127], v[92:95], v[24:27]
v_mfma_f32_16x16x32_bf16 v[28:31], v[100:103], v[92:95], v[28:31]
v_mfma_f32_16x16x32_bf16 v[32:35], a[28:31], v[96:99], v[32:35]
v_mfma_f32_16x16x32_bf16 v[36:39], a[76:79], v[96:99], v[36:39]
v_mfma_f32_16x16x32_bf16 v[40:43], a[124:127], v[96:99], v[40:43]
v_mfma_f32_16x16x32_bf16 v[44:47], v[100:103], v[96:99], v[44:47]
s_waitcnt lgkmcnt(4)
v_mfma_f32_16x16x32_bf16 v[64:67], v[196:199], a[24:27], v[64:67]
ds_read_b128 v[172:175], v252 offset:12288
v_mfma_f32_16x16x32_bf16 v[64:67], v[200:203], a[28:31], v[64:67]
v_mfma_f32_16x16x32_bf16 v[64:67], v[204:207], a[32:35], v[64:67]
ds_read_b128 v[176:179], v252 offset:13312
v_mfma_f32_16x16x32_bf16 v[64:67], v[208:211], a[36:39], v[64:67]
v_mfma_f32_16x16x32_bf16 v[64:67], v[212:215], a[40:43], v[64:67]
ds_read_b128 v[180:183], v252 offset:14336
v_mfma_f32_16x16x32_bf16 v[64:67], v[216:219], a[44:47], v[64:67]
v_mfma_f32_16x16x32_bf16 v[68:71], v[196:199], a[72:75], v[68:71]
ds_read_b128 v[184:187], v252 offset:15360
v_mfma_f32_16x16x32_bf16 v[68:71], v[200:203], a[76:79], v[68:71]
v_mfma_f32_16x16x32_bf16 v[68:71], v[204:207], a[80:83], v[68:71]
ds_read_b128 v[188:191], v252 offset:16384
v_mfma_f32_16x16x32_bf16 v[68:71], v[208:211], a[84:87], v[68:71]
v_mfma_f32_16x16x32_bf16 v[68:71], v[212:215], a[88:91], v[68:71]
ds_read_b128 v[192:195], v252 offset:17408
v_mfma_f32_16x16x32_bf16 v[68:71], v[216:219], a[92:95], v[68:71]
ds_read_b128 v[100:103], v253 offset:512
v_mfma_f32_16x16x32_bf16 v[72:75], v[196:199], a[120:123], v[72:75]
v_mfma_f32_16x16x32_bf16 v[72:75], v[200:203], a[124:127], v[72:75]
v_cvt_pk_bf16_f32 v88, v64, v65
v_cvt_pk_bf16_f32 v89, v66, v67
v_mfma_f32_16x16x32_bf16 v[72:75], v[204:207], a[128:131], v[72:75]
v_mfma_f32_16x16x32_bf16 v[72:75], v[208:211], a[132:135], v[72:75]
v_mfma_f32_16x16x32_bf16 v[72:75], v[212:215], a[136:139], v[72:75]
v_mfma_f32_16x16x32_bf16 v[72:75], v[216:219], a[140:143], v[72:75]
s_waitcnt lgkmcnt(1)
v_mfma_f32_16x16x32_bf16 v[76:79], v[172:175], a[0:3], 0
ds_read_b128 v[196:199], v252 offset:18432
v_mfma_f32_16x16x32_bf16 v[76:79], v[176:179], a[4:7], v[76:79]
v_cvt_pk_bf16_f32 v92, v68, v69
v_cvt_pk_bf16_f32 v93, v70, v71
v_mfma_f32_16x16x32_bf16 v[76:79], v[180:183], a[8:11], v[76:79]
ds_read_b128 v[200:203], v252 offset:19456
v_mfma_f32_16x16x32_bf16 v[76:79], v[184:187], a[12:15], v[76:79]
v_mfma_f32_16x16x32_bf16 v[76:79], v[188:191], a[16:19], v[76:79]
ds_read_b128 v[204:207], v252 offset:20480
v_mfma_f32_16x16x32_bf16 v[76:79], v[192:195], a[20:23], v[76:79]
v_mfma_f32_16x16x32_bf16 v[80:83], v[172:175], a[48:51], 0
ds_read_b128 v[208:211], v252 offset:21504
v_mfma_f32_16x16x32_bf16 v[80:83], v[176:179], a[52:55], v[80:83]
v_cvt_pk_bf16_f32 v96, v72, v73
v_cvt_pk_bf16_f32 v97, v74, v75
v_mfma_f32_16x16x32_bf16 v[80:83], v[180:183], a[56:59], v[80:83]
ds_read_b128 v[212:215], v252 offset:22528
v_mfma_f32_16x16x32_bf16 v[80:83], v[184:187], a[60:63], v[80:83]
v_mfma_f32_16x16x32_bf16 v[80:83], v[188:191], a[64:67], v[80:83]
ds_read_b128 v[216:219], v252 offset:23552
v_mfma_f32_16x16x32_bf16 v[80:83], v[192:195], a[68:71], v[80:83]
v_mfma_f32_16x16x32_bf16 v[84:87], v[172:175], a[96:99], 0
v_mfma_f32_16x16x32_bf16 v[84:87], v[176:179], a[100:103], v[84:87]
v_mfma_f32_16x16x32_bf16 v[84:87], v[180:183], a[104:107], v[84:87]
v_mfma_f32_16x16x32_bf16 v[84:87], v[184:187], a[108:111], v[84:87]
v_mfma_f32_16x16x32_bf16 v[84:87], v[188:191], a[112:115], v[84:87]
v_mfma_f32_16x16x32_bf16 v[84:87], v[192:195], a[116:119], v[84:87]
s_waitcnt vmcnt(21) lgkmcnt(0)
s_barrier
v_add_u32 v252, 24576, v252
v_mfma_f32_16x16x32_bf16 v[76:79], v[196:199], a[24:27], v[76:79]
s_add_u32 m0, s17, 0
s_mov_b32 s24, 294912
v_mfma_f32_16x16x32_bf16 v[76:79], v[200:203], a[28:31], v[76:79]
ds_read_b128 v[172:175], v252 offset:0
v_mfma_f32_16x16x32_bf16 v[76:79], v[204:207], a[32:35], v[76:79]
buffer_load_dwordx4 v251, s[12:15], s24 offen offset:0  lds
v_mfma_f32_16x16x32_bf16 v[76:79], v[208:211], a[36:39], v[76:79]
ds_read_b128 v[176:179], v252 offset:1024
v_mfma_f32_16x16x32_bf16 v[76:79], v[212:215], a[40:43], v[76:79]
v_mfma_f32_16x16x32_bf16 v[76:79], v[216:219], a[44:47], v[76:79]
ds_read_b128 v[180:183], v252 offset:2048
v_mfma_f32_16x16x32_bf16 v[80:83], v[196:199], a[72:75], v[80:83]
buffer_load_dwordx4 v251, s[12:15], s24 offen offset:1024  lds
v_mfma_f32_16x16x32_bf16 v[80:83], v[200:203], a[76:79], v[80:83]
ds_read_b128 v[184:187], v252 offset:3072
v_mfma_f32_16x16x32_bf16 v[80:83], v[204:207], a[80:83], v[80:83]
v_mfma_f32_16x16x32_bf16 v[80:83], v[208:211], a[84:87], v[80:83]
ds_read_b128 v[188:191], v252 offset:4096
v_mfma_f32_16x16x32_bf16 v[80:83], v[212:215], a[88:91], v[80:83]
buffer_load_dwordx4 v251, s[12:15], s24 offen offset:2048  lds
v_mfma_f32_16x16x32_bf16 v[80:83], v[216:219], a[92:95], v[80:83]
ds_read_b128 v[192:195], v252 offset:5120
v_mfma_f32_16x16x32_bf16 v[84:87], v[196:199], a[120:123], v[84:87]
v_mfma_f32_16x16x32_bf16 v[84:87], v[200:203], a[124:127], v[84:87]
v_cvt_pk_bf16_f32 v90, v76, v77
v_cvt_pk_bf16_f32 v91, v78, v79
v_mfma_f32_16x16x32_bf16 v[84:87], v[204:207], a[128:131], v[84:87]
buffer_load_dwordx4 v251, s[12:15], s24 offen offset:3072  lds
v_mfma_f32_16x16x32_bf16 v[84:87], v[208:211], a[132:135], v[84:87]
v_mfma_f32_16x16x32_bf16 v[84:87], v[212:215], a[136:139], v[84:87]
s_add_u32 m0, s17, 4096
s_mov_b32 s24, 299008
v_mfma_f32_16x16x32_bf16 v[84:87], v[216:219], a[140:143], v[84:87]
s_waitcnt lgkmcnt(0)
v_mfma_f32_16x16x32_bf16 v[64:67], v[172:175], a[0:3], 0
buffer_load_dwordx4 v251, s[12:15], s24 offen offset:0  lds
ds_read_b128 v[196:199], v252 offset:6144
v_mfma_f32_16x16x32_bf16 v[64:67], v[176:179], a[4:7], v[64:67]
v_cvt_pk_bf16_f32 v94, v80, v81
v_cvt_pk_bf16_f32 v95, v82, v83
v_mfma_f32_16x16x32_bf16 v[64:67], v[180:183], a[8:11], v[64:67]
ds_read_b128 v[200:203], v252 offset:7168
v_mfma_f32_16x16x32_bf16 v[64:67], v[184:187], a[12:15], v[64:67]
v_mfma_f32_16x16x32_bf16 v[64:67], v[188:191], a[16:19], v[64:67]
buffer_load_dwordx4 v251, s[12:15], s24 offen offset:1024  lds
ds_read_b128 v[204:207], v252 offset:8192
v_mfma_f32_16x16x32_bf16 v[64:67], v[192:195], a[20:23], v[64:67]
v_mfma_f32_16x16x32_bf16 v[68:71], v[172:175], a[48:51], 0
ds_read_b128 v[208:211], v252 offset:9216
v_mfma_f32_16x16x32_bf16 v[68:71], v[176:179], a[52:55], v[68:71]
v_cvt_pk_bf16_f32 v98, v84, v85
v_cvt_pk_bf16_f32 v99, v86, v87
v_mfma_f32_16x16x32_bf16 v[68:71], v[180:183], a[56:59], v[68:71]
ds_read_b128 v[212:215], v252 offset:10240
v_add_u32 v238, s19, v251
v_mfma_f32_16x16x32_bf16 v[68:71], v[184:187], a[60:63], v[68:71]
ds_read_b128 v[108:111], v238 offset:0
v_mfma_f32_16x16x32_bf16 v[68:71], v[188:191], a[64:67], v[68:71]
ds_read_b128 v[216:219], v252 offset:11264
v_mfma_f32_16x16x32_bf16 v[68:71], v[192:195], a[68:71], v[68:71]
v_mfma_f32_16x16x32_bf16 v[72:75], v[172:175], a[96:99], 0
s_waitcnt vmcnt(23)
ds_read_b128 a[192:195], v237 offset:4096
v_mfma_f32_16x16x32_bf16 v[72:75], v[176:179], a[100:103], v[72:75]
v_mfma_f32_16x16x32_bf16 v[72:75], v[180:183], a[104:107], v[72:75]
v_xor_b32 v238, 64, v237
ds_read_b128 a[196:199], v238 offset:4096
v_mfma_f32_16x16x32_bf16 v[72:75], v[184:187], a[108:111], v[72:75]
v_mfma_f32_16x16x32_bf16 v[72:75], v[188:191], a[112:115], v[72:75]
v_xor_b32 v238, 128, v237
ds_read_b128 a[200:203], v238 offset:4096
v_mfma_f32_16x16x32_bf16 v[72:75], v[192:195], a[116:119], v[72:75]
v_mfma_f32_16x16x32_bf16 v[0:3], a[32:35], v[88:91], v[0:3]
v_xor_b32 v238, 192, v237
ds_read_b128 a[204:207], v238 offset:4096
v_mfma_f32_16x16x32_bf16 v[4:7], a[80:83], v[88:91], v[4:7]
v_mfma_f32_16x16x32_bf16 v[8:11], a[128:131], v[88:91], v[8:11]
v_mfma_f32_16x16x32_bf16 v[12:15], v[100:103], v[88:91], v[12:15]
v_mfma_f32_16x16x32_bf16 v[16:19], a[32:35], v[92:95], v[16:19]
v_mfma_f32_16x16x32_bf16 v[20:23], a[80:83], v[92:95], v[20:23]
v_mfma_f32_16x16x32_bf16 v[24:27], a[128:131], v[92:95], v[24:27]
v_mfma_f32_16x16x32_bf16 v[28:31], v[100:103], v[92:95], v[28:31]
v_mfma_f32_16x16x32_bf16 v[32:35], a[32:35], v[96:99], v[32:35]
v_mfma_f32_16x16x32_bf16 v[36:39], a[80:83], v[96:99], v[36:39]
v_mfma_f32_16x16x32_bf16 v[40:43], a[128:131], v[96:99], v[40:43]
v_mfma_f32_16x16x32_bf16 v[44:47], v[100:103], v[96:99], v[44:47]
s_waitcnt lgkmcnt(4)
v_mfma_f32_16x16x32_bf16 v[64:67], v[196:199], a[24:27], v[64:67]
ds_read_b128 v[172:175], v252 offset:12288
v_mfma_f32_16x16x32_bf16 v[64:67], v[200:203], a[28:31], v[64:67]
v_mfma_f32_16x16x32_bf16 v[64:67], v[204:207], a[32:35], v[64:67]
ds_read_b128 v[176:179], v252 offset:13312
v_mfma_f32_16x16x32_bf16 v[64:67], v[208:211], a[36:39], v[64:67]
v_mfma_f32_16x16x32_bf16 v[64:67], v[212:215], a[40:43], v[64:67]
ds_read_b128 v[180:183], v252 offset:14336
v_mfma_f32_16x16x32_bf16 v[64:67], v[216:219], a[44:47], v[64:67]
v_mfma_f32_16x16x32_bf16 v[68:71], v[196:199], a[72:75], v[68:71]
ds_read_b128 v[184:187], v252 offset:15360
v_mfma_f32_16x16x32_bf16 v[68:71], v[200:203], a[76:79], v[68:71]
s_add_u32 m0, s18, 97792
v_mfma_f32_16x16x32_bf16 v[68:71], v[204:207], a[80:83], v[68:71]
ds_read_b128 v[188:191], v252 offset:16384
buffer_load_dwordx4 v108, s[4:7], s22 offen offset:512 nt lds
v_mfma_f32_16x16x32_bf16 v[68:71], v[208:211], a[84:87], v[68:71]
v_mfma_f32_16x16x32_bf16 v[68:71], v[212:215], a[88:91], v[68:71]
ds_read_b128 v[192:195], v252 offset:17408
v_mfma_f32_16x16x32_bf16 v[68:71], v[216:219], a[92:95], v[68:71]
ds_read_b128 v[100:103], v253 offset:576
v_mfma_f32_16x16x32_bf16 v[72:75], v[196:199], a[120:123], v[72:75]
v_mfma_f32_16x16x32_bf16 v[72:75], v[200:203], a[124:127], v[72:75]
v_cvt_pk_bf16_f32 v88, v64, v65
v_cvt_pk_bf16_f32 v89, v66, v67
v_mfma_f32_16x16x32_bf16 v[72:75], v[204:207], a[128:131], v[72:75]
v_mfma_f32_16x16x32_bf16 v[72:75], v[208:211], a[132:135], v[72:75]
s_add_u32 m0, s18, 98816
v_mfma_f32_16x16x32_bf16 v[72:75], v[212:215], a[136:139], v[72:75]
buffer_load_dwordx4 v109, s[4:7], s22 offen offset:512 nt lds
v_mfma_f32_16x16x32_bf16 v[72:75], v[216:219], a[140:143], v[72:75]
s_waitcnt lgkmcnt(1)
v_mfma_f32_16x16x32_bf16 v[76:79], v[172:175], a[0:3], 0
ds_read_b128 v[196:199], v252 offset:18432
v_mfma_f32_16x16x32_bf16 v[76:79], v[176:179], a[4:7], v[76:79]
v_cvt_pk_bf16_f32 v92, v68, v69
v_cvt_pk_bf16_f32 v93, v70, v71
v_mfma_f32_16x16x32_bf16 v[76:79], v[180:183], a[8:11], v[76:79]
ds_read_b128 v[200:203], v252 offset:19456
v_mfma_f32_16x16x32_bf16 v[76:79], v[184:187], a[12:15], v[76:79]
v_mfma_f32_16x16x32_bf16 v[76:79], v[188:191], a[16:19], v[76:79]
ds_read_b128 v[204:207], v252 offset:20480
v_mfma_f32_16x16x32_bf16 v[76:79], v[192:195], a[20:23], v[76:79]
s_add_u32 m0, s18, 99840
v_mfma_f32_16x16x32_bf16 v[80:83], v[172:175], a[48:51], 0
ds_read_b128 v[208:211], v252 offset:21504
buffer_load_dwordx4 v110, s[4:7], s22 offen offset:512 nt lds
v_mfma_f32_16x16x32_bf16 v[80:83], v[176:179], a[52:55], v[80:83]
v_cvt_pk_bf16_f32 v96, v72, v73
v_cvt_pk_bf16_f32 v97, v74, v75
v_mfma_f32_16x16x32_bf16 v[80:83], v[180:183], a[56:59], v[80:83]
ds_read_b128 v[212:215], v252 offset:22528
v_mfma_f32_16x16x32_bf16 v[80:83], v[184:187], a[60:63], v[80:83]
v_mfma_f32_16x16x32_bf16 v[80:83], v[188:191], a[64:67], v[80:83]
ds_read_b128 v[216:219], v252 offset:23552
v_mfma_f32_16x16x32_bf16 v[80:83], v[192:195], a[68:71], v[80:83]
v_mfma_f32_16x16x32_bf16 v[84:87], v[172:175], a[96:99], 0
v_mfma_f32_16x16x32_bf16 v[84:87], v[176:179], a[100:103], v[84:87]
s_add_u32 m0, s18, 100864
v_mfma_f32_16x16x32_bf16 v[84:87], v[180:183], a[104:107], v[84:87]
buffer_load_dwordx4 v111, s[4:7], s22 offen offset:512 nt lds
v_mfma_f32_16x16x32_bf16 v[84:87], v[184:187], a[108:111], v[84:87]
v_mfma_f32_16x16x32_bf16 v[84:87], v[188:191], a[112:115], v[84:87]
v_mfma_f32_16x16x32_bf16 v[84:87], v[192:195], a[116:119], v[84:87]
s_waitcnt vmcnt(21) lgkmcnt(0)
s_barrier
v_add_u32 v252, 24576, v252
v_mfma_f32_16x16x32_bf16 v[76:79], v[196:199], a[24:27], v[76:79]
s_add_u32 m0, s17, 24576
s_mov_b32 s24, 319488
v_mfma_f32_16x16x32_bf16 v[76:79], v[200:203], a[28:31], v[76:79]
ds_read_b128 v[172:175], v252 offset:0
v_mfma_f32_16x16x32_bf16 v[76:79], v[204:207], a[32:35], v[76:79]
buffer_load_dwordx4 v251, s[12:15], s24 offen offset:0  lds
v_mfma_f32_16x16x32_bf16 v[76:79], v[208:211], a[36:39], v[76:79]
ds_read_b128 v[176:179], v252 offset:1024
v_mfma_f32_16x16x32_bf16 v[76:79], v[212:215], a[40:43], v[76:79]
v_mfma_f32_16x16x32_bf16 v[76:79], v[216:219], a[44:47], v[76:79]
ds_read_b128 v[180:183], v252 offset:2048
v_mfma_f32_16x16x32_bf16 v[80:83], v[196:199], a[72:75], v[80:83]
buffer_load_dwordx4 v251, s[12:15], s24 offen offset:1024  lds
v_mfma_f32_16x16x32_bf16 v[80:83], v[200:203], a[76:79], v[80:83]
ds_read_b128 v[184:187], v252 offset:3072
v_mfma_f32_16x16x32_bf16 v[80:83], v[204:207], a[80:83], v[80:83]
v_mfma_f32_16x16x32_bf16 v[80:83], v[208:211], a[84:87], v[80:83]
ds_read_b128 v[188:191], v252 offset:4096
v_mfma_f32_16x16x32_bf16 v[80:83], v[212:215], a[88:91], v[80:83]
buffer_load_dwordx4 v251, s[12:15], s24 offen offset:2048  lds
v_mfma_f32_16x16x32_bf16 v[80:83], v[216:219], a[92:95], v[80:83]
ds_read_b128 v[192:195], v252 offset:5120
v_mfma_f32_16x16x32_bf16 v[84:87], v[196:199], a[120:123], v[84:87]
v_mfma_f32_16x16x32_bf16 v[84:87], v[200:203], a[124:127], v[84:87]
v_cvt_pk_bf16_f32 v90, v76, v77
v_cvt_pk_bf16_f32 v91, v78, v79
v_mfma_f32_16x16x32_bf16 v[84:87], v[204:207], a[128:131], v[84:87]
buffer_load_dwordx4 v251, s[12:15], s24 offen offset:3072  lds
v_mfma_f32_16x16x32_bf16 v[84:87], v[208:211], a[132:135], v[84:87]
v_mfma_f32_16x16x32_bf16 v[84:87], v[212:215], a[136:139], v[84:87]
s_add_u32 m0, s17, 28672
s_mov_b32 s24, 323584
v_mfma_f32_16x16x32_bf16 v[84:87], v[216:219], a[140:143], v[84:87]
s_waitcnt lgkmcnt(0)
v_mfma_f32_16x16x32_bf16 v[64:67], v[172:175], a[0:3], 0
buffer_load_dwordx4 v251, s[12:15], s24 offen offset:0  lds
ds_read_b128 v[196:199], v252 offset:6144
v_mfma_f32_16x16x32_bf16 v[64:67], v[176:179], a[4:7], v[64:67]
v_cvt_pk_bf16_f32 v94, v80, v81
v_cvt_pk_bf16_f32 v95, v82, v83
v_mfma_f32_16x16x32_bf16 v[64:67], v[180:183], a[8:11], v[64:67]
ds_read_b128 v[200:203], v252 offset:7168
v_mfma_f32_16x16x32_bf16 v[64:67], v[184:187], a[12:15], v[64:67]
v_mfma_f32_16x16x32_bf16 v[64:67], v[188:191], a[16:19], v[64:67]
buffer_load_dwordx4 v251, s[12:15], s24 offen offset:1024  lds
ds_read_b128 v[204:207], v252 offset:8192
v_mfma_f32_16x16x32_bf16 v[64:67], v[192:195], a[20:23], v[64:67]
v_mfma_f32_16x16x32_bf16 v[68:71], v[172:175], a[48:51], 0
ds_read_b128 v[208:211], v252 offset:9216
v_mfma_f32_16x16x32_bf16 v[68:71], v[176:179], a[52:55], v[68:71]
v_cvt_pk_bf16_f32 v98, v84, v85
v_cvt_pk_bf16_f32 v99, v86, v87
v_mfma_f32_16x16x32_bf16 v[68:71], v[180:183], a[56:59], v[68:71]
ds_read_b128 v[212:215], v252 offset:10240
v_add_u32 v238, s19, v251
v_mfma_f32_16x16x32_bf16 v[68:71], v[184:187], a[60:63], v[68:71]
ds_read_b128 v[108:111], v238 offset:1024
v_mfma_f32_16x16x32_bf16 v[68:71], v[188:191], a[64:67], v[68:71]
ds_read_b128 v[216:219], v252 offset:11264
v_mfma_f32_16x16x32_bf16 v[68:71], v[192:195], a[68:71], v[68:71]
v_mfma_f32_16x16x32_bf16 v[72:75], v[172:175], a[96:99], 0
s_waitcnt vmcnt(22)
ds_read_b128 a[224:227], v237 offset:8192
v_mfma_f32_16x16x32_bf16 v[72:75], v[176:179], a[100:103], v[72:75]
v_mfma_f32_16x16x32_bf16 v[72:75], v[180:183], a[104:107], v[72:75]
v_xor_b32 v238, 64, v237
ds_read_b128 a[228:231], v238 offset:8192
v_mfma_f32_16x16x32_bf16 v[72:75], v[184:187], a[108:111], v[72:75]
v_mfma_f32_16x16x32_bf16 v[72:75], v[188:191], a[112:115], v[72:75]
v_xor_b32 v238, 128, v237
ds_read_b128 a[232:235], v238 offset:8192
v_mfma_f32_16x16x32_bf16 v[72:75], v[192:195], a[116:119], v[72:75]
v_mfma_f32_16x16x32_bf16 v[0:3], a[36:39], v[88:91], v[0:3]
v_xor_b32 v238, 192, v237
ds_read_b128 a[236:239], v238 offset:8192
v_mfma_f32_16x16x32_bf16 v[4:7], a[84:87], v[88:91], v[4:7]
v_mfma_f32_16x16x32_bf16 v[8:11], a[132:135], v[88:91], v[8:11]
v_mfma_f32_16x16x32_bf16 v[12:15], v[100:103], v[88:91], v[12:15]
v_mfma_f32_16x16x32_bf16 v[16:19], a[36:39], v[92:95], v[16:19]
v_mfma_f32_16x16x32_bf16 v[20:23], a[84:87], v[92:95], v[20:23]
v_mfma_f32_16x16x32_bf16 v[24:27], a[132:135], v[92:95], v[24:27]
v_mfma_f32_16x16x32_bf16 v[28:31], v[100:103], v[92:95], v[28:31]
v_mfma_f32_16x16x32_bf16 v[32:35], a[36:39], v[96:99], v[32:35]
v_mfma_f32_16x16x32_bf16 v[36:39], a[84:87], v[96:99], v[36:39]
v_mfma_f32_16x16x32_bf16 v[40:43], a[132:135], v[96:99], v[40:43]
v_mfma_f32_16x16x32_bf16 v[44:47], v[100:103], v[96:99], v[44:47]
s_waitcnt lgkmcnt(4)
v_mfma_f32_16x16x32_bf16 v[64:67], v[196:199], a[24:27], v[64:67]
ds_read_b128 v[172:175], v252 offset:12288
v_mfma_f32_16x16x32_bf16 v[64:67], v[200:203], a[28:31], v[64:67]
v_mfma_f32_16x16x32_bf16 v[64:67], v[204:207], a[32:35], v[64:67]
ds_read_b128 v[176:179], v252 offset:13312
v_mfma_f32_16x16x32_bf16 v[64:67], v[208:211], a[36:39], v[64:67]
v_mfma_f32_16x16x32_bf16 v[64:67], v[212:215], a[40:43], v[64:67]
ds_read_b128 v[180:183], v252 offset:14336
v_mfma_f32_16x16x32_bf16 v[64:67], v[216:219], a[44:47], v[64:67]
v_mfma_f32_16x16x32_bf16 v[68:71], v[196:199], a[72:75], v[68:71]
ds_read_b128 v[184:187], v252 offset:15360
v_mfma_f32_16x16x32_bf16 v[68:71], v[200:203], a[76:79], v[68:71]
s_add_u32 m0, s18, 101888
v_mfma_f32_16x16x32_bf16 v[68:71], v[204:207], a[80:83], v[68:71]
ds_read_b128 v[188:191], v252 offset:16384
buffer_load_dwordx4 v108, s[4:7], s22 offen offset:512 nt lds
v_mfma_f32_16x16x32_bf16 v[68:71], v[208:211], a[84:87], v[68:71]
v_mfma_f32_16x16x32_bf16 v[68:71], v[212:215], a[88:91], v[68:71]
ds_read_b128 v[192:195], v252 offset:17408
v_mfma_f32_16x16x32_bf16 v[68:71], v[216:219], a[92:95], v[68:71]
ds_read_b128 v[100:103], v253 offset:640
v_mfma_f32_16x16x32_bf16 v[72:75], v[196:199], a[120:123], v[72:75]
v_mfma_f32_16x16x32_bf16 v[72:75], v[200:203], a[124:127], v[72:75]
v_cvt_pk_bf16_f32 v88, v64, v65
v_cvt_pk_bf16_f32 v89, v66, v67
v_mfma_f32_16x16x32_bf16 v[72:75], v[204:207], a[128:131], v[72:75]
v_mfma_f32_16x16x32_bf16 v[72:75], v[208:211], a[132:135], v[72:75]
s_add_u32 m0, s18, 102912
v_mfma_f32_16x16x32_bf16 v[72:75], v[212:215], a[136:139], v[72:75]
buffer_load_dwordx4 v109, s[4:7], s22 offen offset:512 nt lds
v_mfma_f32_16x16x32_bf16 v[72:75], v[216:219], a[140:143], v[72:75]
s_waitcnt lgkmcnt(1)
v_mfma_f32_16x16x32_bf16 v[76:79], v[172:175], a[0:3], 0
ds_read_b128 v[196:199], v252 offset:18432
v_mfma_f32_16x16x32_bf16 v[76:79], v[176:179], a[4:7], v[76:79]
v_cvt_pk_bf16_f32 v92, v68, v69
v_cvt_pk_bf16_f32 v93, v70, v71
v_mfma_f32_16x16x32_bf16 v[76:79], v[180:183], a[8:11], v[76:79]
ds_read_b128 v[200:203], v252 offset:19456
v_mfma_f32_16x16x32_bf16 v[76:79], v[184:187], a[12:15], v[76:79]
v_mfma_f32_16x16x32_bf16 v[76:79], v[188:191], a[16:19], v[76:79]
ds_read_b128 v[204:207], v252 offset:20480
v_mfma_f32_16x16x32_bf16 v[76:79], v[192:195], a[20:23], v[76:79]
s_add_u32 m0, s18, 103936
v_mfma_f32_16x16x32_bf16 v[80:83], v[172:175], a[48:51], 0
ds_read_b128 v[208:211], v252 offset:21504
buffer_load_dwordx4 v110, s[4:7], s22 offen offset:512 nt lds
v_mfma_f32_16x16x32_bf16 v[80:83], v[176:179], a[52:55], v[80:83]
v_cvt_pk_bf16_f32 v96, v72, v73
v_cvt_pk_bf16_f32 v97, v74, v75
v_mfma_f32_16x16x32_bf16 v[80:83], v[180:183], a[56:59], v[80:83]
ds_read_b128 v[212:215], v252 offset:22528
v_mfma_f32_16x16x32_bf16 v[80:83], v[184:187], a[60:63], v[80:83]
v_mfma_f32_16x16x32_bf16 v[80:83], v[188:191], a[64:67], v[80:83]
ds_read_b128 v[216:219], v252 offset:23552
v_mfma_f32_16x16x32_bf16 v[80:83], v[192:195], a[68:71], v[80:83]
v_mfma_f32_16x16x32_bf16 v[84:87], v[172:175], a[96:99], 0
v_mfma_f32_16x16x32_bf16 v[84:87], v[176:179], a[100:103], v[84:87]
s_add_u32 m0, s18, 104960
v_mfma_f32_16x16x32_bf16 v[84:87], v[180:183], a[104:107], v[84:87]
buffer_load_dwordx4 v111, s[4:7], s22 offen offset:512 nt lds
v_mfma_f32_16x16x32_bf16 v[84:87], v[184:187], a[108:111], v[84:87]
v_mfma_f32_16x16x32_bf16 v[84:87], v[188:191], a[112:115], v[84:87]
v_mfma_f32_16x16x32_bf16 v[84:87], v[192:195], a[116:119], v[84:87]
s_waitcnt vmcnt(20) lgkmcnt(0)
s_barrier
v_add_u32 v252, 24576, v252
v_mfma_f32_16x16x32_bf16 v[76:79], v[196:199], a[24:27], v[76:79]
s_add_u32 m0, s17, 49152
s_mov_b32 s24, 344064
v_mfma_f32_16x16x32_bf16 v[76:79], v[200:203], a[28:31], v[76:79]
ds_read_b128 v[172:175], v252 offset:0
v_mfma_f32_16x16x32_bf16 v[76:79], v[204:207], a[32:35], v[76:79]
buffer_load_dwordx4 v251, s[12:15], s24 offen offset:0  lds
v_mfma_f32_16x16x32_bf16 v[76:79], v[208:211], a[36:39], v[76:79]
ds_read_b128 v[176:179], v252 offset:1024
v_mfma_f32_16x16x32_bf16 v[76:79], v[212:215], a[40:43], v[76:79]
v_mfma_f32_16x16x32_bf16 v[76:79], v[216:219], a[44:47], v[76:79]
ds_read_b128 v[180:183], v252 offset:2048
v_mfma_f32_16x16x32_bf16 v[80:83], v[196:199], a[72:75], v[80:83]
buffer_load_dwordx4 v251, s[12:15], s24 offen offset:1024  lds
v_mfma_f32_16x16x32_bf16 v[80:83], v[200:203], a[76:79], v[80:83]
ds_read_b128 v[184:187], v252 offset:3072
v_mfma_f32_16x16x32_bf16 v[80:83], v[204:207], a[80:83], v[80:83]
v_mfma_f32_16x16x32_bf16 v[80:83], v[208:211], a[84:87], v[80:83]
ds_read_b128 v[188:191], v252 offset:4096
v_mfma_f32_16x16x32_bf16 v[80:83], v[212:215], a[88:91], v[80:83]
buffer_load_dwordx4 v251, s[12:15], s24 offen offset:2048  lds
v_mfma_f32_16x16x32_bf16 v[80:83], v[216:219], a[92:95], v[80:83]
ds_read_b128 v[192:195], v252 offset:5120
v_mfma_f32_16x16x32_bf16 v[84:87], v[196:199], a[120:123], v[84:87]
v_mfma_f32_16x16x32_bf16 v[84:87], v[200:203], a[124:127], v[84:87]
v_cvt_pk_bf16_f32 v90, v76, v77
v_cvt_pk_bf16_f32 v91, v78, v79
v_mfma_f32_16x16x32_bf16 v[84:87], v[204:207], a[128:131], v[84:87]
buffer_load_dwordx4 v251, s[12:15], s24 offen offset:3072  lds
v_mfma_f32_16x16x32_bf16 v[84:87], v[208:211], a[132:135], v[84:87]
v_mfma_f32_16x16x32_bf16 v[84:87], v[212:215], a[136:139], v[84:87]
s_add_u32 m0, s17, 53248
s_mov_b32 s24, 348160
v_mfma_f32_16x16x32_bf16 v[84:87], v[216:219], a[140:143], v[84:87]
s_waitcnt lgkmcnt(0)
v_mfma_f32_16x16x32_bf16 v[64:67], v[172:175], a[0:3], 0
buffer_load_dwordx4 v251, s[12:15], s24 offen offset:0  lds
ds_read_b128 v[196:199], v252 offset:6144
v_mfma_f32_16x16x32_bf16 v[64:67], v[176:179], a[4:7], v[64:67]
v_cvt_pk_bf16_f32 v94, v80, v81
v_cvt_pk_bf16_f32 v95, v82, v83
v_mfma_f32_16x16x32_bf16 v[64:67], v[180:183], a[8:11], v[64:67]
ds_read_b128 v[200:203], v252 offset:7168
v_mfma_f32_16x16x32_bf16 v[64:67], v[184:187], a[12:15], v[64:67]
v_mfma_f32_16x16x32_bf16 v[64:67], v[188:191], a[16:19], v[64:67]
buffer_load_dwordx4 v251, s[12:15], s24 offen offset:1024  lds
ds_read_b128 v[204:207], v252 offset:8192
v_mfma_f32_16x16x32_bf16 v[64:67], v[192:195], a[20:23], v[64:67]
v_mfma_f32_16x16x32_bf16 v[68:71], v[172:175], a[48:51], 0
ds_read_b128 v[208:211], v252 offset:9216
v_mfma_f32_16x16x32_bf16 v[68:71], v[176:179], a[52:55], v[68:71]
v_cvt_pk_bf16_f32 v98, v84, v85
v_cvt_pk_bf16_f32 v99, v86, v87
v_mfma_f32_16x16x32_bf16 v[68:71], v[180:183], a[56:59], v[68:71]
ds_read_b128 v[212:215], v252 offset:10240
v_add_u32 v238, s19, v251
v_mfma_f32_16x16x32_bf16 v[68:71], v[184:187], a[60:63], v[68:71]
ds_read_b128 v[108:111], v238 offset:2048
v_mfma_f32_16x16x32_bf16 v[68:71], v[188:191], a[64:67], v[68:71]
ds_read_b128 v[216:219], v252 offset:11264
v_mfma_f32_16x16x32_bf16 v[68:71], v[192:195], a[68:71], v[68:71]
v_mfma_f32_16x16x32_bf16 v[72:75], v[172:175], a[96:99], 0
v_mfma_f32_16x16x32_bf16 v[72:75], v[176:179], a[100:103], v[72:75]
v_readfirstlane_b32 s34, v104
v_readfirstlane_b32 s35, v105
s_nop 3
s_min_u32 s34, s34, s35
s_cmp_ge_u32 s34, 6
s_cbranch_scc0 L_slow
L_back:
v_subrev_u32 v107, s17, v251
v_mfma_f32_16x16x32_bf16 v[72:75], v[180:183], a[104:107], v[72:75]
v_mfma_f32_16x16x32_bf16 v[72:75], v[184:187], a[108:111], v[72:75]
v_lshrrev_b32 v106, 8, v107
v_and_b32 v107, 0xf0, v107
v_mfma_f32_16x16x32_bf16 v[72:75], v[188:191], a[112:115], v[72:75]
v_lshl_add_u32 v107, v106, 10, v107
v_mfma_f32_16x16x32_bf16 v[72:75], v[192:195], a[116:119], v[72:75]
buffer_load_dwordx4 v[164:167], v107, s[40:43], s29 offen sc1
v_mfma_f32_16x16x32_bf16 v[0:3], a[40:43], v[88:91], v[0:3]
v_mfma_f32_16x16x32_bf16 v[4:7], a[88:91], v[88:91], v[4:7]
v_mfma_f32_16x16x32_bf16 v[8:11], a[136:139], v[88:91], v[8:11]
v_mfma_f32_16x16x32_bf16 v[12:15], v[100:103], v[88:91], v[12:15]
v_mfma_f32_16x16x32_bf16 v[16:19], a[40:43], v[92:95], v[16:19]
v_mfma_f32_16x16x32_bf16 v[20:23], a[88:91], v[92:95], v[20:23]
v_mfma_f32_16x16x32_bf16 v[24:27], a[136:139], v[92:95], v[24:27]
v_mfma_f32_16x16x32_bf16 v[28:31], v[100:103], v[92:95], v[28:31]
s_add_u32 s28, s29, 2654208
v_mfma_f32_16x16x32_bf16 v[32:35], a[40:43], v[96:99], v[32:35]
buffer_load_dwordx4 v[168:171], v107, s[40:43], s28 offen sc1
v_mfma_f32_16x16x32_bf16 v[36:39], a[88:91], v[96:99], v[36:39]
v_mfma_f32_16x16x32_bf16 v[40:43], a[136:139], v[96:99], v[40:43]
v_mfma_f32_16x16x32_bf16 v[44:47], v[100:103], v[96:99], v[44:47]
s_waitcnt lgkmcnt(0)
v_mfma_f32_16x16x32_bf16 v[64:67], v[196:199], a[24:27], v[64:67]
ds_read_b128 v[172:175], v252 offset:12288
v_mfma_f32_16x16x32_bf16 v[64:67], v[200:203], a[28:31], v[64:67]
v_mfma_f32_16x16x32_bf16 v[64:67], v[204:207], a[32:35], v[64:67]
ds_read_b128 v[176:179], v252 offset:13312
v_mfma_f32_16x16x32_bf16 v[64:67], v[208:211], a[36:39], v[64:67]
v_mfma_f32_16x16x32_bf16 v[64:67], v[212:215], a[40:43], v[64:67]
ds_read_b128 v[180:183], v252 offset:14336
buffer_load_dword v60, off, s[40:43], s38 sc1
v_mfma_f32_16x16x32_bf16 v[64:67], v[216:219], a[44:47], v[64:67]
v_mfma_f32_16x16x32_bf16 v[68:71], v[196:199], a[72:75], v[68:71]
ds_read_b128 v[184:187], v252 offset:15360
v_mfma_f32_16x16x32_bf16 v[68:71], v[200:203], a[76:79], v[68:71]
s_add_u32 m0, s18, 105984
v_mfma_f32_16x16x32_bf16 v[68:71], v[204:207], a[80:83], v[68:71]
ds_read_b128 v[188:191], v252 offset:16384
buffer_load_dwordx4 v108, s[4:7], s22 offen offset:512 nt lds
v_mfma_f32_16x16x32_bf16 v[68:71], v[208:211], a[84:87], v[68:71]
v_mfma_f32_16x16x32_bf16 v[68:71], v[212:215], a[88:91], v[68:71]
ds_read_b128 v[192:195], v252 offset:17408
v_mfma_f32_16x16x32_bf16 v[68:71], v[216:219], a[92:95], v[68:71]
ds_read_b128 v[100:103], v253 offset:704
v_mfma_f32_16x16x32_bf16 v[72:75], v[196:199], a[120:123], v[72:75]
v_mfma_f32_16x16x32_bf16 v[72:75], v[200:203], a[124:127], v[72:75]
v_cvt_pk_bf16_f32 v88, v64, v65
v_cvt_pk_bf16_f32 v89, v66, v67
v_mfma_f32_16x16x32_bf16 v[72:75], v[204:207], a[128:131], v[72:75]
v_mfma_f32_16x16x32_bf16 v[72:75], v[208:211], a[132:135], v[72:75]
s_add_u32 m0, s18, 107008
v_mfma_f32_16x16x32_bf16 v[72:75], v[212:215], a[136:139], v[72:75]
buffer_load_dwordx4 v109, s[4:7], s22 offen offset:512 nt lds
v_mfma_f32_16x16x32_bf16 v[72:75], v[216:219], a[140:143], v[72:75]
s_waitcnt lgkmcnt(1)
v_mfma_f32_16x16x32_bf16 v[76:79], v[172:175], a[0:3], 0
ds_read_b128 v[196:199], v252 offset:18432
v_mfma_f32_16x16x32_bf16 v[76:79], v[176:179], a[4:7], v[76:79]
v_cvt_pk_bf16_f32 v92, v68, v69
v_cvt_pk_bf16_f32 v93, v70, v71
v_mfma_f32_16x16x32_bf16 v[76:79], v[180:183], a[8:11], v[76:79]
ds_read_b128 v[200:203], v252 offset:19456
v_mfma_f32_16x16x32_bf16 v[76:79], v[184:187], a[12:15], v[76:79]
v_mfma_f32_16x16x32_bf16 v[76:79], v[188:191], a[16:19], v[76:79]
ds_read_b128 v[204:207], v252 offset:20480
v_mfma_f32_16x16x32_bf16 v[76:79], v[192:195], a[20:23], v[76:79]
s_add_u32 m0, s18, 108032
v_mfma_f32_16x16x32_bf16 v[80:83], v[172:175], a[48:51], 0
ds_read_b128 v[208:211], v252 offset:21504
buffer_load_dwordx4 v110, s[4:7], s22 offen offset:512 nt lds
v_mfma_f32_16x16x32_bf16 v[80:83], v[176:179], a[52:55], v[80:83]
v_cvt_pk_bf16_f32 v96, v72, v73
v_cvt_pk_bf16_f32 v97, v74, v75
v_mfma_f32_16x16x32_bf16 v[80:83], v[180:183], a[56:59], v[80:83]
ds_read_b128 v[212:215], v252 offset:22528
v_mfma_f32_16x16x32_bf16 v[80:83], v[184:187], a[60:63], v[80:83]
v_mfma_f32_16x16x32_bf16 v[80:83], v[188:191], a[64:67], v[80:83]
ds_read_b128 v[216:219], v252 offset:23552
v_mfma_f32_16x16x32_bf16 v[80:83], v[192:195], a[68:71], v[80:83]
v_mfma_f32_16x16x32_bf16 v[84:87], v[172:175], a[96:99], 0
v_mfma_f32_16x16x32_bf16 v[84:87], v[176:179], a[100:103], v[84:87]
s_add_u32 m0, s18, 109056
v_mfma_f32_16x16x32_bf16 v[84:87], v[180:183], a[104:107], v[84:87]
buffer_load_dwordx4 v111, s[4:7], s22 offen offset:512 nt lds
v_mfma_f32_16x16x32_bf16 v[84:87], v[184:187], a[108:111], v[84:87]
v_mfma_f32_16x16x32_bf16 v[84:87], v[188:191], a[112:115], v[84:87]
v_mfma_f32_16x16x32_bf16 v[84:87], v[192:195], a[116:119], v[84:87]
s_waitcnt vmcnt(27) lgkmcnt(0)
s_barrier
v_add_u32 v252, 4294893568, v252
v_mfma_f32_16x16x32_bf16 v[76:79], v[196:199], a[24:27], v[76:79]
s_add_u32 m0, s17, 73728
s_mov_b32 s24, 368640
v_mfma_f32_16x16x32_bf16 v[76:79], v[200:203], a[28:31], v[76:79]
ds_read_b128 v[172:175], v252 offset:0
v_mfma_f32_16x16x32_bf16 v[76:79], v[204:207], a[32:35], v[76:79]
buffer_load_dwordx4 v251, s[12:15], s24 offen offset:0  lds
v_mfma_f32_16x16x32_bf16 v[76:79], v[208:211], a[36:39], v[76:79]
ds_read_b128 v[176:179], v252 offset:1024
v_mfma_f32_16x16x32_bf16 v[76:79], v[212:215], a[40:43], v[76:79]
v_mfma_f32_16x16x32_bf16 v[76:79], v[216:219], a[44:47], v[76:79]
ds_read_b128 v[180:183], v252 offset:2048
v_mfma_f32_16x16x32_bf16 v[80:83], v[196:199], a[72:75], v[80:83]
buffer_load_dwordx4 v251, s[12:15], s24 offen offset:1024  lds
v_mfma_f32_16x16x32_bf16 v[80:83], v[200:203], a[76:79], v[80:83]
ds_read_b128 v[184:187], v252 offset:3072
v_mfma_f32_16x16x32_bf16 v[80:83], v[204:207], a[80:83], v[80:83]
v_mfma_f32_16x16x32_bf16 v[80:83], v[208:211], a[84:87], v[80:83]
ds_read_b128 v[188:191], v252 offset:4096
v_mfma_f32_16x16x32_bf16 v[80:83], v[212:215], a[88:91], v[80:83]
buffer_load_dwordx4 v251, s[12:15], s24 offen offset:2048  lds
v_mfma_f32_16x16x32_bf16 v[80:83], v[216:219], a[92:95], v[80:83]
ds_read_b128 v[192:195], v252 offset:5120
v_mfma_f32_16x16x32_bf16 v[84:87], v[196:199], a[120:123], v[84:87]
v_mfma_f32_16x16x32_bf16 v[84:87], v[200:203], a[124:127], v[84:87]
v_cvt_pk_bf16_f32 v90, v76, v77
v_cvt_pk_bf16_f32 v91, v78, v79
v_mfma_f32_16x16x32_bf16 v[84:87], v[204:207], a[128:131], v[84:87]
buffer_load_dwordx4 v251, s[12:15], s24 offen offset:3072  lds
v_mfma_f32_16x16x32_bf16 v[84:87], v[208:211], a[132:135], v[84:87]
v_mfma_f32_16x16x32_bf16 v[84:87], v[212:215], a[136:139], v[84:87]
s_add_u32 m0, s17, 77824
s_mov_b32 s24, 372736
v_mfma_f32_16x16x32_bf16 v[84:87], v[216:219], a[140:143], v[84:87]
s_waitcnt lgkmcnt(0)
v_mfma_f32_16x16x32_bf16 v[64:67], a[0:3], v[172:175], 0
buffer_load_dwordx4 v251, s[12:15], s24 offen offset:0  lds
ds_read_b128 v[196:199], v252 offset:6144
v_mfma_f32_16x16x32_bf16 v[64:67], a[4:7], v[176:179], v[64:67]
v_cvt_pk_bf16_f32 v94, v80, v81
v_cvt_pk_bf16_f32 v95, v82, v83
v_mfma_f32_16x16x32_bf16 v[64:67], a[8:11], v[180:183], v[64:67]
ds_read_b128 v[200:203], v252 offset:7168
v_mfma_f32_16x16x32_bf16 v[64:67], a[12:15], v[184:187], v[64:67]
v_mfma_f32_16x16x32_bf16 v[64:67], a[16:19], v[188:191], v[64:67]
buffer_load_dwordx4 v251, s[12:15], s24 offen offset:1024  lds
ds_read_b128 v[204:207], v252 offset:8192
v_mfma_f32_16x16x32_bf16 v[64:67], a[20:23], v[192:195], v[64:67]
v_mfma_f32_16x16x32_bf16 v[68:71], a[48:51], v[172:175], 0
ds_read_b128 v[208:211], v252 offset:9216
v_mfma_f32_16x16x32_bf16 v[68:71], a[52:55], v[176:179], v[68:71]
v_cvt_pk_bf16_f32 v98, v84, v85
v_cvt_pk_bf16_f32 v99, v86, v87
v_mfma_f32_16x16x32_bf16 v[68:71], a[56:59], v[180:183], v[68:71]
ds_read_b128 v[212:215], v252 offset:10240
v_mfma_f32_16x16x32_bf16 v[68:71], a[60:63], v[184:187], v[68:71]
v_mfma_f32_16x16x32_bf16 v[68:71], a[64:67], v[188:191], v[68:71]
ds_read_b128 v[216:219], v252 offset:11264
v_mfma_f32_16x16x32_bf16 v[68:71], a[68:71], v[192:195], v[68:71]
v_mfma_f32_16x16x32_bf16 v[72:75], a[96:99], v[172:175], 0
v_mfma_f32_16x16x32_bf16 v[72:75], a[100:103], v[176:179], v[72:75]
v_mfma_f32_16x16x32_bf16 v[72:75], a[104:107], v[180:183], v[72:75]
v_mfma_f32_16x16x32_bf16 v[72:75], a[108:111], v[184:187], v[72:75]
v_mfma_f32_16x16x32_bf16 v[72:75], a[112:115], v[188:191], v[72:75]
v_mfma_f32_16x16x32_bf16 v[72:75], a[116:119], v[192:195], v[72:75]
v_mfma_f32_16x16x32_bf16 v[0:3], a[44:47], v[88:91], v[0:3]
v_mfma_f32_16x16x32_bf16 v[4:7], a[92:95], v[88:91], v[4:7]
v_mfma_f32_16x16x32_bf16 v[8:11], a[140:143], v[88:91], v[8:11]
v_mfma_f32_16x16x32_bf16 v[12:15], v[100:103], v[88:91], v[12:15]
v_mfma_f32_16x16x32_bf16 v[16:19], a[44:47], v[92:95], v[16:19]
v_mfma_f32_16x16x32_bf16 v[20:23], a[92:95], v[92:95], v[20:23]
v_mfma_f32_16x16x32_bf16 v[24:27], a[140:143], v[92:95], v[24:27]
v_mfma_f32_16x16x32_bf16 v[28:31], v[100:103], v[92:95], v[28:31]
v_mfma_f32_16x16x32_bf16 v[32:35], a[44:47], v[96:99], v[32:35]
v_mfma_f32_16x16x32_bf16 v[36:39], a[92:95], v[96:99], v[36:39]
v_mfma_f32_16x16x32_bf16 v[40:43], a[140:143], v[96:99], v[40:43]
v_mfma_f32_16x16x32_bf16 v[44:47], v[100:103], v[96:99], v[44:47]
s_waitcnt lgkmcnt(0)
v_mfma_f32_16x16x32_bf16 v[64:67], a[24:27], v[196:199], v[64:67]
ds_read_b128 v[172:175], v252 offset:12288
v_mfma_f32_16x16x32_bf16 v[64:67], a[28:31], v[200:203], v[64:67]
v_mfma_f32_16x16x32_bf16 v[64:67], a[32:35], v[204:207], v[64:67]
ds_read_b128 v[176:179], v252 offset:13312
v_mfma_f32_16x16x32_bf16 v[64:67], a[36:39], v[208:211], v[64:67]
v_mfma_f32_16x16x32_bf16 v[64:67], a[40:43], v[212:215], v[64:67]
ds_read_b128 v[180:183], v252 offset:14336
v_mfma_f32_16x16x32_bf16 v[64:67], a[44:47], v[216:219], v[64:67]
v_mfma_f32_16x16x32_bf16 v[68:71], a[72:75], v[196:199], v[68:71]
ds_read_b128 v[184:187], v252 offset:15360
v_mfma_f32_16x16x32_bf16 v[68:71], a[76:79], v[200:203], v[68:71]
s_mov_b32 exec_lo, 0xffff0000
v_mov_b32 v12, 0xff800000
v_mov_b32 v28, 0xff800000
v_mov_b32 v44, 0xff800000
s_waitcnt vmcnt(10)
v_mov_b32 v60, 0xff800000
s_mov_b32 exec_lo, -1
v_mfma_f32_16x16x32_bf16 v[68:71], a[80:83], v[204:207], v[68:71]
ds_read_b128 v[188:191], v252 offset:16384
v_max3_f32 v13, v0, v1, v2
v_mfma_f32_16x16x32_bf16 v[68:71], a[84:87], v[208:211], v[68:71]
v_mov_b32 v95, 0
v_max3_f32 v29, v16, v17, v18
v_max3_f32 v45, v32, v33, v34
v_mfma_f32_16x16x32_bf16 v[68:71], a[88:91], v[212:215], v[68:71]
ds_read_b128 v[192:195], v252 offset:17408
v_max3_f32 v13, v13, v3, v4
v_mfma_f32_16x16x32_bf16 v[68:71], a[92:95], v[216:219], v[68:71]
v_max3_f32 v29, v29, v19, v20
v_max3_f32 v45, v45, v35, v36
v_max3_f32 v13, v13, v5, v6
v_mfma_f32_16x16x32_bf16 v[72:75], a[120:123], v[196:199], v[72:75]
v_max3_f32 v29, v29, v21, v22
v_max3_f32 v45, v45, v37, v38
v_mfma_f32_16x16x32_bf16 v[72:75], a[124:127], v[200:203], v[72:75]
v_cvt_pk_bf16_f32 v88, v64, v65
v_cvt_pk_bf16_f32 v89, v66, v67
v_mov_b32 v103, 0
v_mfma_f32_16x16x32_bf16 v[72:75], a[128:131], v[204:207], v[72:75]
v_max3_f32 v13, v13, v7, v8
v_max3_f32 v29, v29, v23, v24
v_max3_f32 v45, v45, v39, v40
v_mfma_f32_16x16x32_bf16 v[72:75], a[132:135], v[208:211], v[72:75]
v_max3_f32 v13, v13, v9, v10
v_max3_f32 v29, v29, v25, v26
v_mfma_f32_16x16x32_bf16 v[72:75], a[136:139], v[212:215], v[72:75]
v_max3_f32 v45, v45, v41, v42
v_max3_f32 v13, v13, v11, v12
v_max3_f32 v29, v29, v27, v28
v_mfma_f32_16x16x32_bf16 v[72:75], a[140:143], v[216:219], v[72:75]
s_waitcnt lgkmcnt(0)
v_max3_f32 v45, v45, v43, v44
v_mfma_f32_16x16x32_bf16 v[76:79], a[0:3], v[172:175], 0
ds_read_b128 v[196:199], v252 offset:18432
v_mov_b32 v14, v13
v_mfma_f32_16x16x32_bf16 v[76:79], a[4:7], v[176:179], v[76:79]
v_cvt_pk_bf16_f32 v90, v68, v69
v_cvt_pk_bf16_f32 v91, v70, v71
v_mov_b32 v30, v29
v_mfma_f32_16x16x32_bf16 v[76:79], a[8:11], v[180:183], v[76:79]
ds_read_b128 v[200:203], v252 offset:19456
v_mov_b32 v46, v45
v_mfma_f32_16x16x32_bf16 v[76:79], a[12:15], v[184:187], v[76:79]
v_permlane32_swap_b32 v13, v14
v_permlane32_swap_b32 v29, v30
v_permlane32_swap_b32 v45, v46
v_mfma_f32_16x16x32_bf16 v[76:79], a[16:19], v[188:191], v[76:79]
ds_read_b128 v[204:207], v252 offset:20480
v_max_f32 v13, v13, v14
v_mfma_f32_16x16x32_bf16 v[76:79], a[20:23], v[192:195], v[76:79]
v_max_f32 v29, v29, v30
v_max_f32 v45, v45, v46
v_mov_b32 v14, v13
v_mfma_f32_16x16x32_bf16 v[80:83], a[48:51], v[172:175], 0
ds_read_b128 v[208:211], v252 offset:21504
v_mov_b32 v30, v29
v_mfma_f32_16x16x32_bf16 v[80:83], a[52:55], v[176:179], v[80:83]
v_cvt_pk_bf16_f32 v92, v72, v73
v_cvt_pk_bf16_f32 v93, v74, v75
v_mov_b32 v46, v45
v_mfma_f32_16x16x32_bf16 v[80:83], a[56:59], v[180:183], v[80:83]
ds_read_b128 v[212:215], v252 offset:22528
v_permlane16_swap_b32 v13, v14
v_mfma_f32_16x16x32_bf16 v[80:83], a[60:63], v[184:187], v[80:83]
v_permlane16_swap_b32 v29, v30
v_permlane16_swap_b32 v45, v46
v_max_f32 v13, v13, v14
v_mfma_f32_16x16x32_bf16 v[80:83], a[64:67], v[188:191], v[80:83]
ds_read_b128 v[216:219], v252 offset:23552
v_max_f32 v29, v29, v30
v_mfma_f32_16x16x32_bf16 v[80:83], a[68:71], v[192:195], v[80:83]
v_max_f32 v45, v45, v46
v_mul_f32 v13, s27, v13
v_mfma_f32_16x16x32_bf16 v[84:87], a[96:99], v[172:175], 0
v_mul_f32 v29, s27, v29
v_mul_f32 v45, s27, v45
v_fma_f32 v0, v0, s26, v13
v_mfma_f32_16x16x32_bf16 v[84:87], a[100:103], v[176:179], v[84:87]
v_fma_f32 v16, v16, s26, v29
v_fma_f32 v32, v32, s26, v45
v_mfma_f32_16x16x32_bf16 v[84:87], a[104:107], v[180:183], v[84:87]
v_fma_f32 v1, v1, s26, v13
v_fma_f32 v17, v17, s26, v29
v_fma_f32 v33, v33, s26, v45
v_mfma_f32_16x16x32_bf16 v[84:87], a[108:111], v[184:187], v[84:87]
v_fma_f32 v2, v2, s26, v13
v_fma_f32 v18, v18, s26, v29
v_mfma_f32_16x16x32_bf16 v[84:87], a[112:115], v[188:191], v[84:87]
v_fma_f32 v34, v34, s26, v45
v_fma_f32 v3, v3, s26, v13
v_fma_f32 v19, v19, s26, v29
v_mfma_f32_16x16x32_bf16 v[84:87], a[116:119], v[192:195], v[84:87]
s_waitcnt lgkmcnt(0)
s_barrier
v_add_u32 v252, 24576, v252
v_mfma_f32_16x16x32_bf16 v[76:79], a[24:27], v[196:199], v[76:79]
s_add_u32 m0, s17, 0
s_mov_b32 s24, 393216
v_mfma_f32_16x16x32_bf16 v[76:79], a[28:31], v[200:203], v[76:79]
ds_read_b128 v[172:175], v252 offset:0
v_fma_f32 v35, v35, s26, v45
v_fma_f32 v4, v4, s26, v13
v_mfma_f32_16x16x32_bf16 v[76:79], a[32:35], v[204:207], v[76:79]
buffer_load_dwordx4 v251, s[12:15], s24 offen offset:0  lds
v_fma_f32 v20, v20, s26, v29
v_mfma_f32_16x16x32_bf16 v[76:79], a[36:39], v[208:211], v[76:79]
ds_read_b128 v[176:179], v252 offset:1024
v_fma_f32 v36, v36, s26, v45
v_mfma_f32_16x16x32_bf16 v[76:79], a[40:43], v[212:215], v[76:79]
v_fma_f32 v5, v5, s26, v13
v_fma_f32 v21, v21, s26, v29
v_fma_f32 v37, v37, s26, v45
v_mfma_f32_16x16x32_bf16 v[76:79], a[44:47], v[216:219], v[76:79]
ds_read_b128 v[180:183], v252 offset:2048
v_fma_f32 v6, v6, s26, v13
v_mfma_f32_16x16x32_bf16 v[80:83], a[72:75], v[196:199], v[80:83]
buffer_load_dwordx4 v251, s[12:15], s24 offen offset:1024  lds
v_fma_f32 v22, v22, s26, v29
v_fma_f32 v38, v38, s26, v45
v_mfma_f32_16x16x32_bf16 v[80:83], a[76:79], v[200:203], v[80:83]
ds_read_b128 v[184:187], v252 offset:3072
v_fma_f32 v7, v7, s26, v13
v_mfma_f32_16x16x32_bf16 v[80:83], a[80:83], v[204:207], v[80:83]
v_fma_f32 v23, v23, s26, v29
v_fma_f32 v39, v39, s26, v45
v_fma_f32 v8, v8, s26, v13
v_mfma_f32_16x16x32_bf16 v[80:83], a[84:87], v[208:211], v[80:83]
ds_read_b128 v[188:191], v252 offset:4096
v_fma_f32 v24, v24, s26, v29
v_mfma_f32_16x16x32_bf16 v[80:83], a[88:91], v[212:215], v[80:83]
buffer_load_dwordx4 v251, s[12:15], s24 offen offset:2048  lds
v_fma_f32 v40, v40, s26, v45
v_fma_f32 v9, v9, s26, v13
v_mfma_f32_16x16x32_bf16 v[80:83], a[92:95], v[216:219], v[80:83]
ds_read_b128 v[192:195], v252 offset:5120
v_fma_f32 v25, v25, s26, v29
v_mfma_f32_16x16x32_bf16 v[84:87], a[120:123], v[196:199], v[84:87]
v_fma_f32 v41, v41, s26, v45
v_fma_f32 v10, v10, s26, v13
v_fma_f32 v26, v26, s26, v29
v_mfma_f32_16x16x32_bf16 v[84:87], a[124:127], v[200:203], v[84:87]
v_cvt_pk_bf16_f32 v96, v76, v77
v_cvt_pk_bf16_f32 v97, v78, v79
v_mfma_f32_16x16x32_bf16 v[84:87], a[128:131], v[204:207], v[84:87]
buffer_load_dwordx4 v251, s[12:15], s24 offen offset:3072  lds
v_fma_f32 v42, v42, s26, v45
v_mfma_f32_16x16x32_bf16 v[84:87], a[132:135], v[208:211], v[84:87]
v_fma_f32 v11, v11, s26, v13
v_fma_f32 v27, v27, s26, v29
v_fma_f32 v43, v43, s26, v45
v_mfma_f32_16x16x32_bf16 v[84:87], a[136:139], v[212:215], v[84:87]
s_add_u32 m0, s17, 4096
s_mov_b32 s24, 397312
v_mfma_f32_16x16x32_bf16 v[84:87], a[140:143], v[216:219], v[84:87]
v_fma_f32 v12, v12, s26, v13
v_fma_f32 v28, v28, s26, v29
v_fma_f32 v44, v44, s26, v45
s_waitcnt lgkmcnt(0)
v_mfma_f32_16x16x32_bf16 v[64:67], a[0:3], v[172:175], 0
buffer_load_dwordx4 v251, s[12:15], s24 offen offset:0  lds
ds_read_b128 v[196:199], v252 offset:6144
v_mfma_f32_16x16x32_bf16 v[64:67], a[4:7], v[176:179], v[64:67]
v_cvt_pk_bf16_f32 v98, v80, v81
v_cvt_pk_bf16_f32 v99, v82, v83
v_mfma_f32_16x16x32_bf16 v[64:67], a[8:11], v[180:183], v[64:67]
ds_read_b128 v[200:203], v252 offset:7168
v_exp_f32 v0, v0
v_mfma_f32_16x16x32_bf16 v[64:67], a[12:15], v[184:187], v[64:67]
v_exp_f32 v16, v16
v_mfma_f32_16x16x32_bf16 v[64:67], a[16:19], v[188:191], v[64:67]
buffer_load_dwordx4 v251, s[12:15], s24 offen offset:1024  lds
ds_read_b128 v[204:207], v252 offset:8192
v_mfma_f32_16x16x32_bf16 v[64:67], a[20:23], v[192:195], v[64:67]
v_exp_f32 v32, v32
v_mfma_f32_16x16x32_bf16 v[68:71], a[48:51], v[172:175], 0
ds_read_b128 v[208:211], v252 offset:9216
v_exp_f32 v1, v1
v_mfma_f32_16x16x32_bf16 v[68:71], a[52:55], v[176:179], v[68:71]
v_cvt_pk_bf16_f32 v100, v84, v85
v_cvt_pk_bf16_f32 v101, v86, v87
v_mfma_f32_16x16x32_bf16 v[68:71], a[56:59], v[180:183], v[68:71]
ds_read_b128 v[212:215], v252 offset:10240
v_exp_f32 v17, v17
v_mfma_f32_16x16x32_bf16 v[68:71], a[60:63], v[184:187], v[68:71]
v_exp_f32 v33, v33
v_mfma_f32_16x16x32_bf16 v[68:71], a[64:67], v[188:191], v[68:71]
ds_read_b128 v[216:219], v252 offset:11264
v_exp_f32 v2, v2
v_mfma_f32_16x16x32_bf16 v[68:71], a[68:71], v[192:195], v[68:71]
v_exp_f32 v18, v18
v_mfma_f32_16x16x32_bf16 v[72:75], a[96:99], v[172:175], 0
v_exp_f32 v34, v34
v_exp_f32 v3, v3
v_mfma_f32_16x16x32_bf16 v[72:75], a[100:103], v[176:179], v[72:75]
v_subrev_u32 v61, s17, v251
v_bfe_u32 v63, v61, 4, 2
v_mfma_f32_16x16x32_bf16 v[72:75], a[104:107], v[180:183], v[72:75]
v_lshlrev_b32 v63, 10, v63
v_bfe_u32 v62, v61, 6, 2
v_mfma_f32_16x16x32_bf16 v[72:75], a[108:111], v[184:187], v[72:75]
v_lshl_add_u32 v63, v62, 4, v63
v_lshrrev_b32 v62, 8, v61
v_mfma_f32_16x16x32_bf16 v[72:75], a[112:115], v[188:191], v[72:75]
v_lshl_add_u32 v63, v62, 6, v63
v_add_u32 v63, s3, v63
v_mfma_f32_16x16x32_bf16 v[72:75], a[116:119], v[192:195], v[72:75]
s_waitcnt lgkmcnt(0)
ds_write_b128 v63, v[164:167] offset:4096
v_exp_f32 v19, v19
v_mfma_f32_16x16x32_bf16 v[64:67], a[24:27], v[196:199], v[64:67]
ds_read_b128 v[172:175], v252 offset:12288
ds_write_b128 v63, v[168:171]
v_mfma_f32_16x16x32_bf16 v[64:67], a[28:31], v[200:203], v[64:67]
v_add_u32 v63, s33, v236
v_mov_b32 v62, 159744
v_mfma_f32_16x16x32_bf16 v[64:67], a[32:35], v[204:207], v[64:67]
ds_read_b128 v[176:179], v252 offset:13312
v_cndmask_b32 v63, v62, v63, vcc
v_mfma_f32_16x16x32_bf16 v[64:67], a[36:39], v[208:211], v[64:67]
v_exp_f32 v35, v35
v_exp_f32 v4, v4
v_mfma_f32_16x16x32_bf16 v[64:67], a[40:43], v[212:215], v[64:67]
ds_read_b128 v[180:183], v252 offset:14336
v_mfma_f32_16x16x32_bf16 v[64:67], a[44:47], v[216:219], v[64:67]
v_exp_f32 v20, v20
v_exp_f32 v36, v36
v_mfma_f32_16x16x32_bf16 v[68:71], a[72:75], v[196:199], v[68:71]
ds_read_b128 v[184:187], v252 offset:15360
v_mfma_f32_16x16x32_bf16 v[68:71], a[76:79], v[200:203], v[68:71]
s_add_u32 s25, s22, 1746432
s_sub_u32 s25, s25, s17
v_mfma_f32_16x16x32_bf16 v[68:71], a[80:83], v[204:207], v[68:71]
ds_read_b128 v[188:191], v252 offset:16384
v_exp_f32 v5, v5
v_mfma_f32_16x16x32_bf16 v[68:71], a[84:87], v[208:211], v[68:71]
s_lshl_b32 m0, s16, 10
s_add_u32 m0, m0, 147456
s_nop 0
buffer_load_dwordx4 v251, s[4:7], s25 offen lds
v_mov_b32 v111, 0
v_mfma_f32_16x16x32_bf16 v[68:71], a[88:91], v[212:215], v[68:71]
ds_read_b128 v[192:195], v252 offset:17408
v_exp_f32 v21, v21
v_mfma_f32_16x16x32_bf16 v[68:71], a[92:95], v[216:219], v[68:71]
v_exp_f32 v37, v37
v_mfma_f32_16x16x32_bf16 v[72:75], a[120:123], v[196:199], v[72:75]
v_exp_f32 v6, v6
v_mfma_f32_16x16x32_bf16 v[72:75], a[124:127], v[200:203], v[72:75]
v_cvt_pk_bf16_f32 v104, v64, v65
v_cvt_pk_bf16_f32 v105, v66, v67
v_mov_b32 v119, 0
v_mfma_f32_16x16x32_bf16 v[72:75], a[128:131], v[204:207], v[72:75]
v_exp_f32 v22, v22
v_exp_f32 v38, v38
v_mfma_f32_16x16x32_bf16 v[72:75], a[132:135], v[208:211], v[72:75]
v_exp_f32 v7, v7
v_mfma_f32_16x16x32_bf16 v[72:75], a[136:139], v[212:215], v[72:75]
v_exp_f32 v23, v23
v_mfma_f32_16x16x32_bf16 v[72:75], a[140:143], v[216:219], v[72:75]
s_waitcnt lgkmcnt(0)
v_exp_f32 v39, v39
v_mfma_f32_16x16x32_bf16 v[76:79], a[0:3], v[172:175], 0
ds_read_b128 v[196:199], v252 offset:18432
v_exp_f32 v8, v8
v_mfma_f32_16x16x32_bf16 v[76:79], a[4:7], v[176:179], v[76:79]
v_cvt_pk_bf16_f32 v106, v68, v69
v_cvt_pk_bf16_f32 v107, v70, v71
v_mfma_f32_16x16x32_bf16 v[76:79], a[8:11], v[180:183], v[76:79]
ds_read_b128 v[200:203], v252 offset:19456
v_mfma_f32_16x16x32_bf16 v[76:79], a[12:15], v[184:187], v[76:79]
v_exp_f32 v24, v24
v_exp_f32 v40, v40
v_mfma_f32_16x16x32_bf16 v[76:79], a[16:19], v[188:191], v[76:79]
ds_read_b128 v[204:207], v252 offset:20480
v_mfma_f32_16x16x32_bf16 v[76:79], a[20:23], v[192:195], v[76:79]
v_exp_f32 v9, v9
v_exp_f32 v25, v25
v_mfma_f32_16x16x32_bf16 v[80:83], a[48:51], v[172:175], 0
ds_read_b128 v[208:211], v252 offset:21504
v_mfma_f32_16x16x32_bf16 v[80:83], a[52:55], v[176:179], v[80:83]
v_cvt_pk_bf16_f32 v108, v72, v73
v_cvt_pk_bf16_f32 v109, v74, v75
v_exp_f32 v41, v41
v_mfma_f32_16x16x32_bf16 v[80:83], a[56:59], v[180:183], v[80:83]
ds_read_b128 v[212:215], v252 offset:22528
v_mfma_f32_16x16x32_bf16 v[80:83], a[60:63], v[184:187], v[80:83]
v_exp_f32 v10, v10
v_exp_f32 v26, v26
v_mfma_f32_16x16x32_bf16 v[80:83], a[64:67], v[188:191], v[80:83]
ds_read_b128 v[216:219], v252 offset:23552
v_mfma_f32_16x16x32_bf16 v[80:83], a[68:71], v[192:195], v[80:83]
v_exp_f32 v42, v42
v_mfma_f32_16x16x32_bf16 v[84:87], a[96:99], v[172:175], 0
v_exp_f32 v11, v11
v_exp_f32 v27, v27
v_mfma_f32_16x16x32_bf16 v[84:87], a[100:103], v[176:179], v[84:87]
v_exp_f32 v43, v43
v_mfma_f32_16x16x32_bf16 v[84:87], a[104:107], v[180:183], v[84:87]
v_exp_f32 v12, v12
v_mfma_f32_16x16x32_bf16 v[84:87], a[108:111], v[184:187], v[84:87]
v_exp_f32 v28, v28
v_mfma_f32_16x16x32_bf16 v[84:87], a[112:115], v[188:191], v[84:87]
v_exp_f32 v44, v44
v_add_f32 v13, v0, v1
v_add_f32 v29, v16, v17
v_mfma_f32_16x16x32_bf16 v[84:87], a[116:119], v[192:195], v[84:87]
s_waitcnt lgkmcnt(0)
s_barrier
v_add_u32 v252, 24576, v252
v_mfma_f32_16x16x32_bf16 v[76:79], a[24:27], v[196:199], v[76:79]
s_add_u32 m0, s17, 24576
s_mov_b32 s24, 417792
v_mfma_f32_16x16x32_bf16 v[76:79], a[28:31], v[200:203], v[76:79]
ds_read_b128 v[172:175], v252 offset:0
v_add_f32 v45, v32, v33
v_add_f32 v13, v13, v2
v_mfma_f32_16x16x32_bf16 v[76:79], a[32:35], v[204:207], v[76:79]
buffer_load_dwordx4 v251, s[12:15], s24 offen offset:0  lds
v_add_f32 v29, v29, v18
v_mfma_f32_16x16x32_bf16 v[76:79], a[36:39], v[208:211], v[76:79]
ds_read_b128 v[176:179], v252 offset:1024
v_add_f32 v45, v45, v34
v_add_f32 v13, v13, v3
v_mfma_f32_16x16x32_bf16 v[76:79], a[40:43], v[212:215], v[76:79]
v_add_f32 v29, v29, v19
v_add_f32 v45, v45, v35
v_mfma_f32_16x16x32_bf16 v[76:79], a[44:47], v[216:219], v[76:79]
ds_read_b128 v[180:183], v252 offset:2048
v_add_f32 v13, v13, v4
v_mfma_f32_16x16x32_bf16 v[80:83], a[72:75], v[196:199], v[80:83]
buffer_load_dwordx4 v251, s[12:15], s24 offen offset:1024  lds
v_add_f32 v29, v29, v20
v_add_f32 v45, v45, v36
v_mfma_f32_16x16x32_bf16 v[80:83], a[76:79], v[200:203], v[80:83]
ds_read_b128 v[184:187], v252 offset:3072
v_add_f32 v13, v13, v5
v_mfma_f32_16x16x32_bf16 v[80:83], a[80:83], v[204:207], v[80:83]
ds_read_b128 v[120:123], v63 offset:0
v_add_f32 v29, v29, v21
v_add_f32 v45, v45, v37
v_mfma_f32_16x16x32_bf16 v[80:83], a[84:87], v[208:211], v[80:83]
ds_read_b128 v[188:191], v252 offset:4096
ds_read_b128 v[124:127], v63 offset:64
v_mfma_f32_16x16x32_bf16 v[80:83], a[88:91], v[212:215], v[80:83]
buffer_load_dwordx4 v251, s[12:15], s24 offen offset:2048  lds
v_add_f32 v13, v13, v6
v_add_f32 v29, v29, v22
v_mfma_f32_16x16x32_bf16 v[80:83], a[92:95], v[216:219], v[80:83]
ds_read_b128 v[192:195], v252 offset:5120
ds_read_b128 v[128:131], v63 offset:128
v_mfma_f32_16x16x32_bf16 v[84:87], a[120:123], v[196:199], v[84:87]
ds_read_b128 v[132:135], v63 offset:192
v_add_f32 v45, v45, v38
v_add_f32 v13, v13, v7
v_mfma_f32_16x16x32_bf16 v[84:87], a[124:127], v[200:203], v[84:87]
v_cvt_pk_bf16_f32 v112, v76, v77
v_cvt_pk_bf16_f32 v113, v78, v79
v_mfma_f32_16x16x32_bf16 v[84:87], a[128:131], v[204:207], v[84:87]
buffer_load_dwordx4 v251, s[12:15], s24 offen offset:3072  lds
ds_read_b128 v[136:139], v63 offset:256
v_mfma_f32_16x16x32_bf16 v[84:87], a[132:135], v[208:211], v[84:87]
ds_read_b128 v[140:143], v63 offset:320
v_add_f32 v29, v29, v23
v_add_f32 v45, v45, v39
v_mfma_f32_16x16x32_bf16 v[84:87], a[136:139], v[212:215], v[84:87]
s_add_u32 m0, s17, 28672
s_mov_b32 s24, 421888
v_mfma_f32_16x16x32_bf16 v[84:87], a[140:143], v[216:219], v[84:87]
ds_read_b128 v[144:147], v63 offset:384
v_add_f32 v13, v13, v8
v_add_f32 v29, v29, v24
s_waitcnt lgkmcnt(5)
v_mfma_f32_16x16x32_bf16 v[64:67], a[0:3], v[172:175], 0
buffer_load_dwordx4 v251, s[12:15], s24 offen offset:0  lds
ds_read_b128 v[148:151], v63 offset:448
ds_read_b128 v[196:199], v252 offset:6144
v_mfma_f32_16x16x32_bf16 v[64:67], a[4:7], v[176:179], v[64:67]
v_cvt_pk_bf16_f32 v114, v80, v81
v_cvt_pk_bf16_f32 v115, v82, v83
v_mfma_f32_16x16x32_bf16 v[64:67], a[8:11], v[180:183], v[64:67]
ds_read_b128 v[152:155], v63 offset:512
ds_read_b128 v[200:203], v252 offset:7168
v_add_f32 v45, v45, v40
v_mfma_f32_16x16x32_bf16 v[64:67], a[12:15], v[184:187], v[64:67]
ds_read_b128 v[156:159], v63 offset:576
v_add_f32 v13, v13, v9
v_mfma_f32_16x16x32_bf16 v[64:67], a[16:19], v[188:191], v[64:67]
buffer_load_dwordx4 v251, s[12:15], s24 offen offset:1024  lds
ds_read_b128 v[204:207], v252 offset:8192
v_add_f32 v29, v29, v25
v_mfma_f32_16x16x32_bf16 v[64:67], a[20:23], v[192:195], v[64:67]
ds_read_b128 v[160:163], v63 offset:640
v_add_f32 v45, v45, v41
v_mfma_f32_16x16x32_bf16 v[68:71], a[48:51], v[172:175], 0
ds_read_b128 v[164:167], v63 offset:704
ds_read_b128 v[208:211], v252 offset:9216
v_add_f32 v13, v13, v10
v_mfma_f32_16x16x32_bf16 v[68:71], a[52:55], v[176:179], v[68:71]
v_cvt_pk_bf16_f32 v116, v84, v85
v_cvt_pk_bf16_f32 v117, v86, v87
v_mfma_f32_16x16x32_bf16 v[68:71], a[56:59], v[180:183], v[68:71]
ds_read_b128 v[212:215], v252 offset:10240
v_add_f32 v29, v29, v26
v_mfma_f32_16x16x32_bf16 v[68:71], a[60:63], v[184:187], v[68:71]
v_add_f32 v45, v45, v42
v_add_f32 v13, v13, v11
v_add_f32 v29, v29, v27
v_mfma_f32_16x16x32_bf16 v[68:71], a[64:67], v[188:191], v[68:71]
s_waitcnt lgkmcnt(14)
ds_read_b128 v[216:219], v252 offset:11264
v_add_f32 v45, v45, v43
v_mfma_f32_16x16x32_bf16 v[68:71], a[68:71], v[192:195], v[68:71]
v_add_f32 v13, v13, v12
v_add_f32 v29, v29, v28
v_add_f32 v45, v45, v44
v_mfma_f32_16x16x32_bf16 v[72:75], a[96:99], v[172:175], 0
v_mov_b32 v14, v13
v_mov_b32 v30, v29
v_mfma_f32_16x16x32_bf16 v[72:75], a[100:103], v[176:179], v[72:75]
v_mov_b32 v46, v45
v_permlane32_swap_b32 v13, v14
v_permlane32_swap_b32 v29, v30
v_mfma_f32_16x16x32_bf16 v[72:75], a[104:107], v[180:183], v[72:75]
v_permlane32_swap_b32 v45, v46
v_add_f32 v13, v13, v14
v_mfma_f32_16x16x32_bf16 v[72:75], a[108:111], v[184:187], v[72:75]
v_add_f32 v29, v29, v30
v_add_f32 v45, v45, v46
v_mov_b32 v14, v13
v_mfma_f32_16x16x32_bf16 v[72:75], a[112:115], v[188:191], v[72:75]
v_mov_b32 v30, v29
v_mov_b32 v46, v45
v_mfma_f32_16x16x32_bf16 v[72:75], a[116:119], v[192:195], v[72:75]
v_permlane16_swap_b32 v13, v14
v_permlane16_swap_b32 v29, v30
v_mfma_f32_16x16x32_bf16 v[48:51], a[0:3], v[120:123], 0
v_permlane16_swap_b32 v45, v46
v_add_f32 v13, v13, v14
v_add_f32 v29, v29, v30
v_mfma_f32_16x16x32_bf16 v[48:51], a[4:7], v[124:127], v[48:51]
v_add_f32 v45, v45, v46
v_mfma_f32_16x16x32_bf16 v[48:51], a[8:11], v[128:131], v[48:51]
v_rcp_f32 v13, v13
v_rcp_f32 v29, v29
s_waitcnt lgkmcnt(14)
v_mfma_f32_16x16x32_bf16 v[48:51], a[12:15], v[132:135], v[48:51]
v_rcp_f32 v45, v45
s_waitcnt lgkmcnt(13)
v_mfma_f32_16x16x32_bf16 v[48:51], a[16:19], v[136:139], v[48:51]
v_mul_f32 v0, v0, v13
v_mul_f32 v16, v16, v29
v_mul_f32 v32, v32, v45
s_waitcnt lgkmcnt(12)
v_mfma_f32_16x16x32_bf16 v[48:51], a[20:23], v[140:143], v[48:51]
v_mul_f32 v1, v1, v13
v_mul_f32 v17, v17, v29
s_waitcnt lgkmcnt(11)
v_mfma_f32_16x16x32_bf16 v[48:51], a[24:27], v[144:147], v[48:51]
v_mul_f32 v33, v33, v45
v_mul_f32 v2, v2, v13
v_mul_f32 v18, v18, v29
s_waitcnt lgkmcnt(10)
v_mfma_f32_16x16x32_bf16 v[48:51], a[28:31], v[148:151], v[48:51]
v_mul_f32 v34, v34, v45
v_mul_f32 v3, v3, v13
s_waitcnt lgkmcnt(8)
v_mfma_f32_16x16x32_bf16 v[48:51], a[32:35], v[152:155], v[48:51]
v_mul_f32 v19, v19, v29
v_mul_f32 v35, v35, v45
v_mul_f32 v4, v4, v13
s_waitcnt lgkmcnt(6)
v_mfma_f32_16x16x32_bf16 v[48:51], a[36:39], v[156:159], v[48:51]
v_mul_f32 v20, v20, v29
v_mul_f32 v36, v36, v45
s_waitcnt lgkmcnt(4)
v_mfma_f32_16x16x32_bf16 v[48:51], a[40:43], v[160:163], v[48:51]
v_mul_f32 v5, v5, v13
v_mul_f32 v21, v21, v29
s_waitcnt lgkmcnt(3)
v_mfma_f32_16x16x32_bf16 v[48:51], a[44:47], v[164:167], v[48:51]
v_mul_f32 v37, v37, v45
v_mul_f32 v6, v6, v13
v_mul_f32 v22, v22, v29
v_mfma_f32_16x16x32_bf16 v[52:55], a[48:51], v[120:123], 0
v_mul_f32 v38, v38, v45
v_mul_f32 v7, v7, v13
v_mfma_f32_16x16x32_bf16 v[52:55], a[52:55], v[124:127], v[52:55]
v_mul_f32 v23, v23, v29
v_mul_f32 v39, v39, v45
v_mul_f32 v8, v8, v13
v_mfma_f32_16x16x32_bf16 v[52:55], a[56:59], v[128:131], v[52:55]
v_mul_f32 v24, v24, v29
v_mul_f32 v40, v40, v45
v_mfma_f32_16x16x32_bf16 v[52:55], a[60:63], v[132:135], v[52:55]
v_mul_f32 v9, v9, v13
v_mul_f32 v25, v25, v29
v_mul_f32 v41, v41, v45
v_mfma_f32_16x16x32_bf16 v[52:55], a[64:67], v[136:139], v[52:55]
v_mul_f32 v10, v10, v13
v_mul_f32 v26, v26, v29
v_mfma_f32_16x16x32_bf16 v[52:55], a[68:71], v[140:143], v[52:55]
v_mul_f32 v42, v42, v45
v_mul_f32 v11, v11, v13
v_mul_f32 v27, v27, v29
v_mfma_f32_16x16x32_bf16 v[52:55], a[72:75], v[144:147], v[52:55]
v_mul_f32 v43, v43, v45
v_mul_f32 v12, v12, v13
v_mfma_f32_16x16x32_bf16 v[52:55], a[76:79], v[148:151], v[52:55]
v_mul_f32 v28, v28, v29
v_mul_f32 v44, v44, v45
v_mfma_f32_16x16x32_bf16 v[52:55], a[80:83], v[152:155], v[52:55]
v_cvt_pk_bf16_f32 v0, v0, v1
v_cvt_pk_bf16_f32 v16, v16, v17
v_cvt_pk_bf16_f32 v32, v32, v33
v_mfma_f32_16x16x32_bf16 v[52:55], a[84:87], v[156:159], v[52:55]
v_cvt_pk_bf16_f32 v1, v2, v3
v_cvt_pk_bf16_f32 v17, v18, v19
v_mfma_f32_16x16x32_bf16 v[52:55], a[88:91], v[160:163], v[52:55]
v_cvt_pk_bf16_f32 v33, v34, v35
v_cvt_pk_bf16_f32 v2, v4, v5
v_cvt_pk_bf16_f32 v18, v20, v21
v_mfma_f32_16x16x32_bf16 v[52:55], a[92:95], v[164:167], v[52:55]
v_cvt_pk_bf16_f32 v34, v36, v37
v_cvt_pk_bf16_f32 v3, v6, v7
v_mfma_f32_16x16x32_bf16 v[56:59], a[96:99], v[120:123], 0
v_cvt_pk_bf16_f32 v19, v22, v23
v_cvt_pk_bf16_f32 v35, v38, v39
v_cvt_pk_bf16_f32 v4, v8, v9
v_mfma_f32_16x16x32_bf16 v[56:59], a[100:103], v[124:127], v[56:59]
v_cvt_pk_bf16_f32 v20, v24, v25
v_cvt_pk_bf16_f32 v36, v40, v41
v_mfma_f32_16x16x32_bf16 v[56:59], a[104:107], v[128:131], v[56:59]
v_cvt_pk_bf16_f32 v5, v10, v11
v_cvt_pk_bf16_f32 v21, v26, v27
v_cvt_pk_bf16_f32 v37, v42, v43
v_mfma_f32_16x16x32_bf16 v[56:59], a[108:111], v[132:135], v[56:59]
v_cvt_pk_bf16_f32 v6, v12, 0
v_cvt_pk_bf16_f32 v22, v28, 0
v_mfma_f32_16x16x32_bf16 v[56:59], a[112:115], v[136:139], v[56:59]
v_cvt_pk_bf16_f32 v38, v44, 0
v_mov_b32 v7, 0
v_mov_b32 v23, 0
v_mfma_f32_16x16x32_bf16 v[56:59], a[116:119], v[140:143], v[56:59]
v_mov_b32 v39, 0
v_mfma_f32_16x16x32_bf16 v[56:59], a[120:123], v[144:147], v[56:59]
v_mfma_f32_16x16x32_bf16 v[56:59], a[124:127], v[148:151], v[56:59]
v_mfma_f32_16x16x32_bf16 v[56:59], a[128:131], v[152:155], v[56:59]
v_mfma_f32_16x16x32_bf16 v[56:59], a[132:135], v[156:159], v[56:59]
v_mfma_f32_16x16x32_bf16 v[56:59], a[136:139], v[160:163], v[56:59]
v_mfma_f32_16x16x32_bf16 v[56:59], a[140:143], v[164:167], v[56:59]
s_waitcnt lgkmcnt(0)
v_mfma_f32_16x16x32_bf16 v[64:67], a[24:27], v[196:199], v[64:67]
ds_read_b128 v[172:175], v252 offset:12288
v_mfma_f32_16x16x32_bf16 v[64:67], a[28:31], v[200:203], v[64:67]
ds_read_u16 v94, v254 offset:0
v_mfma_f32_16x16x32_bf16 v[64:67], a[32:35], v[204:207], v[64:67]
ds_read_b128 v[176:179], v252 offset:13312
v_mfma_f32_16x16x32_bf16 v[64:67], a[36:39], v[208:211], v[64:67]
v_mfma_f32_16x16x32_bf16 v[64:67], a[40:43], v[212:215], v[64:67]
ds_read_b128 v[180:183], v252 offset:14336
v_mfma_f32_16x16x32_bf16 v[64:67], a[44:47], v[216:219], v[64:67]
ds_read_u16 v102, v254 offset:8
v_mfma_f32_16x16x32_bf16 v[68:71], a[72:75], v[196:199], v[68:71]
ds_read_b128 v[184:187], v252 offset:15360
v_mfma_f32_16x16x32_bf16 v[68:71], a[76:79], v[200:203], v[68:71]
v_max3_f32 v61, v48, v49, v50
v_max3_f32 v61, v61, v51, v52
v_max3_f32 v61, v61, v53, v54
v_mfma_f32_16x16x32_bf16 v[68:71], a[80:83], v[204:207], v[68:71]
ds_read_b128 v[188:191], v252 offset:16384
v_max3_f32 v61, v61, v55, v56
v_max3_f32 v61, v61, v57, v58
v_mfma_f32_16x16x32_bf16 v[68:71], a[84:87], v[208:211], v[68:71]
ds_read_u16 v110, v254 offset:64
v_mov_b32 v153, 0
v_mfma_f32_16x16x32_bf16 v[68:71], a[88:91], v[212:215], v[68:71]
ds_read_b128 v[192:195], v252 offset:17408
v_max3_f32 v61, v61, v59, v60
v_mov_b32 v62, v61
v_mfma_f32_16x16x32_bf16 v[68:71], a[92:95], v[216:219], v[68:71]
s_nop 0
v_permlane32_swap_b32 v61, v62
v_max_f32 v61, v61, v62
v_mfma_f32_16x16x32_bf16 v[72:75], a[120:123], v[196:199], v[72:75]
v_mov_b32 v62, v61
s_nop 1
v_permlane16_swap_b32 v61, v62
v_max_f32 v61, v61, v62
v_mfma_f32_16x16x32_bf16 v[72:75], a[124:127], v[200:203], v[72:75]
ds_read_u16 v118, v254 offset:72
v_cvt_pk_bf16_f32 v146, v64, v65
v_cvt_pk_bf16_f32 v147, v66, v67
v_mov_b32 v161, 0
v_mfma_f32_16x16x32_bf16 v[72:75], a[128:131], v[204:207], v[72:75]
v_mul_f32 v61, s27, v61
v_fma_f32 v48, v48, s26, v61
v_mfma_f32_16x16x32_bf16 v[72:75], a[132:135], v[208:211], v[72:75]
v_fma_f32 v49, v49, s26, v61
v_fma_f32 v50, v50, s26, v61
v_fma_f32 v51, v51, s26, v61
v_mfma_f32_16x16x32_bf16 v[72:75], a[136:139], v[212:215], v[72:75]
v_fma_f32 v52, v52, s26, v61
v_fma_f32 v53, v53, s26, v61
v_mfma_f32_16x16x32_bf16 v[72:75], a[140:143], v[216:219], v[72:75]
s_waitcnt lgkmcnt(1)
ds_read_u16 v152, v254 offset:128
v_mfma_f32_16x16x32_bf16 v[76:79], a[0:3], v[172:175], 0
ds_read_b128 v[196:199], v252 offset:18432
v_fma_f32 v54, v54, s26, v61
v_fma_f32 v55, v55, s26, v61
v_mfma_f32_16x16x32_bf16 v[76:79], a[4:7], v[176:179], v[76:79]
v_cvt_pk_bf16_f32 v148, v68, v69
v_cvt_pk_bf16_f32 v149, v70, v71
v_mfma_f32_16x16x32_bf16 v[76:79], a[8:11], v[180:183], v[76:79]
ds_read_b128 v[200:203], v252 offset:19456
v_fma_f32 v56, v56, s26, v61
v_fma_f32 v57, v57, s26, v61
v_mfma_f32_16x16x32_bf16 v[76:79], a[12:15], v[184:187], v[76:79]
ds_read_u16 v160, v254 offset:136
v_fma_f32 v58, v58, s26, v61
v_mfma_f32_16x16x32_bf16 v[76:79], a[16:19], v[188:191], v[76:79]
ds_read_b128 v[204:207], v252 offset:20480
v_fma_f32 v59, v59, s26, v61
v_fma_f32 v60, v60, s26, v61
v_mfma_f32_16x16x32_bf16 v[76:79], a[20:23], v[192:195], v[76:79]
v_exp_f32 v48, v48
v_mfma_f32_16x16x32_bf16 v[80:83], a[48:51], v[172:175], 0
ds_read_b128 v[208:211], v252 offset:21504
v_exp_f32 v49, v49
v_mfma_f32_16x16x32_bf16 v[80:83], a[52:55], v[176:179], v[80:83]
v_cvt_pk_bf16_f32 v150, v72, v73
v_cvt_pk_bf16_f32 v151, v74, v75
v_mfma_f32_16x16x32_bf16 v[80:83], a[56:59], v[180:183], v[80:83]
ds_read_b128 v[212:215], v252 offset:22528
v_exp_f32 v50, v50
v_mfma_f32_16x16x32_bf16 v[80:83], a[60:63], v[184:187], v[80:83]
v_exp_f32 v51, v51
v_mfma_f32_16x16x32_bf16 v[80:83], a[64:67], v[188:191], v[80:83]
ds_read_b128 v[216:219], v252 offset:23552
v_mfma_f32_16x16x32_bf16 v[80:83], a[68:71], v[192:195], v[80:83]
v_exp_f32 v52, v52
v_exp_f32 v53, v53
v_mfma_f32_16x16x32_bf16 v[84:87], a[96:99], v[172:175], 0
v_exp_f32 v54, v54
v_mfma_f32_16x16x32_bf16 v[84:87], a[100:103], v[176:179], v[84:87]
v_exp_f32 v55, v55
v_mfma_f32_16x16x32_bf16 v[84:87], a[104:107], v[180:183], v[84:87]
v_exp_f32 v56, v56
v_mfma_f32_16x16x32_bf16 v[84:87], a[108:111], v[184:187], v[84:87]
v_exp_f32 v57, v57
v_exp_f32 v58, v58
v_mfma_f32_16x16x32_bf16 v[84:87], a[112:115], v[188:191], v[84:87]
v_exp_f32 v59, v59
v_mfma_f32_16x16x32_bf16 v[84:87], a[116:119], v[192:195], v[84:87]
s_waitcnt vmcnt(13) lgkmcnt(0)
s_barrier
v_add_u32 v252, 24576, v252
v_mfma_f32_16x16x32_bf16 v[76:79], a[24:27], v[196:199], v[76:79]
s_add_u32 m0, s17, 49152
s_mov_b32 s24, 442368
v_mfma_f32_16x16x32_bf16 v[76:79], a[28:31], v[200:203], v[76:79]
ds_read_b128 v[172:175], v252 offset:0
v_exp_f32 v60, v60
v_mfma_f32_16x16x32_bf16 v[76:79], a[32:35], v[204:207], v[76:79]
buffer_load_dwordx4 v251, s[12:15], s24 offen offset:0  lds
v_add_f32 v61, v48, v49
v_mfma_f32_16x16x32_bf16 v[76:79], a[36:39], v[208:211], v[76:79]
ds_read_b128 v[176:179], v252 offset:1024
v_add_f32 v61, v61, v50
v_add_f32 v61, v61, v51
v_mfma_f32_16x16x32_bf16 v[76:79], a[40:43], v[212:215], v[76:79]
v_add_f32 v61, v61, v52
v_add_f32 v61, v61, v53
v_mfma_f32_16x16x32_bf16 v[76:79], a[44:47], v[216:219], v[76:79]
ds_read_b128 v[180:183], v252 offset:2048
v_add_f32 v61, v61, v54
v_add_f32 v61, v61, v55
v_mfma_f32_16x16x32_bf16 v[80:83], a[72:75], v[196:199], v[80:83]
buffer_load_dwordx4 v251, s[12:15], s24 offen offset:1024  lds
v_add_f32 v61, v61, v56
v_mfma_f32_16x16x32_bf16 v[80:83], a[76:79], v[200:203], v[80:83]
ds_read_b128 v[184:187], v252 offset:3072
v_add_f32 v61, v61, v57
v_add_f32 v61, v61, v58
v_mfma_f32_16x16x32_bf16 v[80:83], a[80:83], v[204:207], v[80:83]
v_add_f32 v61, v61, v59
v_add_f32 v61, v61, v60
v_mfma_f32_16x16x32_bf16 v[80:83], a[84:87], v[208:211], v[80:83]
ds_read_b128 v[188:191], v252 offset:4096
v_mov_b32 v62, v61
s_nop 1
v_permlane32_swap_b32 v61, v62
v_mfma_f32_16x16x32_bf16 v[80:83], a[88:91], v[212:215], v[80:83]
buffer_load_dwordx4 v251, s[12:15], s24 offen offset:2048  lds
v_add_f32 v61, v61, v62
v_mfma_f32_16x16x32_bf16 v[80:83], a[92:95], v[216:219], v[80:83]
ds_read_b128 v[192:195], v252 offset:5120
v_mov_b32 v62, v61
s_nop 1
v_permlane16_swap_b32 v61, v62
v_mfma_f32_16x16x32_bf16 v[84:87], a[120:123], v[196:199], v[84:87]
v_add_f32 v61, v61, v62
v_mfma_f32_16x16x32_bf16 v[84:87], a[124:127], v[200:203], v[84:87]
v_cvt_pk_bf16_f32 v154, v76, v77
v_cvt_pk_bf16_f32 v155, v78, v79
v_mfma_f32_16x16x32_bf16 v[84:87], a[128:131], v[204:207], v[84:87]
buffer_load_dwordx4 v251, s[12:15], s24 offen offset:3072  lds
v_rcp_f32 v61, v61
s_nop 0
v_cndmask_b32 v61, 0, v61, vcc
v_mfma_f32_16x16x32_bf16 v[84:87], a[132:135], v[208:211], v[84:87]
v_mul_f32 v48, v48, v61
v_mul_f32 v49, v49, v61
v_mfma_f32_16x16x32_bf16 v[84:87], a[136:139], v[212:215], v[84:87]
s_add_u32 m0, s17, 53248
s_mov_b32 s24, 446464
v_mul_f32 v50, v50, v61
v_mfma_f32_16x16x32_bf16 v[84:87], a[140:143], v[216:219], v[84:87]
v_mul_f32 v51, v51, v61
v_mul_f32 v52, v52, v61
v_mul_f32 v53, v53, v61
v_mul_f32 v54, v54, v61
v_mul_f32 v55, v55, v61
v_mul_f32 v56, v56, v61
v_mul_f32 v57, v57, v61
v_mul_f32 v58, v58, v61
v_mul_f32 v59, v59, v61
v_mul_f32 v60, v60, v61
v_cvt_pk_bf16_f32 v48, v48, v49
v_cvt_pk_bf16_f32 v49, v50, v51
v_cvt_pk_bf16_f32 v50, v52, v53
v_cvt_pk_bf16_f32 v51, v54, v55
v_cvt_pk_bf16_f32 v52, v56, v57
v_cvt_pk_bf16_f32 v53, v58, v59
v_cvt_pk_bf16_f32 v54, v60, 0
v_mov_b32 v55, 0
v_mfma_f32_16x16x32_bf16 v[8:11], v[0:3], v[88:91], 0
buffer_load_dwordx4 v251, s[12:15], s24 offen offset:0  lds
v_mfma_f32_16x16x32_bf16 v[8:11], v[4:7], v[92:95], v[8:11]
v_cvt_pk_bf16_f32 v156, v80, v81
v_cvt_pk_bf16_f32 v157, v82, v83
v_mfma_f32_16x16x32_bf16 v[24:27], v[16:19], v[88:91], 0
v_mfma_f32_16x16x32_bf16 v[24:27], v[20:23], v[92:95], v[24:27]
v_mfma_f32_16x16x32_bf16 v[40:43], v[32:35], v[88:91], 0
buffer_load_dwordx4 v251, s[12:15], s24 offen offset:1024  lds
v_mfma_f32_16x16x32_bf16 v[40:43], v[36:39], v[92:95], v[40:43]
v_mfma_f32_16x16x32_bf16 v[56:59], v[48:51], v[88:91], 0
v_mfma_f32_16x16x32_bf16 v[56:59], v[52:55], v[92:95], v[56:59]
v_cvt_pk_bf16_f32 v158, v84, v85
v_cvt_pk_bf16_f32 v159, v86, v87
v_mfma_f32_16x16x32_bf16 v[12:15], v[0:3], v[96:99], 0
v_mfma_f32_16x16x32_bf16 v[12:15], v[4:7], v[100:103], v[12:15]
v_mfma_f32_16x16x32_bf16 v[28:31], v[16:19], v[96:99], 0
v_mfma_f32_16x16x32_bf16 v[28:31], v[20:23], v[100:103], v[28:31]
v_mfma_f32_16x16x32_bf16 v[44:47], v[32:35], v[96:99], 0
v_mfma_f32_16x16x32_bf16 v[44:47], v[36:39], v[100:103], v[44:47]
v_mfma_f32_16x16x32_bf16 v[60:63], v[48:51], v[96:99], 0
v_mfma_f32_16x16x32_bf16 v[60:63], v[52:55], v[100:103], v[60:63]
s_waitcnt lgkmcnt(0)
v_mfma_f32_16x16x32_bf16 v[64:67], a[0:3], v[172:175], 0
ds_read_b128 v[196:199], v252 offset:6144
v_mfma_f32_16x16x32_bf16 v[64:67], a[4:7], v[176:179], v[64:67]
v_cvt_pk_bf16_f32 v120, v8, v12
v_cvt_pk_bf16_f32 v122, v9, v13
v_mfma_f32_16x16x32_bf16 v[64:67], a[8:11], v[180:183], v[64:67]
v_cvt_pk_bf16_f32 v124, v10, v14
v_cvt_pk_bf16_f32 v126, v11, v15
ds_read_b128 v[200:203], v252 offset:7168
v_mfma_f32_16x16x32_bf16 v[64:67], a[12:15], v[184:187], v[64:67]
v_cvt_pk_bf16_f32 v128, v24, v28
v_cvt_pk_bf16_f32 v130, v25, v29
v_mfma_f32_16x16x32_bf16 v[64:67], a[16:19], v[188:191], v[64:67]
v_cvt_pk_bf16_f32 v132, v26, v30
v_cvt_pk_bf16_f32 v134, v27, v31
ds_read_b128 v[204:207], v252 offset:8192
v_mfma_f32_16x16x32_bf16 v[64:67], a[20:23], v[192:195], v[64:67]
v_cvt_pk_bf16_f32 v136, v40, v44
v_cvt_pk_bf16_f32 v138, v41, v45
v_mfma_f32_16x16x32_bf16 v[68:71], a[48:51], v[172:175], 0
v_cvt_pk_bf16_f32 v140, v42, v46
v_cvt_pk_bf16_f32 v142, v43, v47
ds_read_b128 v[208:211], v252 offset:9216
v_mfma_f32_16x16x32_bf16 v[68:71], a[52:55], v[176:179], v[68:71]
v_cvt_pk_bf16_f32 v144, v56, v60
v_mfma_f32_16x16x32_bf16 v[68:71], a[56:59], v[180:183], v[68:71]
ds_read_b128 v[212:215], v252 offset:10240
v_mfma_f32_16x16x32_bf16 v[68:71], a[60:63], v[184:187], v[68:71]
v_mfma_f32_16x16x32_bf16 v[68:71], a[64:67], v[188:191], v[68:71]
ds_read_b128 v[216:219], v252 offset:11264
v_mfma_f32_16x16x32_bf16 v[68:71], a[68:71], v[192:195], v[68:71]
v_mfma_f32_16x16x32_bf16 v[72:75], a[96:99], v[172:175], 0
v_mfma_f32_16x16x32_bf16 v[72:75], a[100:103], v[176:179], v[72:75]
v_mfma_f32_16x16x32_bf16 v[72:75], a[104:107], v[180:183], v[72:75]
v_mfma_f32_16x16x32_bf16 v[72:75], a[108:111], v[184:187], v[72:75]
v_mfma_f32_16x16x32_bf16 v[72:75], a[112:115], v[188:191], v[72:75]
v_mfma_f32_16x16x32_bf16 v[72:75], a[116:119], v[192:195], v[72:75]
v_mfma_f32_16x16x32_bf16 v[8:11], v[0:3], v[104:107], 0
v_mfma_f32_16x16x32_bf16 v[8:11], v[4:7], v[108:111], v[8:11]
v_mfma_f32_16x16x32_bf16 v[24:27], v[16:19], v[104:107], 0
v_mfma_f32_16x16x32_bf16 v[24:27], v[20:23], v[108:111], v[24:27]
v_mfma_f32_16x16x32_bf16 v[40:43], v[32:35], v[104:107], 0
v_mfma_f32_16x16x32_bf16 v[40:43], v[36:39], v[108:111], v[40:43]
v_mfma_f32_16x16x32_bf16 v[56:59], v[48:51], v[104:107], 0
v_mfma_f32_16x16x32_bf16 v[56:59], v[52:55], v[108:111], v[56:59]
v_mfma_f32_16x16x32_bf16 v[12:15], v[0:3], v[112:115], 0
v_mfma_f32_16x16x32_bf16 v[12:15], v[4:7], v[116:119], v[12:15]
v_mfma_f32_16x16x32_bf16 v[28:31], v[16:19], v[112:115], 0
v_mfma_f32_16x16x32_bf16 v[28:31], v[20:23], v[116:119], v[28:31]
v_mfma_f32_16x16x32_bf16 v[44:47], v[32:35], v[112:115], 0
v_mfma_f32_16x16x32_bf16 v[44:47], v[36:39], v[116:119], v[44:47]
v_mfma_f32_16x16x32_bf16 v[60:63], v[48:51], v[112:115], 0
v_mfma_f32_16x16x32_bf16 v[60:63], v[52:55], v[116:119], v[60:63]
s_waitcnt lgkmcnt(0)
v_mfma_f32_16x16x32_bf16 v[64:67], a[24:27], v[196:199], v[64:67]
ds_read_b128 v[172:175], v252 offset:12288
v_mfma_f32_16x16x32_bf16 v[64:67], a[28:31], v[200:203], v[64:67]
v_cvt_pk_bf16_f32 v121, v8, v12
v_cvt_pk_bf16_f32 v123, v9, v13
v_mfma_f32_16x16x32_bf16 v[64:67], a[32:35], v[204:207], v[64:67]
ds_read_b128 v[176:179], v252 offset:13312
v_cvt_pk_bf16_f32 v125, v10, v14
v_cvt_pk_bf16_f32 v127, v11, v15
v_mfma_f32_16x16x32_bf16 v[64:67], a[36:39], v[208:211], v[64:67]
v_cvt_pk_bf16_f32 v129, v24, v28
v_cvt_pk_bf16_f32 v131, v25, v29
v_mfma_f32_16x16x32_bf16 v[64:67], a[40:43], v[212:215], v[64:67]
ds_read_b128 v[180:183], v252 offset:14336
v_cvt_pk_bf16_f32 v133, v26, v30
v_cvt_pk_bf16_f32 v135, v27, v31
v_mfma_f32_16x16x32_bf16 v[64:67], a[44:47], v[216:219], v[64:67]
v_cvt_pk_bf16_f32 v137, v40, v44
v_cvt_pk_bf16_f32 v139, v41, v45
v_mfma_f32_16x16x32_bf16 v[68:71], a[72:75], v[196:199], v[68:71]
ds_read_b128 v[184:187], v252 offset:15360
v_cvt_pk_bf16_f32 v141, v42, v46
v_cvt_pk_bf16_f32 v143, v43, v47
v_mfma_f32_16x16x32_bf16 v[68:71], a[76:79], v[200:203], v[68:71]
ds_read_u16 v94, v254 offset:192
v_cvt_pk_bf16_f32 v145, v56, v60
v_mfma_f32_16x16x32_bf16 v[68:71], a[80:83], v[204:207], v[68:71]
ds_read_b128 v[188:191], v252 offset:16384
v_mfma_f32_16x16x32_bf16 v[68:71], a[84:87], v[208:211], v[68:71]
buffer_store_dwordx2 v[120:121], v239, s[8:11], s21 offen offset:0 sc1
v_mfma_f32_16x16x32_bf16 v[68:71], a[88:91], v[212:215], v[68:71]
ds_read_b128 v[192:195], v252 offset:17408
v_mfma_f32_16x16x32_bf16 v[68:71], a[92:95], v[216:219], v[68:71]
ds_read_u16 v102, v254 offset:200
v_mfma_f32_16x16x32_bf16 v[72:75], a[120:123], v[196:199], v[72:75]
v_mfma_f32_16x16x32_bf16 v[72:75], a[124:127], v[200:203], v[72:75]
v_cvt_pk_bf16_f32 v88, v64, v65
v_cvt_pk_bf16_f32 v89, v66, v67
v_mfma_f32_16x16x32_bf16 v[72:75], a[128:131], v[204:207], v[72:75]
v_mfma_f32_16x16x32_bf16 v[72:75], a[132:135], v[208:211], v[72:75]
v_mfma_f32_16x16x32_bf16 v[72:75], a[136:139], v[212:215], v[72:75]
v_mfma_f32_16x16x32_bf16 v[72:75], a[140:143], v[216:219], v[72:75]
v_mfma_f32_16x16x32_bf16 v[8:11], v[0:3], v[146:149], 0
v_mfma_f32_16x16x32_bf16 v[8:11], v[4:7], v[150:153], v[8:11]
v_cvt_pk_bf16_f32 v90, v68, v69
v_cvt_pk_bf16_f32 v91, v70, v71
v_mfma_f32_16x16x32_bf16 v[24:27], v[16:19], v[146:149], 0
v_mfma_f32_16x16x32_bf16 v[24:27], v[20:23], v[150:153], v[24:27]
buffer_store_dwordx2 v[122:123], v240, s[8:11], s21 offen offset:0 sc1
v_mfma_f32_16x16x32_bf16 v[40:43], v[32:35], v[146:149], 0
v_mfma_f32_16x16x32_bf16 v[40:43], v[36:39], v[150:153], v[40:43]
v_mfma_f32_16x16x32_bf16 v[56:59], v[48:51], v[146:149], 0
v_mfma_f32_16x16x32_bf16 v[56:59], v[52:55], v[150:153], v[56:59]
v_cvt_pk_bf16_f32 v92, v72, v73
v_cvt_pk_bf16_f32 v93, v74, v75
v_mfma_f32_16x16x32_bf16 v[12:15], v[0:3], v[154:157], 0
v_mfma_f32_16x16x32_bf16 v[12:15], v[4:7], v[158:161], v[12:15]
v_mfma_f32_16x16x32_bf16 v[28:31], v[16:19], v[154:157], 0
v_mfma_f32_16x16x32_bf16 v[28:31], v[20:23], v[158:161], v[28:31]
v_mfma_f32_16x16x32_bf16 v[44:47], v[32:35], v[154:157], 0
v_mfma_f32_16x16x32_bf16 v[44:47], v[36:39], v[158:161], v[44:47]
v_mfma_f32_16x16x32_bf16 v[60:63], v[48:51], v[154:157], 0
v_mfma_f32_16x16x32_bf16 v[60:63], v[52:55], v[158:161], v[60:63]
s_waitcnt lgkmcnt(1)
buffer_store_dwordx2 v[124:125], v241, s[8:11], s21 offen offset:0 sc1
v_mfma_f32_16x16x32_bf16 v[76:79], a[0:3], v[172:175], 0
ds_read_b128 v[196:199], v252 offset:18432
v_mfma_f32_16x16x32_bf16 v[76:79], a[4:7], v[176:179], v[76:79]
v_cvt_pk_bf16_f32 v146, v8, v12
v_cvt_pk_bf16_f32 v148, v9, v13
v_mfma_f32_16x16x32_bf16 v[76:79], a[8:11], v[180:183], v[76:79]
ds_read_b128 v[200:203], v252 offset:19456
v_cvt_pk_bf16_f32 v150, v10, v14
v_cvt_pk_bf16_f32 v152, v11, v15
v_mfma_f32_16x16x32_bf16 v[76:79], a[12:15], v[184:187], v[76:79]
v_cvt_pk_bf16_f32 v154, v24, v28
v_cvt_pk_bf16_f32 v156, v25, v29
v_mfma_f32_16x16x32_bf16 v[76:79], a[16:19], v[188:191], v[76:79]
ds_read_b128 v[204:207], v252 offset:20480
v_cvt_pk_bf16_f32 v158, v26, v30
v_cvt_pk_bf16_f32 v160, v27, v31
v_mfma_f32_16x16x32_bf16 v[76:79], a[20:23], v[192:195], v[76:79]
v_cvt_pk_bf16_f32 v162, v40, v44
v_cvt_pk_bf16_f32 v164, v41, v45
v_mfma_f32_16x16x32_bf16 v[80:83], a[48:51], v[172:175], 0
ds_read_b128 v[208:211], v252 offset:21504
v_cvt_pk_bf16_f32 v166, v42, v46
v_cvt_pk_bf16_f32 v168, v43, v47
v_mfma_f32_16x16x32_bf16 v[80:83], a[52:55], v[176:179], v[80:83]
v_cvt_pk_bf16_f32 v170, v56, v60
v_mfma_f32_16x16x32_bf16 v[80:83], a[56:59], v[180:183], v[80:83]
ds_read_b128 v[212:215], v252 offset:22528
v_mfma_f32_16x16x32_bf16 v[80:83], a[60:63], v[184:187], v[80:83]
v_mfma_f32_16x16x32_bf16 v[80:83], a[64:67], v[188:191], v[80:83]
ds_read_b128 v[216:219], v252 offset:23552
v_mfma_f32_16x16x32_bf16 v[80:83], a[68:71], v[192:195], v[80:83]
buffer_store_dwordx2 v[126:127], v242, s[8:11], s21 offen offset:0 sc1
v_mfma_f32_16x16x32_bf16 v[84:87], a[96:99], v[172:175], 0
v_mfma_f32_16x16x32_bf16 v[84:87], a[100:103], v[176:179], v[84:87]
v_mfma_f32_16x16x32_bf16 v[84:87], a[104:107], v[180:183], v[84:87]
v_mfma_f32_16x16x32_bf16 v[84:87], a[108:111], v[184:187], v[84:87]
v_mfma_f32_16x16x32_bf16 v[84:87], a[112:115], v[188:191], v[84:87]
v_mfma_f32_16x16x32_bf16 v[84:87], a[116:119], v[192:195], v[84:87]
s_waitcnt vmcnt(17) lgkmcnt(0)
s_barrier
v_add_u32 v252, 4294893568, v252
v_mfma_f32_16x16x32_bf16 v[76:79], a[24:27], v[196:199], v[76:79]
s_add_u32 m0, s17, 73728
s_mov_b32 s24, 466944
v_mfma_f32_16x16x32_bf16 v[76:79], a[28:31], v[200:203], v[76:79]
ds_read_b128 v[172:175], v252 offset:0
v_mfma_f32_16x16x32_bf16 v[76:79], a[32:35], v[204:207], v[76:79]
buffer_load_dwordx4 v251, s[12:15], s24 offen offset:0  lds
v_mfma_f32_16x16x32_bf16 v[76:79], a[36:39], v[208:211], v[76:79]
ds_read_b128 v[176:179], v252 offset:1024
v_mfma_f32_16x16x32_bf16 v[76:79], a[40:43], v[212:215], v[76:79]
v_mfma_f32_16x16x32_bf16 v[76:79], a[44:47], v[216:219], v[76:79]
ds_read_b128 v[180:183], v252 offset:2048
buffer_store_dwordx2 v[128:129], v243, s[8:11], s21 offen offset:0 sc1
v_mfma_f32_16x16x32_bf16 v[80:83], a[72:75], v[196:199], v[80:83]
buffer_load_dwordx4 v251, s[12:15], s24 offen offset:1024  lds
v_mfma_f32_16x16x32_bf16 v[80:83], a[76:79], v[200:203], v[80:83]
ds_read_b128 v[184:187], v252 offset:3072
v_mfma_f32_16x16x32_bf16 v[80:83], a[80:83], v[204:207], v[80:83]
v_mfma_f32_16x16x32_bf16 v[80:83], a[84:87], v[208:211], v[80:83]
ds_read_b128 v[188:191], v252 offset:4096
v_mfma_f32_16x16x32_bf16 v[80:83], a[88:91], v[212:215], v[80:83]
buffer_load_dwordx4 v251, s[12:15], s24 offen offset:2048  lds
v_mfma_f32_16x16x32_bf16 v[80:83], a[92:95], v[216:219], v[80:83]
ds_read_b128 v[192:195], v252 offset:5120
v_mfma_f32_16x16x32_bf16 v[84:87], a[120:123], v[196:199], v[84:87]
v_mfma_f32_16x16x32_bf16 v[84:87], a[124:127], v[200:203], v[84:87]
v_cvt_pk_bf16_f32 v96, v76, v77
v_cvt_pk_bf16_f32 v97, v78, v79
v_mfma_f32_16x16x32_bf16 v[84:87], a[128:131], v[204:207], v[84:87]
buffer_load_dwordx4 v251, s[12:15], s24 offen offset:3072  lds
v_mfma_f32_16x16x32_bf16 v[84:87], a[132:135], v[208:211], v[84:87]
v_mfma_f32_16x16x32_bf16 v[84:87], a[136:139], v[212:215], v[84:87]
s_add_u32 m0, s17, 77824
s_mov_b32 s24, 471040
v_mfma_f32_16x16x32_bf16 v[84:87], a[140:143], v[216:219], v[84:87]
buffer_store_dwordx2 v[130:131], v244, s[8:11], s21 offen offset:0 sc1
v_mfma_f32_16x16x32_bf16 v[8:11], v[0:3], v[88:91], 0
buffer_load_dwordx4 v251, s[12:15], s24 offen offset:0  lds
v_mfma_f32_16x16x32_bf16 v[8:11], v[4:7], v[92:95], v[8:11]
v_cvt_pk_bf16_f32 v98, v80, v81
v_cvt_pk_bf16_f32 v99, v82, v83
v_mfma_f32_16x16x32_bf16 v[24:27], v[16:19], v[88:91], 0
v_mfma_f32_16x16x32_bf16 v[24:27], v[20:23], v[92:95], v[24:27]
v_mfma_f32_16x16x32_bf16 v[40:43], v[32:35], v[88:91], 0
buffer_load_dwordx4 v251, s[12:15], s24 offen offset:1024  lds
v_mfma_f32_16x16x32_bf16 v[40:43], v[36:39], v[92:95], v[40:43]
v_mfma_f32_16x16x32_bf16 v[56:59], v[48:51], v[88:91], 0
v_mfma_f32_16x16x32_bf16 v[56:59], v[52:55], v[92:95], v[56:59]
v_cvt_pk_bf16_f32 v100, v84, v85
v_cvt_pk_bf16_f32 v101, v86, v87
v_mfma_f32_16x16x32_bf16 v[12:15], v[0:3], v[96:99], 0
s_nop 0
v_mfma_f32_16x16x32_bf16 v[12:15], v[4:7], v[100:103], v[12:15]
v_mfma_f32_16x16x32_bf16 v[28:31], v[16:19], v[96:99], 0
v_mfma_f32_16x16x32_bf16 v[28:31], v[20:23], v[100:103], v[28:31]
buffer_store_dwordx2 v[132:133], v245, s[8:11], s21 offen offset:0 sc1
v_mfma_f32_16x16x32_bf16 v[44:47], v[32:35], v[96:99], 0
v_mfma_f32_16x16x32_bf16 v[44:47], v[36:39], v[100:103], v[44:47]
v_mfma_f32_16x16x32_bf16 v[60:63], v[48:51], v[96:99], 0
v_mfma_f32_16x16x32_bf16 v[60:63], v[52:55], v[100:103], v[60:63]
s_waitcnt lgkmcnt(0)
v_mfma_f32_16x16x32_bf16 v[64:67], a[0:3], v[172:175], 0
ds_read_b128 v[196:199], v252 offset:6144
v_mfma_f32_16x16x32_bf16 v[64:67], a[4:7], v[176:179], v[64:67]
v_cvt_pk_bf16_f32 v147, v8, v12
v_cvt_pk_bf16_f32 v149, v9, v13
v_mfma_f32_16x16x32_bf16 v[64:67], a[8:11], v[180:183], v[64:67]
v_cvt_pk_bf16_f32 v151, v10, v14
v_cvt_pk_bf16_f32 v153, v11, v15
ds_read_b128 v[200:203], v252 offset:7168
v_mfma_f32_16x16x32_bf16 v[64:67], a[12:15], v[184:187], v[64:67]
v_cvt_pk_bf16_f32 v155, v24, v28
v_cvt_pk_bf16_f32 v157, v25, v29
v_mfma_f32_16x16x32_bf16 v[64:67], a[16:19], v[188:191], v[64:67]
v_cvt_pk_bf16_f32 v159, v26, v30
v_cvt_pk_bf16_f32 v161, v27, v31
ds_read_b128 v[204:207], v252 offset:8192
v_mfma_f32_16x16x32_bf16 v[64:67], a[20:23], v[192:195], v[64:67]
v_cvt_pk_bf16_f32 v163, v40, v44
v_cvt_pk_bf16_f32 v165, v41, v45
v_mfma_f32_16x16x32_bf16 v[68:71], a[48:51], v[172:175], 0
v_cvt_pk_bf16_f32 v167, v42, v46
v_cvt_pk_bf16_f32 v169, v43, v47
ds_read_b128 v[208:211], v252 offset:9216
v_mfma_f32_16x16x32_bf16 v[68:71], a[52:55], v[176:179], v[68:71]
v_cvt_pk_bf16_f32 v171, v56, v60
buffer_store_dwordx2 v[134:135], v246, s[8:11], s21 offen offset:0 sc1
v_mfma_f32_16x16x32_bf16 v[68:71], a[56:59], v[180:183], v[68:71]
ds_read_b128 v[212:215], v252 offset:10240
v_mfma_f32_16x16x32_bf16 v[68:71], a[60:63], v[184:187], v[68:71]
buffer_store_dwordx2 v[146:147], v239, s[8:11], s21 offen offset:128 sc1
v_mfma_f32_16x16x32_bf16 v[68:71], a[64:67], v[188:191], v[68:71]
ds_read_b128 v[216:219], v252 offset:11264
v_mfma_f32_16x16x32_bf16 v[68:71], a[68:71], v[192:195], v[68:71]
v_mfma_f32_16x16x32_bf16 v[72:75], a[96:99], v[172:175], 0
v_mfma_f32_16x16x32_bf16 v[72:75], a[100:103], v[176:179], v[72:75]
v_mfma_f32_16x16x32_bf16 v[72:75], a[104:107], v[180:183], v[72:75]
v_mfma_f32_16x16x32_bf16 v[72:75], a[108:111], v[184:187], v[72:75]
v_mfma_f32_16x16x32_bf16 v[72:75], a[112:115], v[188:191], v[72:75]
v_mfma_f32_16x16x32_bf16 v[72:75], a[116:119], v[192:195], v[72:75]
s_waitcnt lgkmcnt(0)
v_mfma_f32_16x16x32_bf16 v[64:67], a[24:27], v[196:199], v[64:67]
ds_read_b128 v[172:175], v252 offset:12288
v_mfma_f32_16x16x32_bf16 v[64:67], a[28:31], v[200:203], v[64:67]
buffer_store_dwordx2 v[136:137], v247, s[8:11], s21 offen offset:0 sc1
v_mfma_f32_16x16x32_bf16 v[64:67], a[32:35], v[204:207], v[64:67]
ds_read_b128 v[176:179], v252 offset:13312
v_mfma_f32_16x16x32_bf16 v[64:67], a[36:39], v[208:211], v[64:67]
v_mfma_f32_16x16x32_bf16 v[64:67], a[40:43], v[212:215], v[64:67]
ds_read_b128 v[180:183], v252 offset:14336
v_mfma_f32_16x16x32_bf16 v[64:67], a[44:47], v[216:219], v[64:67]
v_mfma_f32_16x16x32_bf16 v[68:71], a[72:75], v[196:199], v[68:71]
ds_read_b128 v[184:187], v252 offset:15360
v_mfma_f32_16x16x32_bf16 v[68:71], a[76:79], v[200:203], v[68:71]
ds_read_u16 v110, v254 offset:256
v_mfma_f32_16x16x32_bf16 v[68:71], a[80:83], v[204:207], v[68:71]
ds_read_b128 v[188:191], v252 offset:16384
v_mfma_f32_16x16x32_bf16 v[68:71], a[84:87], v[208:211], v[68:71]
buffer_store_dwordx2 v[148:149], v240, s[8:11], s21 offen offset:128 sc1
v_mfma_f32_16x16x32_bf16 v[68:71], a[88:91], v[212:215], v[68:71]
ds_read_b128 v[192:195], v252 offset:17408
v_mfma_f32_16x16x32_bf16 v[68:71], a[92:95], v[216:219], v[68:71]
ds_read_u16 v118, v254 offset:264
v_mfma_f32_16x16x32_bf16 v[72:75], a[120:123], v[196:199], v[72:75]
v_mfma_f32_16x16x32_bf16 v[72:75], a[124:127], v[200:203], v[72:75]
v_cvt_pk_bf16_f32 v104, v64, v65
v_cvt_pk_bf16_f32 v105, v66, v67
buffer_store_dwordx2 v[138:139], v248, s[8:11], s21 offen offset:0 sc1
v_mfma_f32_16x16x32_bf16 v[72:75], a[128:131], v[204:207], v[72:75]
v_mfma_f32_16x16x32_bf16 v[72:75], a[132:135], v[208:211], v[72:75]
v_mfma_f32_16x16x32_bf16 v[72:75], a[136:139], v[212:215], v[72:75]
v_mfma_f32_16x16x32_bf16 v[72:75], a[140:143], v[216:219], v[72:75]
s_waitcnt lgkmcnt(1)
v_mfma_f32_16x16x32_bf16 v[76:79], a[0:3], v[172:175], 0
ds_read_b128 v[196:199], v252 offset:18432
v_mfma_f32_16x16x32_bf16 v[76:79], a[4:7], v[176:179], v[76:79]
v_cvt_pk_bf16_f32 v106, v68, v69
v_cvt_pk_bf16_f32 v107, v70, v71
v_mfma_f32_16x16x32_bf16 v[76:79], a[8:11], v[180:183], v[76:79]
ds_read_b128 v[200:203], v252 offset:19456
v_mfma_f32_16x16x32_bf16 v[76:79], a[12:15], v[184:187], v[76:79]
v_mfma_f32_16x16x32_bf16 v[76:79], a[16:19], v[188:191], v[76:79]
ds_read_b128 v[204:207], v252 offset:20480
v_mfma_f32_16x16x32_bf16 v[76:79], a[20:23], v[192:195], v[76:79]
v_mfma_f32_16x16x32_bf16 v[80:83], a[48:51], v[172:175], 0
ds_read_b128 v[208:211], v252 offset:21504
v_mfma_f32_16x16x32_bf16 v[80:83], a[52:55], v[176:179], v[80:83]
v_cvt_pk_bf16_f32 v108, v72, v73
v_cvt_pk_bf16_f32 v109, v74, v75
buffer_store_dwordx2 v[140:141], v249, s[8:11], s21 offen offset:0 sc1
v_mfma_f32_16x16x32_bf16 v[80:83], a[56:59], v[180:183], v[80:83]
ds_read_b128 v[212:215], v252 offset:22528
v_mfma_f32_16x16x32_bf16 v[80:83], a[60:63], v[184:187], v[80:83]
buffer_store_dwordx2 v[150:151], v241, s[8:11], s21 offen offset:128 sc1
v_mfma_f32_16x16x32_bf16 v[80:83], a[64:67], v[188:191], v[80:83]
ds_read_b128 v[216:219], v252 offset:23552
v_mfma_f32_16x16x32_bf16 v[80:83], a[68:71], v[192:195], v[80:83]
v_mfma_f32_16x16x32_bf16 v[84:87], a[96:99], v[172:175], 0
v_mfma_f32_16x16x32_bf16 v[84:87], a[100:103], v[176:179], v[84:87]
v_mfma_f32_16x16x32_bf16 v[84:87], a[104:107], v[180:183], v[84:87]
v_mfma_f32_16x16x32_bf16 v[84:87], a[108:111], v[184:187], v[84:87]
v_mfma_f32_16x16x32_bf16 v[84:87], a[112:115], v[188:191], v[84:87]
v_mfma_f32_16x16x32_bf16 v[84:87], a[116:119], v[192:195], v[84:87]
s_waitcnt vmcnt(26) lgkmcnt(0)
s_barrier
v_add_u32 v252, 24576, v252
v_mfma_f32_16x16x32_bf16 v[76:79], a[24:27], v[196:199], v[76:79]
s_add_u32 m0, s17, 0
s_mov_b32 s24, 491520
v_mfma_f32_16x16x32_bf16 v[76:79], a[28:31], v[200:203], v[76:79]
ds_read_b128 v[172:175], v252 offset:0
buffer_store_dwordx2 v[142:143], v250, s[8:11], s21 offen offset:0 sc1
v_mfma_f32_16x16x32_bf16 v[76:79], a[32:35], v[204:207], v[76:79]
buffer_load_dwordx4 v251, s[12:15], s24 offen offset:0  lds
v_mfma_f32_16x16x32_bf16 v[76:79], a[36:39], v[208:211], v[76:79]
ds_read_b128 v[176:179], v252 offset:1024
v_mfma_f32_16x16x32_bf16 v[76:79], a[40:43], v[212:215], v[76:79]
v_mfma_f32_16x16x32_bf16 v[76:79], a[44:47], v[216:219], v[76:79]
ds_read_b128 v[180:183], v252 offset:2048
v_mfma_f32_16x16x32_bf16 v[80:83], a[72:75], v[196:199], v[80:83]
buffer_load_dwordx4 v251, s[12:15], s24 offen offset:1024  lds
v_mfma_f32_16x16x32_bf16 v[80:83], a[76:79], v[200:203], v[80:83]
ds_read_b128 v[184:187], v252 offset:3072
v_mfma_f32_16x16x32_bf16 v[80:83], a[80:83], v[204:207], v[80:83]
v_mfma_f32_16x16x32_bf16 v[80:83], a[84:87], v[208:211], v[80:83]
ds_read_b128 v[188:191], v252 offset:4096
buffer_store_dwordx2 v[152:153], v242, s[8:11], s21 offen offset:128 sc1
v_mfma_f32_16x16x32_bf16 v[80:83], a[88:91], v[212:215], v[80:83]
buffer_load_dwordx4 v251, s[12:15], s24 offen offset:2048  lds
v_mfma_f32_16x16x32_bf16 v[80:83], a[92:95], v[216:219], v[80:83]
ds_read_b128 v[192:195], v252 offset:5120
v_mfma_f32_16x16x32_bf16 v[84:87], a[120:123], v[196:199], v[84:87]
v_mfma_f32_16x16x32_bf16 v[84:87], a[124:127], v[200:203], v[84:87]
v_cvt_pk_bf16_f32 v112, v76, v77
v_cvt_pk_bf16_f32 v113, v78, v79
s_add_u32 s25, s21, 1746432
s_mov_b64 exec, 0xffff
buffer_store_dwordx2 v[144:145], v239, s[8:11], s25 offen offset:0 sc1
s_mov_b64 exec, -1
v_mfma_f32_16x16x32_bf16 v[84:87], a[128:131], v[204:207], v[84:87]
buffer_load_dwordx4 v251, s[12:15], s24 offen offset:3072  lds
v_mfma_f32_16x16x32_bf16 v[84:87], a[132:135], v[208:211], v[84:87]
v_mfma_f32_16x16x32_bf16 v[84:87], a[136:139], v[212:215], v[84:87]
s_add_u32 m0, s17, 4096
s_mov_b32 s24, 495616
v_mfma_f32_16x16x32_bf16 v[84:87], a[140:143], v[216:219], v[84:87]
v_mfma_f32_16x16x32_bf16 v[8:11], v[0:3], v[104:107], 0
buffer_load_dwordx4 v251, s[12:15], s24 offen offset:0  lds
v_mfma_f32_16x16x32_bf16 v[8:11], v[4:7], v[108:111], v[8:11]
v_cvt_pk_bf16_f32 v114, v80, v81
v_cvt_pk_bf16_f32 v115, v82, v83
v_mfma_f32_16x16x32_bf16 v[24:27], v[16:19], v[104:107], 0
v_mfma_f32_16x16x32_bf16 v[24:27], v[20:23], v[108:111], v[24:27]
v_mfma_f32_16x16x32_bf16 v[40:43], v[32:35], v[104:107], 0
buffer_load_dwordx4 v251, s[12:15], s24 offen offset:1024  lds
v_mfma_f32_16x16x32_bf16 v[40:43], v[36:39], v[108:111], v[40:43]
v_mfma_f32_16x16x32_bf16 v[56:59], v[48:51], v[104:107], 0
v_mfma_f32_16x16x32_bf16 v[56:59], v[52:55], v[108:111], v[56:59]
v_cvt_pk_bf16_f32 v116, v84, v85
v_cvt_pk_bf16_f32 v117, v86, v87
v_mfma_f32_16x16x32_bf16 v[12:15], v[0:3], v[112:115], 0
s_nop 0
v_mfma_f32_16x16x32_bf16 v[12:15], v[4:7], v[116:119], v[12:15]
buffer_store_dwordx2 v[154:155], v243, s[8:11], s21 offen offset:128 sc1
v_mfma_f32_16x16x32_bf16 v[28:31], v[16:19], v[112:115], 0
v_mfma_f32_16x16x32_bf16 v[28:31], v[20:23], v[116:119], v[28:31]
v_mfma_f32_16x16x32_bf16 v[44:47], v[32:35], v[112:115], 0
v_mfma_f32_16x16x32_bf16 v[44:47], v[36:39], v[116:119], v[44:47]
v_mfma_f32_16x16x32_bf16 v[60:63], v[48:51], v[112:115], 0
v_mfma_f32_16x16x32_bf16 v[60:63], v[52:55], v[116:119], v[60:63]
s_waitcnt lgkmcnt(0)
v_mfma_f32_16x16x32_bf16 v[64:67], a[0:3], v[172:175], 0
ds_read_b128 v[196:199], v252 offset:6144
v_mfma_f32_16x16x32_bf16 v[64:67], a[4:7], v[176:179], v[64:67]
v_cvt_pk_bf16_f32 v120, v8, v12
v_cvt_pk_bf16_f32 v122, v9, v13
v_mfma_f32_16x16x32_bf16 v[64:67], a[8:11], v[180:183], v[64:67]
v_cvt_pk_bf16_f32 v124, v10, v14
v_cvt_pk_bf16_f32 v126, v11, v15
ds_read_b128 v[200:203], v252 offset:7168
v_mfma_f32_16x16x32_bf16 v[64:67], a[12:15], v[184:187], v[64:67]
v_cvt_pk_bf16_f32 v128, v24, v28
v_cvt_pk_bf16_f32 v130, v25, v29
v_mfma_f32_16x16x32_bf16 v[64:67], a[16:19], v[188:191], v[64:67]
v_cvt_pk_bf16_f32 v132, v26, v30
v_cvt_pk_bf16_f32 v134, v27, v31
ds_read_b128 v[204:207], v252 offset:8192
v_mfma_f32_16x16x32_bf16 v[64:67], a[20:23], v[192:195], v[64:67]
v_cvt_pk_bf16_f32 v136, v40, v44
v_cvt_pk_bf16_f32 v138, v41, v45
v_mfma_f32_16x16x32_bf16 v[68:71], a[48:51], v[172:175], 0
v_cvt_pk_bf16_f32 v140, v42, v46
v_cvt_pk_bf16_f32 v142, v43, v47
ds_read_b128 v[208:211], v252 offset:9216
v_mfma_f32_16x16x32_bf16 v[68:71], a[52:55], v[176:179], v[68:71]
v_cvt_pk_bf16_f32 v144, v56, v60
v_mfma_f32_16x16x32_bf16 v[68:71], a[56:59], v[180:183], v[68:71]
ds_read_b128 v[212:215], v252 offset:10240
v_mfma_f32_16x16x32_bf16 v[68:71], a[60:63], v[184:187], v[68:71]
v_mfma_f32_16x16x32_bf16 v[68:71], a[64:67], v[188:191], v[68:71]
ds_read_b128 v[216:219], v252 offset:11264
v_mfma_f32_16x16x32_bf16 v[68:71], a[68:71], v[192:195], v[68:71]
buffer_store_dwordx2 v[156:157], v244, s[8:11], s21 offen offset:128 sc1
v_mfma_f32_16x16x32_bf16 v[72:75], a[96:99], v[172:175], 0
v_mfma_f32_16x16x32_bf16 v[72:75], a[100:103], v[176:179], v[72:75]
v_mfma_f32_16x16x32_bf16 v[72:75], a[104:107], v[180:183], v[72:75]
v_mfma_f32_16x16x32_bf16 v[72:75], a[108:111], v[184:187], v[72:75]
v_mfma_f32_16x16x32_bf16 v[72:75], a[112:115], v[188:191], v[72:75]
v_mfma_f32_16x16x32_bf16 v[72:75], a[116:119], v[192:195], v[72:75]
s_waitcnt lgkmcnt(0)
v_mfma_f32_16x16x32_bf16 v[64:67], a[24:27], v[196:199], v[64:67]
ds_read_b128 v[172:175], v252 offset:12288
v_mfma_f32_16x16x32_bf16 v[64:67], a[28:31], v[200:203], v[64:67]
v_mfma_f32_16x16x32_bf16 v[64:67], a[32:35], v[204:207], v[64:67]
ds_read_b128 v[176:179], v252 offset:13312
v_mfma_f32_16x16x32_bf16 v[64:67], a[36:39], v[208:211], v[64:67]
v_mfma_f32_16x16x32_bf16 v[64:67], a[40:43], v[212:215], v[64:67]
ds_read_b128 v[180:183], v252 offset:14336
v_mfma_f32_16x16x32_bf16 v[64:67], a[44:47], v[216:219], v[64:67]
v_mfma_f32_16x16x32_bf16 v[68:71], a[72:75], v[196:199], v[68:71]
ds_read_b128 v[184:187], v252 offset:15360
v_mfma_f32_16x16x32_bf16 v[68:71], a[76:79], v[200:203], v[68:71]
ds_read_u16 v94, v254 offset:320
v_mfma_f32_16x16x32_bf16 v[68:71], a[80:83], v[204:207], v[68:71]
ds_read_b128 v[188:191], v252 offset:16384
v_mfma_f32_16x16x32_bf16 v[68:71], a[84:87], v[208:211], v[68:71]
v_mfma_f32_16x16x32_bf16 v[68:71], a[88:91], v[212:215], v[68:71]
ds_read_b128 v[192:195], v252 offset:17408
v_mfma_f32_16x16x32_bf16 v[68:71], a[92:95], v[216:219], v[68:71]
ds_read_u16 v102, v254 offset:328
buffer_store_dwordx2 v[158:159], v245, s[8:11], s21 offen offset:128 sc1
v_mfma_f32_16x16x32_bf16 v[72:75], a[120:123], v[196:199], v[72:75]
v_mfma_f32_16x16x32_bf16 v[72:75], a[124:127], v[200:203], v[72:75]
v_cvt_pk_bf16_f32 v88, v64, v65
v_cvt_pk_bf16_f32 v89, v66, v67
v_mfma_f32_16x16x32_bf16 v[72:75], a[128:131], v[204:207], v[72:75]
v_mfma_f32_16x16x32_bf16 v[72:75], a[132:135], v[208:211], v[72:75]
v_mfma_f32_16x16x32_bf16 v[72:75], a[136:139], v[212:215], v[72:75]
v_mfma_f32_16x16x32_bf16 v[72:75], a[140:143], v[216:219], v[72:75]
s_waitcnt lgkmcnt(1)
v_mfma_f32_16x16x32_bf16 v[76:79], a[0:3], v[172:175], 0
ds_read_b128 v[196:199], v252 offset:18432
v_mfma_f32_16x16x32_bf16 v[76:79], a[4:7], v[176:179], v[76:79]
v_cvt_pk_bf16_f32 v90, v68, v69
v_cvt_pk_bf16_f32 v91, v70, v71
v_mfma_f32_16x16x32_bf16 v[76:79], a[8:11], v[180:183], v[76:79]
ds_read_b128 v[200:203], v252 offset:19456
v_mfma_f32_16x16x32_bf16 v[76:79], a[12:15], v[184:187], v[76:79]
v_mfma_f32_16x16x32_bf16 v[76:79], a[16:19], v[188:191], v[76:79]
ds_read_b128 v[204:207], v252 offset:20480
v_mfma_f32_16x16x32_bf16 v[76:79], a[20:23], v[192:195], v[76:79]
v_mfma_f32_16x16x32_bf16 v[80:83], a[48:51], v[172:175], 0
ds_read_b128 v[208:211], v252 offset:21504
v_mfma_f32_16x16x32_bf16 v[80:83], a[52:55], v[176:179], v[80:83]
v_cvt_pk_bf16_f32 v92, v72, v73
v_cvt_pk_bf16_f32 v93, v74, v75
v_mfma_f32_16x16x32_bf16 v[80:83], a[56:59], v[180:183], v[80:83]
ds_read_b128 v[212:215], v252 offset:22528
v_mfma_f32_16x16x32_bf16 v[80:83], a[60:63], v[184:187], v[80:83]
v_mfma_f32_16x16x32_bf16 v[80:83], a[64:67], v[188:191], v[80:83]
ds_read_b128 v[216:219], v252 offset:23552
v_mfma_f32_16x16x32_bf16 v[80:83], a[68:71], v[192:195], v[80:83]
buffer_store_dwordx2 v[160:161], v246, s[8:11], s21 offen offset:128 sc1
v_mfma_f32_16x16x32_bf16 v[84:87], a[96:99], v[172:175], 0
v_mfma_f32_16x16x32_bf16 v[84:87], a[100:103], v[176:179], v[84:87]
v_mfma_f32_16x16x32_bf16 v[84:87], a[104:107], v[180:183], v[84:87]
v_mfma_f32_16x16x32_bf16 v[84:87], a[108:111], v[184:187], v[84:87]
v_mfma_f32_16x16x32_bf16 v[84:87], a[112:115], v[188:191], v[84:87]
v_mfma_f32_16x16x32_bf16 v[84:87], a[116:119], v[192:195], v[84:87]
s_waitcnt vmcnt(33) lgkmcnt(0)
s_barrier
v_add_u32 v252, 24576, v252
v_mfma_f32_16x16x32_bf16 v[76:79], a[24:27], v[196:199], v[76:79]
s_add_u32 m0, s17, 24576
s_mov_b32 s24, 516096
v_mfma_f32_16x16x32_bf16 v[76:79], a[28:31], v[200:203], v[76:79]
ds_read_b128 v[172:175], v252 offset:0
v_mfma_f32_16x16x32_bf16 v[76:79], a[32:35], v[204:207], v[76:79]
buffer_load_dwordx4 v251, s[12:15], s24 offen offset:0  lds
v_mfma_f32_16x16x32_bf16 v[76:79], a[36:39], v[208:211], v[76:79]
ds_read_b128 v[176:179], v252 offset:1024
v_mfma_f32_16x16x32_bf16 v[76:79], a[40:43], v[212:215], v[76:79]
v_mfma_f32_16x16x32_bf16 v[76:79], a[44:47], v[216:219], v[76:79]
ds_read_b128 v[180:183], v252 offset:2048
v_mfma_f32_16x16x32_bf16 v[80:83], a[72:75], v[196:199], v[80:83]
buffer_load_dwordx4 v251, s[12:15], s24 offen offset:1024  lds
v_mfma_f32_16x16x32_bf16 v[80:83], a[76:79], v[200:203], v[80:83]
ds_read_b128 v[184:187], v252 offset:3072
v_mfma_f32_16x16x32_bf16 v[80:83], a[80:83], v[204:207], v[80:83]
v_mfma_f32_16x16x32_bf16 v[80:83], a[84:87], v[208:211], v[80:83]
ds_read_b128 v[188:191], v252 offset:4096
v_mfma_f32_16x16x32_bf16 v[80:83], a[88:91], v[212:215], v[80:83]
buffer_load_dwordx4 v251, s[12:15], s24 offen offset:2048  lds
v_mfma_f32_16x16x32_bf16 v[80:83], a[92:95], v[216:219], v[80:83]
ds_read_b128 v[192:195], v252 offset:5120
buffer_store_dwordx2 v[162:163], v247, s[8:11], s21 offen offset:128 sc1
v_mfma_f32_16x16x32_bf16 v[84:87], a[120:123], v[196:199], v[84:87]
v_mfma_f32_16x16x32_bf16 v[84:87], a[124:127], v[200:203], v[84:87]
v_cvt_pk_bf16_f32 v96, v76, v77
v_cvt_pk_bf16_f32 v97, v78, v79
v_mfma_f32_16x16x32_bf16 v[84:87], a[128:131], v[204:207], v[84:87]
buffer_load_dwordx4 v251, s[12:15], s24 offen offset:3072  lds
v_mfma_f32_16x16x32_bf16 v[84:87], a[132:135], v[208:211], v[84:87]
v_mfma_f32_16x16x32_bf16 v[84:87], a[136:139], v[212:215], v[84:87]
s_add_u32 m0, s17, 28672
s_mov_b32 s24, 520192
v_mfma_f32_16x16x32_bf16 v[84:87], a[140:143], v[216:219], v[84:87]
v_mfma_f32_16x16x32_bf16 v[8:11], v[0:3], v[88:91], 0
buffer_load_dwordx4 v251, s[12:15], s24 offen offset:0  lds
v_mfma_f32_16x16x32_bf16 v[8:11], v[4:7], v[92:95], v[8:11]
v_cvt_pk_bf16_f32 v98, v80, v81
v_cvt_pk_bf16_f32 v99, v82, v83
v_mfma_f32_16x16x32_bf16 v[24:27], v[16:19], v[88:91], 0
v_mfma_f32_16x16x32_bf16 v[24:27], v[20:23], v[92:95], v[24:27]
v_mfma_f32_16x16x32_bf16 v[40:43], v[32:35], v[88:91], 0
buffer_load_dwordx4 v251, s[12:15], s24 offen offset:1024  lds
v_mfma_f32_16x16x32_bf16 v[40:43], v[36:39], v[92:95], v[40:43]
v_mfma_f32_16x16x32_bf16 v[56:59], v[48:51], v[88:91], 0
v_mfma_f32_16x16x32_bf16 v[56:59], v[52:55], v[92:95], v[56:59]
v_cvt_pk_bf16_f32 v100, v84, v85
v_cvt_pk_bf16_f32 v101, v86, v87
v_mfma_f32_16x16x32_bf16 v[12:15], v[0:3], v[96:99], 0
s_nop 0
v_mfma_f32_16x16x32_bf16 v[12:15], v[4:7], v[100:103], v[12:15]
v_mfma_f32_16x16x32_bf16 v[28:31], v[16:19], v[96:99], 0
v_mfma_f32_16x16x32_bf16 v[28:31], v[20:23], v[100:103], v[28:31]
buffer_store_dwordx2 v[164:165], v248, s[8:11], s21 offen offset:128 sc1
v_mfma_f32_16x16x32_bf16 v[44:47], v[32:35], v[96:99], 0
v_mfma_f32_16x16x32_bf16 v[44:47], v[36:39], v[100:103], v[44:47]
v_mfma_f32_16x16x32_bf16 v[60:63], v[48:51], v[96:99], 0
v_mfma_f32_16x16x32_bf16 v[60:63], v[52:55], v[100:103], v[60:63]
s_waitcnt lgkmcnt(0)
v_mfma_f32_16x16x32_bf16 v[64:67], a[0:3], v[172:175], 0
ds_read_b128 v[196:199], v252 offset:6144
v_mfma_f32_16x16x32_bf16 v[64:67], a[4:7], v[176:179], v[64:67]
v_cvt_pk_bf16_f32 v121, v8, v12
v_cvt_pk_bf16_f32 v123, v9, v13
v_mfma_f32_16x16x32_bf16 v[64:67], a[8:11], v[180:183], v[64:67]
v_cvt_pk_bf16_f32 v125, v10, v14
v_cvt_pk_bf16_f32 v127, v11, v15
ds_read_b128 v[200:203], v252 offset:7168
v_mfma_f32_16x16x32_bf16 v[64:67], a[12:15], v[184:187], v[64:67]
v_cvt_pk_bf16_f32 v129, v24, v28
v_cvt_pk_bf16_f32 v131, v25, v29
v_mfma_f32_16x16x32_bf16 v[64:67], a[16:19], v[188:191], v[64:67]
v_cvt_pk_bf16_f32 v133, v26, v30
v_cvt_pk_bf16_f32 v135, v27, v31
ds_read_b128 v[204:207], v252 offset:8192
v_mfma_f32_16x16x32_bf16 v[64:67], a[20:23], v[192:195], v[64:67]
v_cvt_pk_bf16_f32 v137, v40, v44
v_cvt_pk_bf16_f32 v139, v41, v45
v_mfma_f32_16x16x32_bf16 v[68:71], a[48:51], v[172:175], 0
v_cvt_pk_bf16_f32 v141, v42, v46
v_cvt_pk_bf16_f32 v143, v43, v47
ds_read_b128 v[208:211], v252 offset:9216
v_mfma_f32_16x16x32_bf16 v[68:71], a[52:55], v[176:179], v[68:71]
v_cvt_pk_bf16_f32 v145, v56, v60
v_mfma_f32_16x16x32_bf16 v[68:71], a[56:59], v[180:183], v[68:71]
ds_read_b128 v[212:215], v252 offset:10240
v_mfma_f32_16x16x32_bf16 v[68:71], a[60:63], v[184:187], v[68:71]
buffer_store_dwordx2 v[120:121], v239, s[8:11], s21 offen offset:256 sc1
v_mfma_f32_16x16x32_bf16 v[68:71], a[64:67], v[188:191], v[68:71]
ds_read_b128 v[216:219], v252 offset:11264
v_mfma_f32_16x16x32_bf16 v[68:71], a[68:71], v[192:195], v[68:71]
v_mfma_f32_16x16x32_bf16 v[72:75], a[96:99], v[172:175], 0
v_mfma_f32_16x16x32_bf16 v[72:75], a[100:103], v[176:179], v[72:75]
buffer_store_dwordx2 v[166:167], v249, s[8:11], s21 offen offset:128 sc1
v_mfma_f32_16x16x32_bf16 v[72:75], a[104:107], v[180:183], v[72:75]
v_mfma_f32_16x16x32_bf16 v[72:75], a[108:111], v[184:187], v[72:75]
v_mfma_f32_16x16x32_bf16 v[72:75], a[112:115], v[188:191], v[72:75]
v_mfma_f32_16x16x32_bf16 v[72:75], a[116:119], v[192:195], v[72:75]
s_waitcnt lgkmcnt(0)
v_mfma_f32_16x16x32_bf16 v[64:67], a[24:27], v[196:199], v[64:67]
ds_read_b128 v[172:175], v252 offset:12288
v_mfma_f32_16x16x32_bf16 v[64:67], a[28:31], v[200:203], v[64:67]
v_mfma_f32_16x16x32_bf16 v[64:67], a[32:35], v[204:207], v[64:67]
ds_read_b128 v[176:179], v252 offset:13312
v_mfma_f32_16x16x32_bf16 v[64:67], a[36:39], v[208:211], v[64:67]
v_mfma_f32_16x16x32_bf16 v[64:67], a[40:43], v[212:215], v[64:67]
ds_read_b128 v[180:183], v252 offset:14336
v_mfma_f32_16x16x32_bf16 v[64:67], a[44:47], v[216:219], v[64:67]
v_mfma_f32_16x16x32_bf16 v[68:71], a[72:75], v[196:199], v[68:71]
ds_read_b128 v[184:187], v252 offset:15360
v_mfma_f32_16x16x32_bf16 v[68:71], a[76:79], v[200:203], v[68:71]
ds_read_u16 v110, v254 offset:384
v_mfma_f32_16x16x32_bf16 v[68:71], a[80:83], v[204:207], v[68:71]
ds_read_b128 v[188:191], v252 offset:16384
v_mfma_f32_16x16x32_bf16 v[68:71], a[84:87], v[208:211], v[68:71]
buffer_store_dwordx2 v[122:123], v240, s[8:11], s21 offen offset:256 sc1
v_mfma_f32_16x16x32_bf16 v[68:71], a[88:91], v[212:215], v[68:71]
ds_read_b128 v[192:195], v252 offset:17408
v_mfma_f32_16x16x32_bf16 v[68:71], a[92:95], v[216:219], v[68:71]
ds_read_u16 v118, v254 offset:392
v_mfma_f32_16x16x32_bf16 v[72:75], a[120:123], v[196:199], v[72:75]
v_mfma_f32_16x16x32_bf16 v[72:75], a[124:127], v[200:203], v[72:75]
v_cvt_pk_bf16_f32 v104, v64, v65
v_cvt_pk_bf16_f32 v105, v66, v67
buffer_store_dwordx2 v[168:169], v250, s[8:11], s21 offen offset:128 sc1
v_mfma_f32_16x16x32_bf16 v[72:75], a[128:131], v[204:207], v[72:75]
v_mfma_f32_16x16x32_bf16 v[72:75], a[132:135], v[208:211], v[72:75]
v_mfma_f32_16x16x32_bf16 v[72:75], a[136:139], v[212:215], v[72:75]
v_mfma_f32_16x16x32_bf16 v[72:75], a[140:143], v[216:219], v[72:75]
s_waitcnt lgkmcnt(1)
v_mfma_f32_16x16x32_bf16 v[76:79], a[0:3], v[172:175], 0
ds_read_b128 v[196:199], v252 offset:18432
v_mfma_f32_16x16x32_bf16 v[76:79], a[4:7], v[176:179], v[76:79]
v_cvt_pk_bf16_f32 v106, v68, v69
v_cvt_pk_bf16_f32 v107, v70, v71
v_mfma_f32_16x16x32_bf16 v[76:79], a[8:11], v[180:183], v[76:79]
ds_read_b128 v[200:203], v252 offset:19456
v_mfma_f32_16x16x32_bf16 v[76:79], a[12:15], v[184:187], v[76:79]
v_mfma_f32_16x16x32_bf16 v[76:79], a[16:19], v[188:191], v[76:79]
ds_read_b128 v[204:207], v252 offset:20480
v_mfma_f32_16x16x32_bf16 v[76:79], a[20:23], v[192:195], v[76:79]
v_mfma_f32_16x16x32_bf16 v[80:83], a[48:51], v[172:175], 0
ds_read_b128 v[208:211], v252 offset:21504
v_mfma_f32_16x16x32_bf16 v[80:83], a[52:55], v[176:179], v[80:83]
v_cvt_pk_bf16_f32 v108, v72, v73
v_cvt_pk_bf16_f32 v109, v74, v75
v_mfma_f32_16x16x32_bf16 v[80:83], a[56:59], v[180:183], v[80:83]
ds_read_b128 v[212:215], v252 offset:22528
v_mfma_f32_16x16x32_bf16 v[80:83], a[60:63], v[184:187], v[80:83]
buffer_store_dwordx2 v[124:125], v241, s[8:11], s21 offen offset:256 sc1
v_mfma_f32_16x16x32_bf16 v[80:83], a[64:67], v[188:191], v[80:83]
ds_read_b128 v[216:219], v252 offset:23552
v_mfma_f32_16x16x32_bf16 v[80:83], a[68:71], v[192:195], v[80:83]
v_mfma_f32_16x16x32_bf16 v[84:87], a[96:99], v[172:175], 0
v_mfma_f32_16x16x32_bf16 v[84:87], a[100:103], v[176:179], v[84:87]
s_add_u32 s25, s21, 1746432
s_mov_b64 exec, 0xffff
buffer_store_dwordx2 v[170:171], v239, s[8:11], s25 offen offset:128 sc1
s_mov_b64 exec, -1
v_mfma_f32_16x16x32_bf16 v[84:87], a[104:107], v[180:183], v[84:87]
v_mfma_f32_16x16x32_bf16 v[84:87], a[108:111], v[184:187], v[84:87]
v_mfma_f32_16x16x32_bf16 v[84:87], a[112:115], v[188:191], v[84:87]
v_mfma_f32_16x16x32_bf16 v[84:87], a[116:119], v[192:195], v[84:87]
s_waitcnt vmcnt(35) lgkmcnt(0)
s_barrier
v_add_u32 v252, 24576, v252
v_mfma_f32_16x16x32_bf16 v[76:79], a[24:27], v[196:199], v[76:79]
s_add_u32 m0, s17, 49152
s_mov_b32 s24, 540672
v_mfma_f32_16x16x32_bf16 v[76:79], a[28:31], v[200:203], v[76:79]
ds_read_b128 v[172:175], v252 offset:0
v_mfma_f32_16x16x32_bf16 v[76:79], a[32:35], v[204:207], v[76:79]
buffer_load_dwordx4 v251, s[12:15], s24 offen offset:0  lds
v_mfma_f32_16x16x32_bf16 v[76:79], a[36:39], v[208:211], v[76:79]
ds_read_b128 v[176:179], v252 offset:1024
v_mfma_f32_16x16x32_bf16 v[76:79], a[40:43], v[212:215], v[76:79]
v_mfma_f32_16x16x32_bf16 v[76:79], a[44:47], v[216:219], v[76:79]
ds_read_b128 v[180:183], v252 offset:2048
v_mfma_f32_16x16x32_bf16 v[80:83], a[72:75], v[196:199], v[80:83]
buffer_load_dwordx4 v251, s[12:15], s24 offen offset:1024  lds
v_mfma_f32_16x16x32_bf16 v[80:83], a[76:79], v[200:203], v[80:83]
ds_read_b128 v[184:187], v252 offset:3072
v_mfma_f32_16x16x32_bf16 v[80:83], a[80:83], v[204:207], v[80:83]
v_mfma_f32_16x16x32_bf16 v[80:83], a[84:87], v[208:211], v[80:83]
ds_read_b128 v[188:191], v252 offset:4096
buffer_store_dwordx2 v[126:127], v242, s[8:11], s21 offen offset:256 sc1
v_mfma_f32_16x16x32_bf16 v[80:83], a[88:91], v[212:215], v[80:83]
buffer_load_dwordx4 v251, s[12:15], s24 offen offset:2048  lds
v_mfma_f32_16x16x32_bf16 v[80:83], a[92:95], v[216:219], v[80:83]
ds_read_b128 v[192:195], v252 offset:5120
v_mfma_f32_16x16x32_bf16 v[84:87], a[120:123], v[196:199], v[84:87]
v_mfma_f32_16x16x32_bf16 v[84:87], a[124:127], v[200:203], v[84:87]
v_cvt_pk_bf16_f32 v112, v76, v77
v_cvt_pk_bf16_f32 v113, v78, v79
v_mfma_f32_16x16x32_bf16 v[84:87], a[128:131], v[204:207], v[84:87]
buffer_load_dwordx4 v251, s[12:15], s24 offen offset:3072  lds
v_mfma_f32_16x16x32_bf16 v[84:87], a[132:135], v[208:211], v[84:87]
v_mfma_f32_16x16x32_bf16 v[84:87], a[136:139], v[212:215], v[84:87]
s_add_u32 m0, s17, 53248
s_mov_b32 s24, 544768
v_mfma_f32_16x16x32_bf16 v[84:87], a[140:143], v[216:219], v[84:87]
v_mfma_f32_16x16x32_bf16 v[8:11], v[0:3], v[104:107], 0
buffer_load_dwordx4 v251, s[12:15], s24 offen offset:0  lds
v_mfma_f32_16x16x32_bf16 v[8:11], v[4:7], v[108:111], v[8:11]
v_cvt_pk_bf16_f32 v114, v80, v81
v_cvt_pk_bf16_f32 v115, v82, v83
v_mfma_f32_16x16x32_bf16 v[24:27], v[16:19], v[104:107], 0
v_mfma_f32_16x16x32_bf16 v[24:27], v[20:23], v[108:111], v[24:27]
v_mfma_f32_16x16x32_bf16 v[40:43], v[32:35], v[104:107], 0
buffer_load_dwordx4 v251, s[12:15], s24 offen offset:1024  lds
v_mfma_f32_16x16x32_bf16 v[40:43], v[36:39], v[108:111], v[40:43]
v_mfma_f32_16x16x32_bf16 v[56:59], v[48:51], v[104:107], 0
v_mfma_f32_16x16x32_bf16 v[56:59], v[52:55], v[108:111], v[56:59]
v_cvt_pk_bf16_f32 v116, v84, v85
v_cvt_pk_bf16_f32 v117, v86, v87
v_mfma_f32_16x16x32_bf16 v[12:15], v[0:3], v[112:115], 0
s_nop 0
v_mfma_f32_16x16x32_bf16 v[12:15], v[4:7], v[116:119], v[12:15]
buffer_store_dwordx2 v[128:129], v243, s[8:11], s21 offen offset:256 sc1
v_mfma_f32_16x16x32_bf16 v[28:31], v[16:19], v[112:115], 0
v_mfma_f32_16x16x32_bf16 v[28:31], v[20:23], v[116:119], v[28:31]
v_mfma_f32_16x16x32_bf16 v[44:47], v[32:35], v[112:115], 0
v_mfma_f32_16x16x32_bf16 v[44:47], v[36:39], v[116:119], v[44:47]
v_mfma_f32_16x16x32_bf16 v[60:63], v[48:51], v[112:115], 0
v_mfma_f32_16x16x32_bf16 v[60:63], v[52:55], v[116:119], v[60:63]
s_waitcnt lgkmcnt(0)
v_mfma_f32_16x16x32_bf16 v[64:67], a[0:3], v[172:175], 0
ds_read_b128 v[196:199], v252 offset:6144
v_mfma_f32_16x16x32_bf16 v[64:67], a[4:7], v[176:179], v[64:67]
v_cvt_pk_bf16_f32 v146, v8, v12
v_cvt_pk_bf16_f32 v148, v9, v13
v_mfma_f32_16x16x32_bf16 v[64:67], a[8:11], v[180:183], v[64:67]
v_cvt_pk_bf16_f32 v150, v10, v14
v_cvt_pk_bf16_f32 v152, v11, v15
ds_read_b128 v[200:203], v252 offset:7168
v_mfma_f32_16x16x32_bf16 v[64:67], a[12:15], v[184:187], v[64:67]
v_cvt_pk_bf16_f32 v154, v24, v28
v_cvt_pk_bf16_f32 v156, v25, v29
v_mfma_f32_16x16x32_bf16 v[64:67], a[16:19], v[188:191], v[64:67]
v_cvt_pk_bf16_f32 v158, v26, v30
v_cvt_pk_bf16_f32 v160, v27, v31
ds_read_b128 v[204:207], v252 offset:8192
v_mfma_f32_16x16x32_bf16 v[64:67], a[20:23], v[192:195], v[64:67]
v_cvt_pk_bf16_f32 v162, v40, v44
v_cvt_pk_bf16_f32 v164, v41, v45
v_mfma_f32_16x16x32_bf16 v[68:71], a[48:51], v[172:175], 0
v_cvt_pk_bf16_f32 v166, v42, v46
v_cvt_pk_bf16_f32 v168, v43, v47
ds_read_b128 v[208:211], v252 offset:9216
v_mfma_f32_16x16x32_bf16 v[68:71], a[52:55], v[176:179], v[68:71]
v_cvt_pk_bf16_f32 v170, v56, v60
v_mfma_f32_16x16x32_bf16 v[68:71], a[56:59], v[180:183], v[68:71]
ds_read_b128 v[212:215], v252 offset:10240
v_mfma_f32_16x16x32_bf16 v[68:71], a[60:63], v[184:187], v[68:71]
v_mfma_f32_16x16x32_bf16 v[68:71], a[64:67], v[188:191], v[68:71]
ds_read_b128 v[216:219], v252 offset:11264
v_mfma_f32_16x16x32_bf16 v[68:71], a[68:71], v[192:195], v[68:71]
buffer_store_dwordx2 v[130:131], v244, s[8:11], s21 offen offset:256 sc1
v_mfma_f32_16x16x32_bf16 v[72:75], a[96:99], v[172:175], 0
v_mfma_f32_16x16x32_bf16 v[72:75], a[100:103], v[176:179], v[72:75]
v_mfma_f32_16x16x32_bf16 v[72:75], a[104:107], v[180:183], v[72:75]
v_mfma_f32_16x16x32_bf16 v[72:75], a[108:111], v[184:187], v[72:75]
v_mfma_f32_16x16x32_bf16 v[72:75], a[112:115], v[188:191], v[72:75]
v_mfma_f32_16x16x32_bf16 v[72:75], a[116:119], v[192:195], v[72:75]
s_waitcnt lgkmcnt(0)
v_mfma_f32_16x16x32_bf16 v[64:67], a[24:27], v[196:199], v[64:67]
ds_read_b128 v[172:175], v252 offset:12288
v_mfma_f32_16x16x32_bf16 v[64:67], a[28:31], v[200:203], v[64:67]
v_mfma_f32_16x16x32_bf16 v[64:67], a[32:35], v[204:207], v[64:67]
ds_read_b128 v[176:179], v252 offset:13312
v_mfma_f32_16x16x32_bf16 v[64:67], a[36:39], v[208:211], v[64:67]
v_mfma_f32_16x16x32_bf16 v[64:67], a[40:43], v[212:215], v[64:67]
ds_read_b128 v[180:183], v252 offset:14336
v_mfma_f32_16x16x32_bf16 v[64:67], a[44:47], v[216:219], v[64:67]
v_mfma_f32_16x16x32_bf16 v[68:71], a[72:75], v[196:199], v[68:71]
ds_read_b128 v[184:187], v252 offset:15360
v_mfma_f32_16x16x32_bf16 v[68:71], a[76:79], v[200:203], v[68:71]
ds_read_u16 v94, v254 offset:448
v_mfma_f32_16x16x32_bf16 v[68:71], a[80:83], v[204:207], v[68:71]
ds_read_b128 v[188:191], v252 offset:16384
v_mfma_f32_16x16x32_bf16 v[68:71], a[84:87], v[208:211], v[68:71]
v_mfma_f32_16x16x32_bf16 v[68:71], a[88:91], v[212:215], v[68:71]
ds_read_b128 v[192:195], v252 offset:17408
v_mfma_f32_16x16x32_bf16 v[68:71], a[92:95], v[216:219], v[68:71]
ds_read_u16 v102, v254 offset:456
buffer_store_dwordx2 v[132:133], v245, s[8:11], s21 offen offset:256 sc1
v_mfma_f32_16x16x32_bf16 v[72:75], a[120:123], v[196:199], v[72:75]
v_mfma_f32_16x16x32_bf16 v[72:75], a[124:127], v[200:203], v[72:75]
v_cvt_pk_bf16_f32 v88, v64, v65
v_cvt_pk_bf16_f32 v89, v66, v67
v_mfma_f32_16x16x32_bf16 v[72:75], a[128:131], v[204:207], v[72:75]
v_mfma_f32_16x16x32_bf16 v[72:75], a[132:135], v[208:211], v[72:75]
v_mfma_f32_16x16x32_bf16 v[72:75], a[136:139], v[212:215], v[72:75]
v_mfma_f32_16x16x32_bf16 v[72:75], a[140:143], v[216:219], v[72:75]
s_waitcnt lgkmcnt(1)
v_mfma_f32_16x16x32_bf16 v[76:79], a[0:3], v[172:175], 0
ds_read_b128 v[196:199], v252 offset:18432
v_mfma_f32_16x16x32_bf16 v[76:79], a[4:7], v[176:179], v[76:79]
v_cvt_pk_bf16_f32 v90, v68, v69
v_cvt_pk_bf16_f32 v91, v70, v71
v_mfma_f32_16x16x32_bf16 v[76:79], a[8:11], v[180:183], v[76:79]
ds_read_b128 v[200:203], v252 offset:19456
v_mfma_f32_16x16x32_bf16 v[76:79], a[12:15], v[184:187], v[76:79]
v_mfma_f32_16x16x32_bf16 v[76:79], a[16:19], v[188:191], v[76:79]
ds_read_b128 v[204:207], v252 offset:20480
v_mfma_f32_16x16x32_bf16 v[76:79], a[20:23], v[192:195], v[76:79]
v_mfma_f32_16x16x32_bf16 v[80:83], a[48:51], v[172:175], 0
ds_read_b128 v[208:211], v252 offset:21504
v_mfma_f32_16x16x32_bf16 v[80:83], a[52:55], v[176:179], v[80:83]
v_cvt_pk_bf16_f32 v92, v72, v73
v_cvt_pk_bf16_f32 v93, v74, v75
v_mfma_f32_16x16x32_bf16 v[80:83], a[56:59], v[180:183], v[80:83]
ds_read_b128 v[212:215], v252 offset:22528
v_mfma_f32_16x16x32_bf16 v[80:83], a[60:63], v[184:187], v[80:83]
v_mfma_f32_16x16x32_bf16 v[80:83], a[64:67], v[188:191], v[80:83]
ds_read_b128 v[216:219], v252 offset:23552
v_mfma_f32_16x16x32_bf16 v[80:83], a[68:71], v[192:195], v[80:83]
buffer_store_dwordx2 v[134:135], v246, s[8:11], s21 offen offset:256 sc1
v_mfma_f32_16x16x32_bf16 v[84:87], a[96:99], v[172:175], 0
v_mfma_f32_16x16x32_bf16 v[84:87], a[100:103], v[176:179], v[84:87]
v_mfma_f32_16x16x32_bf16 v[84:87], a[104:107], v[180:183], v[84:87]
v_mfma_f32_16x16x32_bf16 v[84:87], a[108:111], v[184:187], v[84:87]
v_mfma_f32_16x16x32_bf16 v[84:87], a[112:115], v[188:191], v[84:87]
v_mfma_f32_16x16x32_bf16 v[84:87], a[116:119], v[192:195], v[84:87]
s_waitcnt vmcnt(29) lgkmcnt(0)
s_barrier
v_add_u32 v252, 4294893568, v252
v_mfma_f32_16x16x32_bf16 v[76:79], a[24:27], v[196:199], v[76:79]
s_add_u32 m0, s17, 73728
s_mov_b32 s24, 565248
v_mfma_f32_16x16x32_bf16 v[76:79], a[28:31], v[200:203], v[76:79]
ds_read_b128 v[172:175], v252 offset:0
v_mfma_f32_16x16x32_bf16 v[76:79], a[32:35], v[204:207], v[76:79]
buffer_load_dwordx4 v251, s[12:15], s24 offen offset:0  lds
v_mfma_f32_16x16x32_bf16 v[76:79], a[36:39], v[208:211], v[76:79]
ds_read_b128 v[176:179], v252 offset:1024
v_mfma_f32_16x16x32_bf16 v[76:79], a[40:43], v[212:215], v[76:79]
v_mfma_f32_16x16x32_bf16 v[76:79], a[44:47], v[216:219], v[76:79]
ds_read_b128 v[180:183], v252 offset:2048
v_mfma_f32_16x16x32_bf16 v[80:83], a[72:75], v[196:199], v[80:83]
buffer_load_dwordx4 v251, s[12:15], s24 offen offset:1024  lds
v_mfma_f32_16x16x32_bf16 v[80:83], a[76:79], v[200:203], v[80:83]
ds_read_b128 v[184:187], v252 offset:3072
v_mfma_f32_16x16x32_bf16 v[80:83], a[80:83], v[204:207], v[80:83]
v_mfma_f32_16x16x32_bf16 v[80:83], a[84:87], v[208:211], v[80:83]
ds_read_b128 v[188:191], v252 offset:4096
v_mfma_f32_16x16x32_bf16 v[80:83], a[88:91], v[212:215], v[80:83]
buffer_load_dwordx4 v251, s[12:15], s24 offen offset:2048  lds
v_mfma_f32_16x16x32_bf16 v[80:83], a[92:95], v[216:219], v[80:83]
ds_read_b128 v[192:195], v252 offset:5120
buffer_store_dwordx2 v[136:137], v247, s[8:11], s21 offen offset:256 sc1
v_mfma_f32_16x16x32_bf16 v[84:87], a[120:123], v[196:199], v[84:87]
v_mfma_f32_16x16x32_bf16 v[84:87], a[124:127], v[200:203], v[84:87]
v_cvt_pk_bf16_f32 v96, v76, v77
v_cvt_pk_bf16_f32 v97, v78, v79
v_mfma_f32_16x16x32_bf16 v[84:87], a[128:131], v[204:207], v[84:87]
buffer_load_dwordx4 v251, s[12:15], s24 offen offset:3072  lds
v_mfma_f32_16x16x32_bf16 v[84:87], a[132:135], v[208:211], v[84:87]
v_mfma_f32_16x16x32_bf16 v[84:87], a[136:139], v[212:215], v[84:87]
s_add_u32 m0, s17, 77824
s_mov_b32 s24, 569344
v_mfma_f32_16x16x32_bf16 v[84:87], a[140:143], v[216:219], v[84:87]
v_mfma_f32_16x16x32_bf16 v[8:11], v[0:3], v[88:91], 0
buffer_load_dwordx4 v251, s[12:15], s24 offen offset:0  lds
v_mfma_f32_16x16x32_bf16 v[8:11], v[4:7], v[92:95], v[8:11]
v_cvt_pk_bf16_f32 v98, v80, v81
v_cvt_pk_bf16_f32 v99, v82, v83
v_mfma_f32_16x16x32_bf16 v[24:27], v[16:19], v[88:91], 0
v_mfma_f32_16x16x32_bf16 v[24:27], v[20:23], v[92:95], v[24:27]
v_mfma_f32_16x16x32_bf16 v[40:43], v[32:35], v[88:91], 0
buffer_load_dwordx4 v251, s[12:15], s24 offen offset:1024  lds
v_mfma_f32_16x16x32_bf16 v[40:43], v[36:39], v[92:95], v[40:43]
v_mfma_f32_16x16x32_bf16 v[56:59], v[48:51], v[88:91], 0
v_mfma_f32_16x16x32_bf16 v[56:59], v[52:55], v[92:95], v[56:59]
v_cvt_pk_bf16_f32 v100, v84, v85
v_cvt_pk_bf16_f32 v101, v86, v87
v_mfma_f32_16x16x32_bf16 v[12:15], v[0:3], v[96:99], 0
s_nop 0
v_mfma_f32_16x16x32_bf16 v[12:15], v[4:7], v[100:103], v[12:15]
v_mfma_f32_16x16x32_bf16 v[28:31], v[16:19], v[96:99], 0
v_mfma_f32_16x16x32_bf16 v[28:31], v[20:23], v[100:103], v[28:31]
buffer_store_dwordx2 v[138:139], v248, s[8:11], s21 offen offset:256 sc1
v_mfma_f32_16x16x32_bf16 v[44:47], v[32:35], v[96:99], 0
v_mfma_f32_16x16x32_bf16 v[44:47], v[36:39], v[100:103], v[44:47]
v_mfma_f32_16x16x32_bf16 v[60:63], v[48:51], v[96:99], 0
v_mfma_f32_16x16x32_bf16 v[60:63], v[52:55], v[100:103], v[60:63]
s_waitcnt lgkmcnt(0)
v_mfma_f32_16x16x32_bf16 v[64:67], a[0:3], v[172:175], 0
ds_read_b128 v[196:199], v252 offset:6144
v_mfma_f32_16x16x32_bf16 v[64:67], a[4:7], v[176:179], v[64:67]
v_cvt_pk_bf16_f32 v147, v8, v12
v_cvt_pk_bf16_f32 v149, v9, v13
v_mfma_f32_16x16x32_bf16 v[64:67], a[8:11], v[180:183], v[64:67]
v_cvt_pk_bf16_f32 v151, v10, v14
v_cvt_pk_bf16_f32 v153, v11, v15
ds_read_b128 v[200:203], v252 offset:7168
v_mfma_f32_16x16x32_bf16 v[64:67], a[12:15], v[184:187], v[64:67]
v_cvt_pk_bf16_f32 v155, v24, v28
v_cvt_pk_bf16_f32 v157, v25, v29
v_mfma_f32_16x16x32_bf16 v[64:67], a[16:19], v[188:191], v[64:67]
v_cvt_pk_bf16_f32 v159, v26, v30
v_cvt_pk_bf16_f32 v161, v27, v31
ds_read_b128 v[204:207], v252 offset:8192
v_mfma_f32_16x16x32_bf16 v[64:67], a[20:23], v[192:195], v[64:67]
v_cvt_pk_bf16_f32 v163, v40, v44
v_cvt_pk_bf16_f32 v165, v41, v45
v_mfma_f32_16x16x32_bf16 v[68:71], a[48:51], v[172:175], 0
v_cvt_pk_bf16_f32 v167, v42, v46
v_cvt_pk_bf16_f32 v169, v43, v47
ds_read_b128 v[208:211], v252 offset:9216
v_mfma_f32_16x16x32_bf16 v[68:71], a[52:55], v[176:179], v[68:71]
v_cvt_pk_bf16_f32 v171, v56, v60
v_mfma_f32_16x16x32_bf16 v[68:71], a[56:59], v[180:183], v[68:71]
ds_read_b128 v[212:215], v252 offset:10240
v_mfma_f32_16x16x32_bf16 v[68:71], a[60:63], v[184:187], v[68:71]
buffer_store_dwordx2 v[146:147], v239, s[8:11], s21 offen offset:384 sc1
v_mfma_f32_16x16x32_bf16 v[68:71], a[64:67], v[188:191], v[68:71]
ds_read_b128 v[216:219], v252 offset:11264
v_mfma_f32_16x16x32_bf16 v[68:71], a[68:71], v[192:195], v[68:71]
v_mfma_f32_16x16x32_bf16 v[72:75], a[96:99], v[172:175], 0
v_mfma_f32_16x16x32_bf16 v[72:75], a[100:103], v[176:179], v[72:75]
buffer_store_dwordx2 v[140:141], v249, s[8:11], s21 offen offset:256 sc1
v_mfma_f32_16x16x32_bf16 v[72:75], a[104:107], v[180:183], v[72:75]
v_mfma_f32_16x16x32_bf16 v[72:75], a[108:111], v[184:187], v[72:75]
v_mfma_f32_16x16x32_bf16 v[72:75], a[112:115], v[188:191], v[72:75]
v_mfma_f32_16x16x32_bf16 v[72:75], a[116:119], v[192:195], v[72:75]
s_waitcnt lgkmcnt(0)
v_mfma_f32_16x16x32_bf16 v[64:67], a[24:27], v[196:199], v[64:67]
ds_read_b128 v[172:175], v252 offset:12288
v_mfma_f32_16x16x32_bf16 v[64:67], a[28:31], v[200:203], v[64:67]
v_mfma_f32_16x16x32_bf16 v[64:67], a[32:35], v[204:207], v[64:67]
ds_read_b128 v[176:179], v252 offset:13312
v_mfma_f32_16x16x32_bf16 v[64:67], a[36:39], v[208:211], v[64:67]
v_mfma_f32_16x16x32_bf16 v[64:67], a[40:43], v[212:215], v[64:67]
ds_read_b128 v[180:183], v252 offset:14336
v_mfma_f32_16x16x32_bf16 v[64:67], a[44:47], v[216:219], v[64:67]
v_mfma_f32_16x16x32_bf16 v[68:71], a[72:75], v[196:199], v[68:71]
ds_read_b128 v[184:187], v252 offset:15360
v_mfma_f32_16x16x32_bf16 v[68:71], a[76:79], v[200:203], v[68:71]
ds_read_u16 v110, v254 offset:512
v_mfma_f32_16x16x32_bf16 v[68:71], a[80:83], v[204:207], v[68:71]
ds_read_b128 v[188:191], v252 offset:16384
v_mfma_f32_16x16x32_bf16 v[68:71], a[84:87], v[208:211], v[68:71]
buffer_store_dwordx2 v[148:149], v240, s[8:11], s21 offen offset:384 sc1
v_mfma_f32_16x16x32_bf16 v[68:71], a[88:91], v[212:215], v[68:71]
ds_read_b128 v[192:195], v252 offset:17408
v_mfma_f32_16x16x32_bf16 v[68:71], a[92:95], v[216:219], v[68:71]
ds_read_u16 v118, v254 offset:520
v_mfma_f32_16x16x32_bf16 v[72:75], a[120:123], v[196:199], v[72:75]
v_mfma_f32_16x16x32_bf16 v[72:75], a[124:127], v[200:203], v[72:75]
v_cvt_pk_bf16_f32 v104, v64, v65
v_cvt_pk_bf16_f32 v105, v66, v67
buffer_store_dwordx2 v[142:143], v250, s[8:11], s21 offen offset:256 sc1
v_mfma_f32_16x16x32_bf16 v[72:75], a[128:131], v[204:207], v[72:75]
v_mfma_f32_16x16x32_bf16 v[72:75], a[132:135], v[208:211], v[72:75]
v_mfma_f32_16x16x32_bf16 v[72:75], a[136:139], v[212:215], v[72:75]
v_mfma_f32_16x16x32_bf16 v[72:75], a[140:143], v[216:219], v[72:75]
s_waitcnt lgkmcnt(1)
v_mfma_f32_16x16x32_bf16 v[76:79], a[0:3], v[172:175], 0
ds_read_b128 v[196:199], v252 offset:18432
v_mfma_f32_16x16x32_bf16 v[76:79], a[4:7], v[176:179], v[76:79]
v_cvt_pk_bf16_f32 v106, v68, v69
v_cvt_pk_bf16_f32 v107, v70, v71
v_mfma_f32_16x16x32_bf16 v[76:79], a[8:11], v[180:183], v[76:79]
ds_read_b128 v[200:203], v252 offset:19456
v_mfma_f32_16x16x32_bf16 v[76:79], a[12:15], v[184:187], v[76:79]
v_mfma_f32_16x16x32_bf16 v[76:79], a[16:19], v[188:191], v[76:79]
ds_read_b128 v[204:207], v252 offset:20480
v_mfma_f32_16x16x32_bf16 v[76:79], a[20:23], v[192:195], v[76:79]
v_mfma_f32_16x16x32_bf16 v[80:83], a[48:51], v[172:175], 0
ds_read_b128 v[208:211], v252 offset:21504
v_mfma_f32_16x16x32_bf16 v[80:83], a[52:55], v[176:179], v[80:83]
v_cvt_pk_bf16_f32 v108, v72, v73
v_cvt_pk_bf16_f32 v109, v74, v75
v_mfma_f32_16x16x32_bf16 v[80:83], a[56:59], v[180:183], v[80:83]
ds_read_b128 v[212:215], v252 offset:22528
v_mfma_f32_16x16x32_bf16 v[80:83], a[60:63], v[184:187], v[80:83]
buffer_store_dwordx2 v[150:151], v241, s[8:11], s21 offen offset:384 sc1
v_mfma_f32_16x16x32_bf16 v[80:83], a[64:67], v[188:191], v[80:83]
ds_read_b128 v[216:219], v252 offset:23552
v_mfma_f32_16x16x32_bf16 v[80:83], a[68:71], v[192:195], v[80:83]
v_mfma_f32_16x16x32_bf16 v[84:87], a[96:99], v[172:175], 0
s_cmp_eq_u32 s36, 2
s_cselect_b32 s14, 0, 589824
v_mfma_f32_16x16x32_bf16 v[84:87], a[100:103], v[176:179], v[84:87]
s_add_u32 s25, s21, 1746432
s_mov_b64 exec, 0xffff
buffer_store_dwordx2 v[144:145], v239, s[8:11], s25 offen offset:256 sc1
s_mov_b64 exec, -1
v_mfma_f32_16x16x32_bf16 v[84:87], a[104:107], v[180:183], v[84:87]
v_mfma_f32_16x16x32_bf16 v[84:87], a[108:111], v[184:187], v[84:87]
v_mfma_f32_16x16x32_bf16 v[84:87], a[112:115], v[188:191], v[84:87]
v_mfma_f32_16x16x32_bf16 v[84:87], a[116:119], v[192:195], v[84:87]
s_waitcnt vmcnt(32) lgkmcnt(0)
s_barrier
v_add_u32 v252, 24576, v252
v_mfma_f32_16x16x32_bf16 v[76:79], a[24:27], v[196:199], v[76:79]
s_add_u32 m0, s17, 0
s_mov_b32 s24, 0
v_mfma_f32_16x16x32_bf16 v[76:79], a[28:31], v[200:203], v[76:79]
ds_read_b128 v[172:175], v252 offset:0
v_mfma_f32_16x16x32_bf16 v[76:79], a[32:35], v[204:207], v[76:79]
buffer_load_dwordx4 v251, s[12:15], s24 offen offset:0  lds
v_mfma_f32_16x16x32_bf16 v[76:79], a[36:39], v[208:211], v[76:79]
ds_read_b128 v[176:179], v252 offset:1024
v_mfma_f32_16x16x32_bf16 v[76:79], a[40:43], v[212:215], v[76:79]
v_mfma_f32_16x16x32_bf16 v[76:79], a[44:47], v[216:219], v[76:79]
ds_read_b128 v[180:183], v252 offset:2048
v_mfma_f32_16x16x32_bf16 v[80:83], a[72:75], v[196:199], v[80:83]
buffer_load_dwordx4 v251, s[12:15], s24 offen offset:1024  lds
v_mfma_f32_16x16x32_bf16 v[80:83], a[76:79], v[200:203], v[80:83]
ds_read_b128 v[184:187], v252 offset:3072
v_mfma_f32_16x16x32_bf16 v[80:83], a[80:83], v[204:207], v[80:83]
v_mfma_f32_16x16x32_bf16 v[80:83], a[84:87], v[208:211], v[80:83]
ds_read_b128 v[188:191], v252 offset:4096
buffer_store_dwordx2 v[152:153], v242, s[8:11], s21 offen offset:384 sc1
v_mfma_f32_16x16x32_bf16 v[80:83], a[88:91], v[212:215], v[80:83]
buffer_load_dwordx4 v251, s[12:15], s24 offen offset:2048  lds
v_mfma_f32_16x16x32_bf16 v[80:83], a[92:95], v[216:219], v[80:83]
ds_read_b128 v[192:195], v252 offset:5120
v_mfma_f32_16x16x32_bf16 v[84:87], a[120:123], v[196:199], v[84:87]
v_mfma_f32_16x16x32_bf16 v[84:87], a[124:127], v[200:203], v[84:87]
v_cvt_pk_bf16_f32 v112, v76, v77
v_cvt_pk_bf16_f32 v113, v78, v79
v_mfma_f32_16x16x32_bf16 v[84:87], a[128:131], v[204:207], v[84:87]
buffer_load_dwordx4 v251, s[12:15], s24 offen offset:3072  lds
v_mfma_f32_16x16x32_bf16 v[84:87], a[132:135], v[208:211], v[84:87]
v_mfma_f32_16x16x32_bf16 v[84:87], a[136:139], v[212:215], v[84:87]
s_add_u32 m0, s17, 4096
s_mov_b32 s24, 4096
v_mfma_f32_16x16x32_bf16 v[84:87], a[140:143], v[216:219], v[84:87]
v_mfma_f32_16x16x32_bf16 v[8:11], v[0:3], v[104:107], 0
buffer_load_dwordx4 v251, s[12:15], s24 offen offset:0  lds
v_mfma_f32_16x16x32_bf16 v[8:11], v[4:7], v[108:111], v[8:11]
v_cvt_pk_bf16_f32 v114, v80, v81
v_cvt_pk_bf16_f32 v115, v82, v83
v_mfma_f32_16x16x32_bf16 v[24:27], v[16:19], v[104:107], 0
v_mfma_f32_16x16x32_bf16 v[24:27], v[20:23], v[108:111], v[24:27]
v_mfma_f32_16x16x32_bf16 v[40:43], v[32:35], v[104:107], 0
buffer_load_dwordx4 v251, s[12:15], s24 offen offset:1024  lds
v_mfma_f32_16x16x32_bf16 v[40:43], v[36:39], v[108:111], v[40:43]
v_mfma_f32_16x16x32_bf16 v[56:59], v[48:51], v[104:107], 0
v_mfma_f32_16x16x32_bf16 v[56:59], v[52:55], v[108:111], v[56:59]
v_cvt_pk_bf16_f32 v116, v84, v85
v_cvt_pk_bf16_f32 v117, v86, v87
v_mfma_f32_16x16x32_bf16 v[12:15], v[0:3], v[112:115], 0
s_nop 0
v_mfma_f32_16x16x32_bf16 v[12:15], v[4:7], v[116:119], v[12:15]
buffer_store_dwordx2 v[154:155], v243, s[8:11], s21 offen offset:384 sc1
v_mfma_f32_16x16x32_bf16 v[28:31], v[16:19], v[112:115], 0
v_mfma_f32_16x16x32_bf16 v[28:31], v[20:23], v[116:119], v[28:31]
v_mfma_f32_16x16x32_bf16 v[44:47], v[32:35], v[112:115], 0
v_mfma_f32_16x16x32_bf16 v[44:47], v[36:39], v[116:119], v[44:47]
v_mfma_f32_16x16x32_bf16 v[60:63], v[48:51], v[112:115], 0
v_mfma_f32_16x16x32_bf16 v[60:63], v[52:55], v[116:119], v[60:63]
s_waitcnt lgkmcnt(0)
v_mfma_f32_16x16x32_bf16 v[64:67], a[0:3], v[172:175], 0
ds_read_b128 v[196:199], v252 offset:6144
v_mfma_f32_16x16x32_bf16 v[64:67], a[4:7], v[176:179], v[64:67]
v_cvt_pk_bf16_f32 v120, v8, v12
v_cvt_pk_bf16_f32 v122, v9, v13
v_mfma_f32_16x16x32_bf16 v[64:67], a[8:11], v[180:183], v[64:67]
v_cvt_pk_bf16_f32 v124, v10, v14
v_cvt_pk_bf16_f32 v126, v11, v15
ds_read_b128 v[200:203], v252 offset:7168
v_mfma_f32_16x16x32_bf16 v[64:67], a[12:15], v[184:187], v[64:67]
v_cvt_pk_bf16_f32 v128, v24, v28
v_cvt_pk_bf16_f32 v130, v25, v29
v_mfma_f32_16x16x32_bf16 v[64:67], a[16:19], v[188:191], v[64:67]
v_cvt_pk_bf16_f32 v132, v26, v30
v_cvt_pk_bf16_f32 v134, v27, v31
ds_read_b128 v[204:207], v252 offset:8192
v_mfma_f32_16x16x32_bf16 v[64:67], a[20:23], v[192:195], v[64:67]
v_cvt_pk_bf16_f32 v136, v40, v44
v_cvt_pk_bf16_f32 v138, v41, v45
v_mfma_f32_16x16x32_bf16 v[68:71], a[48:51], v[172:175], 0
v_cvt_pk_bf16_f32 v140, v42, v46
v_cvt_pk_bf16_f32 v142, v43, v47
ds_read_b128 v[208:211], v252 offset:9216
v_mfma_f32_16x16x32_bf16 v[68:71], a[52:55], v[176:179], v[68:71]
v_cvt_pk_bf16_f32 v144, v56, v60
v_mfma_f32_16x16x32_bf16 v[68:71], a[56:59], v[180:183], v[68:71]
ds_read_b128 v[212:215], v252 offset:10240
v_mfma_f32_16x16x32_bf16 v[68:71], a[60:63], v[184:187], v[68:71]
v_mfma_f32_16x16x32_bf16 v[68:71], a[64:67], v[188:191], v[68:71]
ds_read_b128 v[216:219], v252 offset:11264
v_mfma_f32_16x16x32_bf16 v[68:71], a[68:71], v[192:195], v[68:71]
buffer_store_dwordx2 v[156:157], v244, s[8:11], s21 offen offset:384 sc1
v_mfma_f32_16x16x32_bf16 v[72:75], a[96:99], v[172:175], 0
v_mfma_f32_16x16x32_bf16 v[72:75], a[100:103], v[176:179], v[72:75]
v_mfma_f32_16x16x32_bf16 v[72:75], a[104:107], v[180:183], v[72:75]
v_mfma_f32_16x16x32_bf16 v[72:75], a[108:111], v[184:187], v[72:75]
v_mfma_f32_16x16x32_bf16 v[72:75], a[112:115], v[188:191], v[72:75]
v_mfma_f32_16x16x32_bf16 v[72:75], a[116:119], v[192:195], v[72:75]
s_waitcnt lgkmcnt(0)
v_mfma_f32_16x16x32_bf16 v[64:67], a[24:27], v[196:199], v[64:67]
ds_read_b128 v[172:175], v252 offset:12288
v_mfma_f32_16x16x32_bf16 v[64:67], a[28:31], v[200:203], v[64:67]
v_mfma_f32_16x16x32_bf16 v[64:67], a[32:35], v[204:207], v[64:67]
ds_read_b128 v[176:179], v252 offset:13312
v_mfma_f32_16x16x32_bf16 v[64:67], a[36:39], v[208:211], v[64:67]
v_mfma_f32_16x16x32_bf16 v[64:67], a[40:43], v[212:215], v[64:67]
ds_read_b128 v[180:183], v252 offset:14336
v_mfma_f32_16x16x32_bf16 v[64:67], a[44:47], v[216:219], v[64:67]
v_mfma_f32_16x16x32_bf16 v[68:71], a[72:75], v[196:199], v[68:71]
ds_read_b128 v[184:187], v252 offset:15360
v_mfma_f32_16x16x32_bf16 v[68:71], a[76:79], v[200:203], v[68:71]
ds_read_u16 v94, v254 offset:576
v_mfma_f32_16x16x32_bf16 v[68:71], a[80:83], v[204:207], v[68:71]
ds_read_b128 v[188:191], v252 offset:16384
v_mfma_f32_16x16x32_bf16 v[68:71], a[84:87], v[208:211], v[68:71]
v_mfma_f32_16x16x32_bf16 v[68:71], a[88:91], v[212:215], v[68:71]
ds_read_b128 v[192:195], v252 offset:17408
v_mfma_f32_16x16x32_bf16 v[68:71], a[92:95], v[216:219], v[68:71]
ds_read_u16 v102, v254 offset:584
buffer_store_dwordx2 v[158:159], v245, s[8:11], s21 offen offset:384 sc1
v_mfma_f32_16x16x32_bf16 v[72:75], a[120:123], v[196:199], v[72:75]
v_mfma_f32_16x16x32_bf16 v[72:75], a[124:127], v[200:203], v[72:75]
v_cvt_pk_bf16_f32 v88, v64, v65
v_cvt_pk_bf16_f32 v89, v66, v67
v_mfma_f32_16x16x32_bf16 v[72:75], a[128:131], v[204:207], v[72:75]
v_mfma_f32_16x16x32_bf16 v[72:75], a[132:135], v[208:211], v[72:75]
v_mfma_f32_16x16x32_bf16 v[72:75], a[136:139], v[212:215], v[72:75]
v_mfma_f32_16x16x32_bf16 v[72:75], a[140:143], v[216:219], v[72:75]
s_waitcnt lgkmcnt(1)
v_mfma_f32_16x16x32_bf16 v[76:79], a[0:3], v[172:175], 0
ds_read_b128 v[196:199], v252 offset:18432
v_mfma_f32_16x16x32_bf16 v[76:79], a[4:7], v[176:179], v[76:79]
v_cvt_pk_bf16_f32 v90, v68, v69
v_cvt_pk_bf16_f32 v91, v70, v71
v_mfma_f32_16x16x32_bf16 v[76:79], a[8:11], v[180:183], v[76:79]
ds_read_b128 v[200:203], v252 offset:19456
v_mfma_f32_16x16x32_bf16 v[76:79], a[12:15], v[184:187], v[76:79]
v_mfma_f32_16x16x32_bf16 v[76:79], a[16:19], v[188:191], v[76:79]
ds_read_b128 v[204:207], v252 offset:20480
v_mfma_f32_16x16x32_bf16 v[76:79], a[20:23], v[192:195], v[76:79]
v_mfma_f32_16x16x32_bf16 v[80:83], a[48:51], v[172:175], 0
ds_read_b128 v[208:211], v252 offset:21504
v_mfma_f32_16x16x32_bf16 v[80:83], a[52:55], v[176:179], v[80:83]
v_cvt_pk_bf16_f32 v92, v72, v73
v_cvt_pk_bf16_f32 v93, v74, v75
v_mfma_f32_16x16x32_bf16 v[80:83], a[56:59], v[180:183], v[80:83]
ds_read_b128 v[212:215], v252 offset:22528
v_mfma_f32_16x16x32_bf16 v[80:83], a[60:63], v[184:187], v[80:83]
v_mfma_f32_16x16x32_bf16 v[80:83], a[64:67], v[188:191], v[80:83]
ds_read_b128 v[216:219], v252 offset:23552
v_mfma_f32_16x16x32_bf16 v[80:83], a[68:71], v[192:195], v[80:83]
buffer_store_dwordx2 v[160:161], v246, s[8:11], s21 offen offset:384 sc1
v_mfma_f32_16x16x32_bf16 v[84:87], a[96:99], v[172:175], 0
v_mfma_f32_16x16x32_bf16 v[84:87], a[100:103], v[176:179], v[84:87]
v_mfma_f32_16x16x32_bf16 v[84:87], a[104:107], v[180:183], v[84:87]
v_mfma_f32_16x16x32_bf16 v[84:87], a[108:111], v[184:187], v[84:87]
v_mfma_f32_16x16x32_bf16 v[84:87], a[112:115], v[188:191], v[84:87]
v_mfma_f32_16x16x32_bf16 v[84:87], a[116:119], v[192:195], v[84:87]
s_waitcnt vmcnt(29) lgkmcnt(0)
s_barrier
v_add_u32 v252, 24576, v252
v_mfma_f32_16x16x32_bf16 v[76:79], a[24:27], v[196:199], v[76:79]
s_add_u32 m0, s17, 24576
s_mov_b32 s24, 24576
v_mfma_f32_16x16x32_bf16 v[76:79], a[28:31], v[200:203], v[76:79]
ds_read_b128 v[172:175], v252 offset:0
v_mfma_f32_16x16x32_bf16 v[76:79], a[32:35], v[204:207], v[76:79]
buffer_load_dwordx4 v251, s[12:15], s24 offen offset:0  lds
v_mfma_f32_16x16x32_bf16 v[76:79], a[36:39], v[208:211], v[76:79]
ds_read_b128 v[176:179], v252 offset:1024
v_mfma_f32_16x16x32_bf16 v[76:79], a[40:43], v[212:215], v[76:79]
v_mfma_f32_16x16x32_bf16 v[76:79], a[44:47], v[216:219], v[76:79]
ds_read_b128 v[180:183], v252 offset:2048
v_mfma_f32_16x16x32_bf16 v[80:83], a[72:75], v[196:199], v[80:83]
buffer_load_dwordx4 v251, s[12:15], s24 offen offset:1024  lds
v_mfma_f32_16x16x32_bf16 v[80:83], a[76:79], v[200:203], v[80:83]
ds_read_b128 v[184:187], v252 offset:3072
v_mfma_f32_16x16x32_bf16 v[80:83], a[80:83], v[204:207], v[80:83]
v_mfma_f32_16x16x32_bf16 v[80:83], a[84:87], v[208:211], v[80:83]
ds_read_b128 v[188:191], v252 offset:4096
v_mfma_f32_16x16x32_bf16 v[80:83], a[88:91], v[212:215], v[80:83]
buffer_load_dwordx4 v251, s[12:15], s24 offen offset:2048  lds
v_mfma_f32_16x16x32_bf16 v[80:83], a[92:95], v[216:219], v[80:83]
ds_read_b128 v[192:195], v252 offset:5120
buffer_store_dwordx2 v[162:163], v247, s[8:11], s21 offen offset:384 sc1
v_mfma_f32_16x16x32_bf16 v[84:87], a[120:123], v[196:199], v[84:87]
v_mfma_f32_16x16x32_bf16 v[84:87], a[124:127], v[200:203], v[84:87]
v_cvt_pk_bf16_f32 v96, v76, v77
v_cvt_pk_bf16_f32 v97, v78, v79
v_mfma_f32_16x16x32_bf16 v[84:87], a[128:131], v[204:207], v[84:87]
buffer_load_dwordx4 v251, s[12:15], s24 offen offset:3072  lds
v_mfma_f32_16x16x32_bf16 v[84:87], a[132:135], v[208:211], v[84:87]
v_mfma_f32_16x16x32_bf16 v[84:87], a[136:139], v[212:215], v[84:87]
s_add_u32 m0, s17, 28672
s_mov_b32 s24, 28672
v_mfma_f32_16x16x32_bf16 v[84:87], a[140:143], v[216:219], v[84:87]
v_mfma_f32_16x16x32_bf16 v[8:11], v[0:3], v[88:91], 0
buffer_load_dwordx4 v251, s[12:15], s24 offen offset:0  lds
v_mfma_f32_16x16x32_bf16 v[8:11], v[4:7], v[92:95], v[8:11]
v_cvt_pk_bf16_f32 v98, v80, v81
v_cvt_pk_bf16_f32 v99, v82, v83
v_mfma_f32_16x16x32_bf16 v[24:27], v[16:19], v[88:91], 0
v_mfma_f32_16x16x32_bf16 v[24:27], v[20:23], v[92:95], v[24:27]
v_mfma_f32_16x16x32_bf16 v[40:43], v[32:35], v[88:91], 0
buffer_load_dwordx4 v251, s[12:15], s24 offen offset:1024  lds
v_mfma_f32_16x16x32_bf16 v[40:43], v[36:39], v[92:95], v[40:43]
v_mfma_f32_16x16x32_bf16 v[56:59], v[48:51], v[88:91], 0
v_mfma_f32_16x16x32_bf16 v[56:59], v[52:55], v[92:95], v[56:59]
v_cvt_pk_bf16_f32 v100, v84, v85
v_cvt_pk_bf16_f32 v101, v86, v87
v_mfma_f32_16x16x32_bf16 v[12:15], v[0:3], v[96:99], 0
s_nop 0
v_mfma_f32_16x16x32_bf16 v[12:15], v[4:7], v[100:103], v[12:15]
v_mfma_f32_16x16x32_bf16 v[28:31], v[16:19], v[96:99], 0
v_mfma_f32_16x16x32_bf16 v[28:31], v[20:23], v[100:103], v[28:31]
buffer_store_dwordx2 v[164:165], v248, s[8:11], s21 offen offset:384 sc1
v_mfma_f32_16x16x32_bf16 v[44:47], v[32:35], v[96:99], 0
v_mfma_f32_16x16x32_bf16 v[44:47], v[36:39], v[100:103], v[44:47]
v_mfma_f32_16x16x32_bf16 v[60:63], v[48:51], v[96:99], 0
v_mfma_f32_16x16x32_bf16 v[60:63], v[52:55], v[100:103], v[60:63]
s_waitcnt lgkmcnt(0)
v_mfma_f32_16x16x32_bf16 v[64:67], a[0:3], v[172:175], 0
ds_read_b128 v[196:199], v252 offset:6144
v_mfma_f32_16x16x32_bf16 v[64:67], a[4:7], v[176:179], v[64:67]
v_cvt_pk_bf16_f32 v121, v8, v12
v_cvt_pk_bf16_f32 v123, v9, v13
v_mfma_f32_16x16x32_bf16 v[64:67], a[8:11], v[180:183], v[64:67]
v_cvt_pk_bf16_f32 v125, v10, v14
v_cvt_pk_bf16_f32 v127, v11, v15
ds_read_b128 v[200:203], v252 offset:7168
v_mfma_f32_16x16x32_bf16 v[64:67], a[12:15], v[184:187], v[64:67]
v_cvt_pk_bf16_f32 v129, v24, v28
v_cvt_pk_bf16_f32 v131, v25, v29
v_mfma_f32_16x16x32_bf16 v[64:67], a[16:19], v[188:191], v[64:67]
v_cvt_pk_bf16_f32 v133, v26, v30
v_cvt_pk_bf16_f32 v135, v27, v31
ds_read_b128 v[204:207], v252 offset:8192
v_mfma_f32_16x16x32_bf16 v[64:67], a[20:23], v[192:195], v[64:67]
v_cvt_pk_bf16_f32 v137, v40, v44
v_cvt_pk_bf16_f32 v139, v41, v45
v_mfma_f32_16x16x32_bf16 v[68:71], a[48:51], v[172:175], 0
v_cvt_pk_bf16_f32 v141, v42, v46
v_cvt_pk_bf16_f32 v143, v43, v47
ds_read_b128 v[208:211], v252 offset:9216
v_mfma_f32_16x16x32_bf16 v[68:71], a[52:55], v[176:179], v[68:71]
v_cvt_pk_bf16_f32 v145, v56, v60
v_mfma_f32_16x16x32_bf16 v[68:71], a[56:59], v[180:183], v[68:71]
ds_read_b128 v[212:215], v252 offset:10240
v_mfma_f32_16x16x32_bf16 v[68:71], a[60:63], v[184:187], v[68:71]
buffer_store_dwordx2 v[120:121], v239, s[8:11], s21 offen offset:512 sc1
v_mfma_f32_16x16x32_bf16 v[68:71], a[64:67], v[188:191], v[68:71]
ds_read_b128 v[216:219], v252 offset:11264
v_mfma_f32_16x16x32_bf16 v[68:71], a[68:71], v[192:195], v[68:71]
v_mfma_f32_16x16x32_bf16 v[72:75], a[96:99], v[172:175], 0
v_mfma_f32_16x16x32_bf16 v[72:75], a[100:103], v[176:179], v[72:75]
buffer_store_dwordx2 v[166:167], v249, s[8:11], s21 offen offset:384 sc1
v_mfma_f32_16x16x32_bf16 v[72:75], a[104:107], v[180:183], v[72:75]
v_mfma_f32_16x16x32_bf16 v[72:75], a[108:111], v[184:187], v[72:75]
v_mfma_f32_16x16x32_bf16 v[72:75], a[112:115], v[188:191], v[72:75]
v_mfma_f32_16x16x32_bf16 v[72:75], a[116:119], v[192:195], v[72:75]
s_waitcnt lgkmcnt(0)
v_mfma_f32_16x16x32_bf16 v[64:67], a[24:27], v[196:199], v[64:67]
ds_read_b128 v[172:175], v252 offset:12288
v_mfma_f32_16x16x32_bf16 v[64:67], a[28:31], v[200:203], v[64:67]
v_mfma_f32_16x16x32_bf16 v[64:67], a[32:35], v[204:207], v[64:67]
ds_read_b128 v[176:179], v252 offset:13312
v_mfma_f32_16x16x32_bf16 v[64:67], a[36:39], v[208:211], v[64:67]
buffer_store_dwordx2 v[122:123], v240, s[8:11], s21 offen offset:512 sc1
v_mfma_f32_16x16x32_bf16 v[64:67], a[40:43], v[212:215], v[64:67]
ds_read_b128 v[180:183], v252 offset:14336
v_mfma_f32_16x16x32_bf16 v[64:67], a[44:47], v[216:219], v[64:67]
v_mfma_f32_16x16x32_bf16 v[68:71], a[72:75], v[196:199], v[68:71]
ds_read_b128 v[184:187], v252 offset:15360
v_mfma_f32_16x16x32_bf16 v[68:71], a[76:79], v[200:203], v[68:71]
ds_read_u16 v110, v254 offset:640
v_mfma_f32_16x16x32_bf16 v[68:71], a[80:83], v[204:207], v[68:71]
ds_read_b128 v[188:191], v252 offset:16384
v_mfma_f32_16x16x32_bf16 v[68:71], a[84:87], v[208:211], v[68:71]
v_mfma_f32_16x16x32_bf16 v[68:71], a[88:91], v[212:215], v[68:71]
ds_read_b128 v[192:195], v252 offset:17408
v_mfma_f32_16x16x32_bf16 v[68:71], a[92:95], v[216:219], v[68:71]
ds_read_u16 v118, v254 offset:648
v_mfma_f32_16x16x32_bf16 v[72:75], a[120:123], v[196:199], v[72:75]
v_mfma_f32_16x16x32_bf16 v[72:75], a[124:127], v[200:203], v[72:75]
v_cvt_pk_bf16_f32 v104, v64, v65
v_cvt_pk_bf16_f32 v105, v66, v67
buffer_store_dwordx2 v[168:169], v250, s[8:11], s21 offen offset:384 sc1
v_mfma_f32_16x16x32_bf16 v[72:75], a[128:131], v[204:207], v[72:75]
v_mfma_f32_16x16x32_bf16 v[72:75], a[132:135], v[208:211], v[72:75]
buffer_store_dwordx2 v[124:125], v241, s[8:11], s21 offen offset:512 sc1
v_mfma_f32_16x16x32_bf16 v[72:75], a[136:139], v[212:215], v[72:75]
v_mfma_f32_16x16x32_bf16 v[72:75], a[140:143], v[216:219], v[72:75]
s_waitcnt lgkmcnt(1)
v_mfma_f32_16x16x32_bf16 v[76:79], a[0:3], v[172:175], 0
ds_read_b128 v[196:199], v252 offset:18432
v_mfma_f32_16x16x32_bf16 v[76:79], a[4:7], v[176:179], v[76:79]
v_cvt_pk_bf16_f32 v106, v68, v69
v_cvt_pk_bf16_f32 v107, v70, v71
v_mfma_f32_16x16x32_bf16 v[76:79], a[8:11], v[180:183], v[76:79]
ds_read_b128 v[200:203], v252 offset:19456
v_mfma_f32_16x16x32_bf16 v[76:79], a[12:15], v[184:187], v[76:79]
v_mfma_f32_16x16x32_bf16 v[76:79], a[16:19], v[188:191], v[76:79]
ds_read_b128 v[204:207], v252 offset:20480
v_mfma_f32_16x16x32_bf16 v[76:79], a[20:23], v[192:195], v[76:79]
v_mfma_f32_16x16x32_bf16 v[80:83], a[48:51], v[172:175], 0
ds_read_b128 v[208:211], v252 offset:21504
v_mfma_f32_16x16x32_bf16 v[80:83], a[52:55], v[176:179], v[80:83]
v_cvt_pk_bf16_f32 v108, v72, v73
v_cvt_pk_bf16_f32 v109, v74, v75
v_mfma_f32_16x16x32_bf16 v[80:83], a[56:59], v[180:183], v[80:83]
ds_read_b128 v[212:215], v252 offset:22528
v_mfma_f32_16x16x32_bf16 v[80:83], a[60:63], v[184:187], v[80:83]
buffer_store_dwordx2 v[126:127], v242, s[8:11], s21 offen offset:512 sc1
v_mfma_f32_16x16x32_bf16 v[80:83], a[64:67], v[188:191], v[80:83]
ds_read_b128 v[216:219], v252 offset:23552
v_mfma_f32_16x16x32_bf16 v[80:83], a[68:71], v[192:195], v[80:83]
v_mfma_f32_16x16x32_bf16 v[84:87], a[96:99], v[172:175], 0
v_mfma_f32_16x16x32_bf16 v[84:87], a[100:103], v[176:179], v[84:87]
s_add_u32 s25, s21, 1746432
s_mov_b64 exec, 0xffff
buffer_store_dwordx2 v[170:171], v239, s[8:11], s25 offen offset:384 sc1
s_mov_b64 exec, -1
v_mfma_f32_16x16x32_bf16 v[84:87], a[104:107], v[180:183], v[84:87]
v_mfma_f32_16x16x32_bf16 v[84:87], a[108:111], v[184:187], v[84:87]
v_mfma_f32_16x16x32_bf16 v[84:87], a[112:115], v[188:191], v[84:87]
v_mfma_f32_16x16x32_bf16 v[84:87], a[116:119], v[192:195], v[84:87]
s_waitcnt vmcnt(33) lgkmcnt(0)
s_barrier
v_add_u32 v252, 24576, v252
v_mfma_f32_16x16x32_bf16 v[76:79], a[24:27], v[196:199], v[76:79]
s_add_u32 m0, s17, 49152
s_mov_b32 s24, 49152
v_mfma_f32_16x16x32_bf16 v[76:79], a[28:31], v[200:203], v[76:79]
ds_read_b128 v[172:175], v252 offset:0
v_mfma_f32_16x16x32_bf16 v[76:79], a[32:35], v[204:207], v[76:79]
buffer_load_dwordx4 v251, s[12:15], s24 offen offset:0  lds
v_mfma_f32_16x16x32_bf16 v[76:79], a[36:39], v[208:211], v[76:79]
ds_read_b128 v[176:179], v252 offset:1024
buffer_store_dwordx2 v[128:129], v243, s[8:11], s21 offen offset:512 sc1
v_mfma_f32_16x16x32_bf16 v[76:79], a[40:43], v[212:215], v[76:79]
v_mfma_f32_16x16x32_bf16 v[76:79], a[44:47], v[216:219], v[76:79]
ds_read_b128 v[180:183], v252 offset:2048
v_mfma_f32_16x16x32_bf16 v[80:83], a[72:75], v[196:199], v[80:83]
buffer_load_dwordx4 v251, s[12:15], s24 offen offset:1024  lds
v_mfma_f32_16x16x32_bf16 v[80:83], a[76:79], v[200:203], v[80:83]
ds_read_b128 v[184:187], v252 offset:3072
v_mfma_f32_16x16x32_bf16 v[80:83], a[80:83], v[204:207], v[80:83]
v_mfma_f32_16x16x32_bf16 v[80:83], a[84:87], v[208:211], v[80:83]
ds_read_b128 v[188:191], v252 offset:4096
v_mfma_f32_16x16x32_bf16 v[80:83], a[88:91], v[212:215], v[80:83]
buffer_load_dwordx4 v251, s[12:15], s24 offen offset:2048  lds
v_mfma_f32_16x16x32_bf16 v[80:83], a[92:95], v[216:219], v[80:83]
ds_read_b128 v[192:195], v252 offset:5120
v_mfma_f32_16x16x32_bf16 v[84:87], a[120:123], v[196:199], v[84:87]
v_mfma_f32_16x16x32_bf16 v[84:87], a[124:127], v[200:203], v[84:87]
v_cvt_pk_bf16_f32 v112, v76, v77
v_cvt_pk_bf16_f32 v113, v78, v79
v_mfma_f32_16x16x32_bf16 v[84:87], a[128:131], v[204:207], v[84:87]
buffer_load_dwordx4 v251, s[12:15], s24 offen offset:3072  lds
v_mfma_f32_16x16x32_bf16 v[84:87], a[132:135], v[208:211], v[84:87]
buffer_store_dwordx2 v[130:131], v244, s[8:11], s21 offen offset:512 sc1
v_mfma_f32_16x16x32_bf16 v[84:87], a[136:139], v[212:215], v[84:87]
s_add_u32 m0, s17, 53248
s_mov_b32 s24, 53248
v_mfma_f32_16x16x32_bf16 v[84:87], a[140:143], v[216:219], v[84:87]
v_mfma_f32_16x16x32_bf16 v[8:11], v[0:3], v[104:107], 0
buffer_load_dwordx4 v251, s[12:15], s24 offen offset:0  lds
v_mfma_f32_16x16x32_bf16 v[8:11], v[4:7], v[108:111], v[8:11]
v_cvt_pk_bf16_f32 v114, v80, v81
v_cvt_pk_bf16_f32 v115, v82, v83
v_mfma_f32_16x16x32_bf16 v[24:27], v[16:19], v[104:107], 0
v_mfma_f32_16x16x32_bf16 v[24:27], v[20:23], v[108:111], v[24:27]
v_mfma_f32_16x16x32_bf16 v[40:43], v[32:35], v[104:107], 0
buffer_load_dwordx4 v251, s[12:15], s24 offen offset:1024  lds
v_mfma_f32_16x16x32_bf16 v[40:43], v[36:39], v[108:111], v[40:43]
v_mfma_f32_16x16x32_bf16 v[56:59], v[48:51], v[104:107], 0
v_mfma_f32_16x16x32_bf16 v[56:59], v[52:55], v[108:111], v[56:59]
v_cvt_pk_bf16_f32 v116, v84, v85
v_cvt_pk_bf16_f32 v117, v86, v87
v_mfma_f32_16x16x32_bf16 v[12:15], v[0:3], v[112:115], 0
s_nop 0
v_mfma_f32_16x16x32_bf16 v[12:15], v[4:7], v[116:119], v[12:15]
buffer_store_dwordx2 v[132:133], v245, s[8:11], s21 offen offset:512 sc1
v_mfma_f32_16x16x32_bf16 v[28:31], v[16:19], v[112:115], 0
v_mfma_f32_16x16x32_bf16 v[28:31], v[20:23], v[116:119], v[28:31]
v_mfma_f32_16x16x32_bf16 v[44:47], v[32:35], v[112:115], 0
v_mfma_f32_16x16x32_bf16 v[44:47], v[36:39], v[116:119], v[44:47]
v_mfma_f32_16x16x32_bf16 v[60:63], v[48:51], v[112:115], 0
v_mfma_f32_16x16x32_bf16 v[60:63], v[52:55], v[116:119], v[60:63]
s_waitcnt lgkmcnt(0)
v_mfma_f32_16x16x32_bf16 v[64:67], a[0:3], v[172:175], 0
ds_read_b128 v[196:199], v252 offset:12288
v_mfma_f32_16x16x32_bf16 v[64:67], a[4:7], v[176:179], v[64:67]
v_cvt_pk_bf16_f32 v146, v8, v12
v_cvt_pk_bf16_f32 v148, v9, v13
v_mfma_f32_16x16x32_bf16 v[64:67], a[8:11], v[180:183], v[64:67]
v_cvt_pk_bf16_f32 v150, v10, v14
v_cvt_pk_bf16_f32 v152, v11, v15
ds_read_b128 v[200:203], v252 offset:13312
v_mfma_f32_16x16x32_bf16 v[64:67], a[12:15], v[184:187], v[64:67]
v_cvt_pk_bf16_f32 v154, v24, v28
v_cvt_pk_bf16_f32 v156, v25, v29
v_mfma_f32_16x16x32_bf16 v[64:67], a[16:19], v[188:191], v[64:67]
v_cvt_pk_bf16_f32 v158, v26, v30
v_cvt_pk_bf16_f32 v160, v27, v31
ds_read_b128 v[204:207], v252 offset:14336
v_mfma_f32_16x16x32_bf16 v[64:67], a[20:23], v[192:195], v[64:67]
v_cvt_pk_bf16_f32 v162, v40, v44
v_cvt_pk_bf16_f32 v164, v41, v45
buffer_store_dwordx2 v[134:135], v246, s[8:11], s21 offen offset:512 sc1
v_mfma_f32_16x16x32_bf16 v[68:71], a[48:51], v[172:175], 0
v_cvt_pk_bf16_f32 v166, v42, v46
v_cvt_pk_bf16_f32 v168, v43, v47
ds_read_b128 v[208:211], v252 offset:15360
v_mfma_f32_16x16x32_bf16 v[68:71], a[52:55], v[176:179], v[68:71]
v_cvt_pk_bf16_f32 v170, v56, v60
v_mfma_f32_16x16x32_bf16 v[68:71], a[56:59], v[180:183], v[68:71]
ds_read_b128 v[212:215], v252 offset:16384
v_mfma_f32_16x16x32_bf16 v[68:71], a[60:63], v[184:187], v[68:71]
v_mfma_f32_16x16x32_bf16 v[68:71], a[64:67], v[188:191], v[68:71]
ds_read_b128 v[216:219], v252 offset:17408
v_mfma_f32_16x16x32_bf16 v[68:71], a[68:71], v[192:195], v[68:71]
v_mfma_f32_16x16x32_bf16 v[72:75], a[96:99], v[172:175], 0
v_mfma_f32_16x16x32_bf16 v[72:75], a[100:103], v[176:179], v[72:75]
v_mfma_f32_16x16x32_bf16 v[72:75], a[104:107], v[180:183], v[72:75]
v_mfma_f32_16x16x32_bf16 v[72:75], a[108:111], v[184:187], v[72:75]
v_mfma_f32_16x16x32_bf16 v[72:75], a[112:115], v[188:191], v[72:75]
v_mfma_f32_16x16x32_bf16 v[72:75], a[116:119], v[192:195], v[72:75]
s_waitcnt lgkmcnt(0)
buffer_store_dwordx2 v[136:137], v247, s[8:11], s21 offen offset:512 sc1
v_mfma_f32_16x16x32_bf16 v[76:79], a[0:3], v[196:199], 0
ds_read_b128 v[172:175], v252 offset:6144
v_mfma_f32_16x16x32_bf16 v[76:79], a[4:7], v[200:203], v[76:79]
v_mfma_f32_16x16x32_bf16 v[76:79], a[8:11], v[204:207], v[76:79]
ds_read_b128 v[176:179], v252 offset:7168
v_mfma_f32_16x16x32_bf16 v[76:79], a[12:15], v[208:211], v[76:79]
v_mfma_f32_16x16x32_bf16 v[76:79], a[16:19], v[212:215], v[76:79]
ds_read_b128 v[180:183], v252 offset:8192
v_mfma_f32_16x16x32_bf16 v[76:79], a[20:23], v[216:219], v[76:79]
v_mfma_f32_16x16x32_bf16 v[80:83], a[48:51], v[196:199], 0
ds_read_b128 v[184:187], v252 offset:9216
v_mfma_f32_16x16x32_bf16 v[80:83], a[52:55], v[200:203], v[80:83]
ds_read_u16 v94, v254 offset:704
v_mfma_f32_16x16x32_bf16 v[80:83], a[56:59], v[204:207], v[80:83]
ds_read_b128 v[188:191], v252 offset:10240
v_mfma_f32_16x16x32_bf16 v[80:83], a[60:63], v[208:211], v[80:83]
v_mfma_f32_16x16x32_bf16 v[80:83], a[64:67], v[212:215], v[80:83]
ds_read_b128 v[192:195], v252 offset:11264
v_mfma_f32_16x16x32_bf16 v[80:83], a[68:71], v[216:219], v[80:83]
ds_read_u16 v102, v254 offset:712
buffer_store_dwordx2 v[138:139], v248, s[8:11], s21 offen offset:512 sc1
v_mfma_f32_16x16x32_bf16 v[84:87], a[96:99], v[196:199], 0
v_mfma_f32_16x16x32_bf16 v[84:87], a[100:103], v[200:203], v[84:87]
v_mfma_f32_16x16x32_bf16 v[84:87], a[104:107], v[204:207], v[84:87]
v_mfma_f32_16x16x32_bf16 v[84:87], a[108:111], v[208:211], v[84:87]
v_mfma_f32_16x16x32_bf16 v[84:87], a[112:115], v[212:215], v[84:87]
v_mfma_f32_16x16x32_bf16 v[84:87], a[116:119], v[216:219], v[84:87]
s_waitcnt lgkmcnt(1)
v_mfma_f32_16x16x32_bf16 v[64:67], a[24:27], v[172:175], v[64:67]
ds_read_b128 v[196:199], v252 offset:18432
v_accvgpr_mov_b32 a0, a144
v_accvgpr_mov_b32 a1, a145
v_mfma_f32_16x16x32_bf16 v[64:67], a[28:31], v[176:179], v[64:67]
v_accvgpr_mov_b32 a2, a146
v_accvgpr_mov_b32 a3, a147
v_accvgpr_mov_b32 a48, a176
v_mfma_f32_16x16x32_bf16 v[64:67], a[32:35], v[180:183], v[64:67]
ds_read_b128 v[200:203], v252 offset:19456
v_accvgpr_mov_b32 a49, a177
v_accvgpr_mov_b32 a50, a178
v_mfma_f32_16x16x32_bf16 v[64:67], a[36:39], v[184:187], v[64:67]
v_accvgpr_mov_b32 a51, a179
v_accvgpr_mov_b32 a96, a208
v_accvgpr_mov_b32 a97, a209
v_mfma_f32_16x16x32_bf16 v[64:67], a[40:43], v[188:191], v[64:67]
ds_read_b128 v[204:207], v252 offset:20480
v_accvgpr_mov_b32 a98, a210
v_mfma_f32_16x16x32_bf16 v[64:67], a[44:47], v[192:195], v[64:67]
v_accvgpr_mov_b32 a99, a211
v_accvgpr_mov_b32 a4, a148
v_accvgpr_mov_b32 a5, a149
buffer_store_dwordx2 v[140:141], v249, s[8:11], s21 offen offset:512 sc1
v_mfma_f32_16x16x32_bf16 v[68:71], a[72:75], v[172:175], v[68:71]
ds_read_b128 v[208:211], v252 offset:21504
v_accvgpr_mov_b32 a6, a150
v_accvgpr_mov_b32 a7, a151
v_mfma_f32_16x16x32_bf16 v[68:71], a[76:79], v[176:179], v[68:71]
v_accvgpr_mov_b32 a52, a180
v_accvgpr_mov_b32 a53, a181
v_accvgpr_mov_b32 a54, a182
v_mfma_f32_16x16x32_bf16 v[68:71], a[80:83], v[180:183], v[68:71]
ds_read_b128 v[212:215], v252 offset:22528
v_accvgpr_mov_b32 a55, a183
v_accvgpr_mov_b32 a100, a212
v_mfma_f32_16x16x32_bf16 v[68:71], a[84:87], v[184:187], v[68:71]
v_accvgpr_mov_b32 a101, a213
v_accvgpr_mov_b32 a102, a214
v_accvgpr_mov_b32 a103, a215
v_mfma_f32_16x16x32_bf16 v[68:71], a[88:91], v[188:191], v[68:71]
ds_read_b128 v[216:219], v252 offset:23552
v_accvgpr_mov_b32 a8, a152
v_accvgpr_mov_b32 a9, a153
v_mfma_f32_16x16x32_bf16 v[68:71], a[92:95], v[192:195], v[68:71]
v_accvgpr_mov_b32 a10, a154
v_accvgpr_mov_b32 a11, a155
v_accvgpr_mov_b32 a56, a184
v_mfma_f32_16x16x32_bf16 v[72:75], a[120:123], v[172:175], v[72:75]
v_accvgpr_mov_b32 a57, a185
v_accvgpr_mov_b32 a58, a186
v_accvgpr_mov_b32 a59, a187
v_mfma_f32_16x16x32_bf16 v[72:75], a[124:127], v[176:179], v[72:75]
v_cvt_pk_bf16_f32 v88, v64, v65
v_cvt_pk_bf16_f32 v89, v66, v67
v_accvgpr_mov_b32 a104, a216
v_mfma_f32_16x16x32_bf16 v[72:75], a[128:131], v[180:183], v[72:75]
v_accvgpr_mov_b32 a105, a217
v_accvgpr_mov_b32 a106, a218
v_mfma_f32_16x16x32_bf16 v[72:75], a[132:135], v[184:187], v[72:75]
v_accvgpr_mov_b32 a107, a219
v_accvgpr_mov_b32 a12, a156
v_accvgpr_mov_b32 a13, a157
v_mfma_f32_16x16x32_bf16 v[72:75], a[136:139], v[188:191], v[72:75]
v_accvgpr_mov_b32 a14, a158
v_accvgpr_mov_b32 a15, a159
v_accvgpr_mov_b32 a60, a188
v_mfma_f32_16x16x32_bf16 v[72:75], a[140:143], v[192:195], v[72:75]
s_waitcnt vmcnt(32) lgkmcnt(0)
s_barrier
v_add_u32 v252, 4294893568, v252
buffer_store_dwordx2 v[142:143], v250, s[8:11], s21 offen offset:512 sc1
v_mfma_f32_16x16x32_bf16 v[76:79], a[24:27], v[196:199], v[76:79]
s_add_u32 m0, s17, 73728
s_mov_b32 s24, 73728
v_accvgpr_mov_b32 a61, a189
v_mfma_f32_16x16x32_bf16 v[76:79], a[28:31], v[200:203], v[76:79]
ds_read_b128 v[172:175], v252 offset:0
v_cvt_pk_bf16_f32 v90, v68, v69
v_cvt_pk_bf16_f32 v91, v70, v71
v_mfma_f32_16x16x32_bf16 v[76:79], a[32:35], v[204:207], v[76:79]
buffer_load_dwordx4 v251, s[12:15], s24 offen offset:0  lds
v_accvgpr_mov_b32 a62, a190
v_accvgpr_mov_b32 a63, a191
v_mfma_f32_16x16x32_bf16 v[76:79], a[36:39], v[208:211], v[76:79]
ds_read_b128 v[176:179], v252 offset:1024
v_accvgpr_mov_b32 a108, a220
v_accvgpr_mov_b32 a109, a221
v_mfma_f32_16x16x32_bf16 v[76:79], a[40:43], v[212:215], v[76:79]
v_accvgpr_mov_b32 a110, a222
v_accvgpr_mov_b32 a111, a223
v_accvgpr_mov_b32 a16, a160
v_mfma_f32_16x16x32_bf16 v[76:79], a[44:47], v[216:219], v[76:79]
ds_read_b128 v[180:183], v252 offset:2048
v_accvgpr_mov_b32 a17, a161
v_accvgpr_mov_b32 a18, a162
v_mfma_f32_16x16x32_bf16 v[80:83], a[72:75], v[196:199], v[80:83]
buffer_load_dwordx4 v251, s[12:15], s24 offen offset:1024  lds
v_accvgpr_mov_b32 a19, a163
v_accvgpr_mov_b32 a64, a192
v_mfma_f32_16x16x32_bf16 v[80:83], a[76:79], v[200:203], v[80:83]
ds_read_b128 v[184:187], v252 offset:3072
v_cvt_pk_bf16_f32 v92, v72, v73
v_cvt_pk_bf16_f32 v93, v74, v75
v_mfma_f32_16x16x32_bf16 v[80:83], a[80:83], v[204:207], v[80:83]
v_accvgpr_mov_b32 a65, a193
v_accvgpr_mov_b32 a66, a194
v_accvgpr_mov_b32 a67, a195
v_mfma_f32_16x16x32_bf16 v[80:83], a[84:87], v[208:211], v[80:83]
ds_read_b128 v[188:191], v252 offset:4096
v_accvgpr_mov_b32 a112, a224
v_mfma_f32_16x16x32_bf16 v[80:83], a[88:91], v[212:215], v[80:83]
buffer_load_dwordx4 v251, s[12:15], s24 offen offset:2048  lds
v_accvgpr_mov_b32 a113, a225
v_accvgpr_mov_b32 a114, a226
v_mfma_f32_16x16x32_bf16 v[80:83], a[92:95], v[216:219], v[80:83]
ds_read_b128 v[192:195], v252 offset:5120
v_accvgpr_mov_b32 a115, a227
v_accvgpr_mov_b32 a20, a164
s_add_u32 s25, s21, 1746432
s_mov_b64 exec, 0xffff
buffer_store_dwordx2 v[144:145], v239, s[8:11], s25 offen offset:512 sc1
s_mov_b64 exec, -1
v_mfma_f32_16x16x32_bf16 v[84:87], a[120:123], v[196:199], v[84:87]
v_accvgpr_mov_b32 a21, a165
v_accvgpr_mov_b32 a22, a166
v_accvgpr_mov_b32 a23, a167
v_mfma_f32_16x16x32_bf16 v[84:87], a[124:127], v[200:203], v[84:87]
v_cvt_pk_bf16_f32 v96, v76, v77
v_cvt_pk_bf16_f32 v97, v78, v79
v_accvgpr_mov_b32 a68, a196
v_mfma_f32_16x16x32_bf16 v[84:87], a[128:131], v[204:207], v[84:87]
buffer_load_dwordx4 v251, s[12:15], s24 offen offset:3072  lds
v_accvgpr_mov_b32 a69, a197
v_accvgpr_mov_b32 a70, a198
v_mfma_f32_16x16x32_bf16 v[84:87], a[132:135], v[208:211], v[84:87]
v_accvgpr_mov_b32 a71, a199
v_accvgpr_mov_b32 a116, a228
v_accvgpr_mov_b32 a117, a229
v_mfma_f32_16x16x32_bf16 v[84:87], a[136:139], v[212:215], v[84:87]
s_add_u32 m0, s17, 77824
s_mov_b32 s24, 77824
v_accvgpr_mov_b32 a118, a230
v_mfma_f32_16x16x32_bf16 v[84:87], a[140:143], v[216:219], v[84:87]
v_accvgpr_mov_b32 a119, a231
v_mfma_f32_16x16x32_bf16 v[8:11], v[0:3], v[88:91], 0
buffer_load_dwordx4 v251, s[12:15], s24 offen offset:0  lds
v_accvgpr_mov_b32 a24, a168
v_mfma_f32_16x16x32_bf16 v[8:11], v[4:7], v[92:95], v[8:11]
v_cvt_pk_bf16_f32 v98, v80, v81
v_cvt_pk_bf16_f32 v99, v82, v83
v_mfma_f32_16x16x32_bf16 v[24:27], v[16:19], v[88:91], 0
v_accvgpr_mov_b32 a25, a169
v_accvgpr_mov_b32 a26, a170
v_mfma_f32_16x16x32_bf16 v[24:27], v[20:23], v[92:95], v[24:27]
v_accvgpr_mov_b32 a27, a171
v_accvgpr_mov_b32 a72, a200
v_mfma_f32_16x16x32_bf16 v[40:43], v[32:35], v[88:91], 0
buffer_load_dwordx4 v251, s[12:15], s24 offen offset:1024  lds
v_accvgpr_mov_b32 a73, a201
v_mfma_f32_16x16x32_bf16 v[40:43], v[36:39], v[92:95], v[40:43]
v_accvgpr_mov_b32 a74, a202
v_accvgpr_mov_b32 a75, a203
v_mfma_f32_16x16x32_bf16 v[56:59], v[48:51], v[88:91], 0
v_accvgpr_mov_b32 a120, a232
v_accvgpr_mov_b32 a121, a233
v_mfma_f32_16x16x32_bf16 v[56:59], v[52:55], v[92:95], v[56:59]
v_cvt_pk_bf16_f32 v100, v84, v85
v_cvt_pk_bf16_f32 v101, v86, v87
v_mfma_f32_16x16x32_bf16 v[12:15], v[0:3], v[96:99], 0
v_accvgpr_mov_b32 a122, a234
v_accvgpr_mov_b32 a123, a235
v_mfma_f32_16x16x32_bf16 v[12:15], v[4:7], v[100:103], v[12:15]
v_accvgpr_mov_b32 a28, a172
v_accvgpr_mov_b32 a29, a173
v_mfma_f32_16x16x32_bf16 v[28:31], v[16:19], v[96:99], 0
v_accvgpr_mov_b32 a30, a174
v_accvgpr_mov_b32 a31, a175
v_mfma_f32_16x16x32_bf16 v[28:31], v[20:23], v[100:103], v[28:31]
v_accvgpr_mov_b32 a76, a204
v_accvgpr_mov_b32 a77, a205
v_mfma_f32_16x16x32_bf16 v[44:47], v[32:35], v[96:99], 0
v_accvgpr_mov_b32 a78, a206
v_accvgpr_mov_b32 a79, a207
v_mfma_f32_16x16x32_bf16 v[44:47], v[36:39], v[100:103], v[44:47]
v_accvgpr_mov_b32 a124, a236
v_accvgpr_mov_b32 a125, a237
v_mfma_f32_16x16x32_bf16 v[60:63], v[48:51], v[96:99], 0
v_accvgpr_mov_b32 a126, a238
v_accvgpr_mov_b32 a127, a239
v_mfma_f32_16x16x32_bf16 v[60:63], v[52:55], v[100:103], v[60:63]
s_waitcnt lgkmcnt(0)
s_mov_b32 s20, s21
s_mov_b32 s21, s22
s_add_u32 s23, s23, 4
s_mul_hi_u32 s31, s23, 79536432
s_mul_i32 s32, s31, 54
s_sub_u32 s32, s23, s32
s_mul_i32 s31, s31, 2032128
s_mul_i32 s32, s32, 5376
s_add_u32 s22, s31, s32
s_add_u32 s29, s29, 884736
s_add_u32 s38, s38, 4608
s_add_u32 s39, s39, 8
s_add_u32 s36, s36, 1
s_cmp_lt_u32 s36, 3
s_cbranch_scc1 L_round
v_cvt_pk_bf16_f32 v147, v8, v12
v_cvt_pk_bf16_f32 v149, v9, v13
v_cvt_pk_bf16_f32 v151, v10, v14
v_cvt_pk_bf16_f32 v153, v11, v15
v_cvt_pk_bf16_f32 v155, v24, v28
v_cvt_pk_bf16_f32 v157, v25, v29
v_cvt_pk_bf16_f32 v159, v26, v30
v_cvt_pk_bf16_f32 v161, v27, v31
v_cvt_pk_bf16_f32 v163, v40, v44
v_cvt_pk_bf16_f32 v165, v41, v45
v_cvt_pk_bf16_f32 v167, v42, v46
v_cvt_pk_bf16_f32 v169, v43, v47
v_cvt_pk_bf16_f32 v171, v56, v60
buffer_store_dwordx2 v[146:147], v239, s[8:11], s20 offen offset:640 sc1
buffer_store_dwordx2 v[148:149], v240, s[8:11], s20 offen offset:640 sc1
buffer_store_dwordx2 v[150:151], v241, s[8:11], s20 offen offset:640 sc1
buffer_store_dwordx2 v[152:153], v242, s[8:11], s20 offen offset:640 sc1
buffer_store_dwordx2 v[154:155], v243, s[8:11], s20 offen offset:640 sc1
buffer_store_dwordx2 v[156:157], v244, s[8:11], s20 offen offset:640 sc1
buffer_store_dwordx2 v[158:159], v245, s[8:11], s20 offen offset:640 sc1
buffer_store_dwordx2 v[160:161], v246, s[8:11], s20 offen offset:640 sc1
buffer_store_dwordx2 v[162:163], v247, s[8:11], s20 offen offset:640 sc1
buffer_store_dwordx2 v[164:165], v248, s[8:11], s20 offen offset:640 sc1
buffer_store_dwordx2 v[166:167], v249, s[8:11], s20 offen offset:640 sc1
buffer_store_dwordx2 v[168:169], v250, s[8:11], s20 offen offset:640 sc1
s_add_u32 s25, s20, 1746432
s_mov_b64 exec, 0xffff
buffer_store_dwordx2 v[170:171], v239, s[8:11], s25 offen offset:640 sc1
s_mov_b64 exec, -1
s_endpgm
L_slow:
s_mov_b32 s32, 0
L_spin:
buffer_load_dwordx2 v[104:105], off, s[44:47], s39 sc1
s_waitcnt vmcnt(0)
v_readfirstlane_b32 s34, v104
v_readfirstlane_b32 s35, v105
s_nop 3
s_min_u32 s34, s34, s35
s_cmp_ge_u32 s34, 6
s_cbranch_scc1 L_back
s_sleep 4
s_add_u32 s32, s32, 1
s_cmp_lt_u32 s32, 20000
s_cbranch_scc1 L_spin
s_branch L_back
L_prod:
s_and_b32 s20, s2, 1
s_lshr_b32 s31, s2, 1
s_lshl_b32 s31, s31, 2
s_add_u32 s21, s31, s16
s_mul_i32 s25, s20, 294912
s_mul_i32 s31, s21, 36864
s_mov_b32 s27, 0
s_mul_i32 s32, s20, 2654208
s_add_u32 s32, s32, s31
s_add_u32 s28, s32, 1048576
s_add_u32 s29, s28, 12288
s_add_u32 s30, s29, 12288
s_mov_b32 s23, 6356992
s_lshl_b32 s26, s20, 2
s_mov_b32 s36, 0
v_lshrrev_b32 v115, 2, v113
v_lshlrev_b32 v115, 8, v115
v_lshl_add_u32 v115, v114, 6, v115
v_and_b32 v116, 3, v113
v_lshl_add_u32 v237, v116, 4, v115
s_mul_i32 s31, s21, 48
v_add_u32 v245, s31, v113
v_add_u32 v246, s31, v113
v_add_u32 v246, 16, v246
v_add_u32 v247, s31, v113
v_add_u32 v247, 32, v247
s_lshl_b32 s31, s27, 2
v_lshrrev_b32 v115, 2, v245
v_mul_u32_u24 v115, 12, v115
v_and_b32 v116, 3, v245
v_add_u32 v115, v115, v116
v_add_u32 v115, s31, v115
v_mul_u32_u24 v116, 19419, v115
v_lshrrev_b32 v116, 20, v116
v_mul_u32_u24 v117, 54, v116
v_sub_u32 v117, v115, v117
v_mul_u32_u24 v116, 2032128, v116
v_mul_u32_u24 v117, 5376, v117
v_add_u32 v118, v116, v117
v_lshl_add_u32 v118, v114, 4, v118
v_add_u32 v118, 1746432, v118
v_mov_b32 v116, 972
v_cmp_gt_u32 s[34:35], v116, v245
v_mov_b32 v116, 0x7fff0000
s_nop 0
v_cndmask_b32 v238, v116, v118, s[34:35]
buffer_load_dwordx4 a[0:3], v238, s[4:7], 0 offen offset:0
buffer_load_dwordx4 a[4:7], v238, s[4:7], 0 offen offset:64
buffer_load_dwordx4 a[8:11], v238, s[4:7], 0 offen offset:128
buffer_load_dwordx4 a[12:15], v238, s[4:7], 0 offen offset:192
buffer_load_dwordx4 a[16:19], v238, s[4:7], 0 offen offset:256
buffer_load_dwordx4 a[20:23], v238, s[4:7], 0 offen offset:320
buffer_load_dwordx4 a[24:27], v238, s[4:7], 0 offen offset:384
buffer_load_dwordx4 a[28:31], v238, s[4:7], 0 offen offset:448
buffer_load_dwordx4 a[32:35], v238, s[4:7], 0 offen offset:512
buffer_load_dwordx4 a[36:39], v238, s[4:7], 0 offen offset:576
buffer_load_dwordx4 a[40:43], v238, s[4:7], 0 offen offset:640
buffer_load_dwordx4 a[44:47], v238, s[4:7], 0 offen offset:704
v_lshrrev_b32 v115, 2, v246
v_mul_u32_u24 v115, 12, v115
v_and_b32 v116, 3, v246
v_add_u32 v115, v115, v116
v_add_u32 v115, s31, v115
v_mul_u32_u24 v116, 19419, v115
v_lshrrev_b32 v116, 20, v116
v_mul_u32_u24 v117, 54, v116
v_sub_u32 v117, v115, v117
v_mul_u32_u24 v116, 2032128, v116
v_mul_u32_u24 v117, 5376, v117
v_add_u32 v118, v116, v117
v_lshl_add_u32 v118, v114, 4, v118
v_add_u32 v118, 1746432, v118
v_mov_b32 v116, 972
v_cmp_gt_u32 s[34:35], v116, v246
v_mov_b32 v116, 0x7fff0000
s_nop 0
v_cndmask_b32 v238, v116, v118, s[34:35]
buffer_load_dwordx4 a[48:51], v238, s[4:7], 0 offen offset:0
buffer_load_dwordx4 a[52:55], v238, s[4:7], 0 offen offset:64
buffer_load_dwordx4 a[56:59], v238, s[4:7], 0 offen offset:128
buffer_load_dwordx4 a[60:63], v238, s[4:7], 0 offen offset:192
buffer_load_dwordx4 a[64:67], v238, s[4:7], 0 offen offset:256
buffer_load_dwordx4 a[68:71], v238, s[4:7], 0 offen offset:320
buffer_load_dwordx4 a[72:75], v238, s[4:7], 0 offen offset:384
buffer_load_dwordx4 a[76:79], v238, s[4:7], 0 offen offset:448
buffer_load_dwordx4 a[80:83], v238, s[4:7], 0 offen offset:512
buffer_load_dwordx4 a[84:87], v238, s[4:7], 0 offen offset:576
buffer_load_dwordx4 a[88:91], v238, s[4:7], 0 offen offset:640
buffer_load_dwordx4 a[92:95], v238, s[4:7], 0 offen offset:704
v_lshrrev_b32 v115, 2, v247
v_mul_u32_u24 v115, 12, v115
v_and_b32 v116, 3, v247
v_add_u32 v115, v115, v116
v_add_u32 v115, s31, v115
v_mul_u32_u24 v116, 19419, v115
v_lshrrev_b32 v116, 20, v116
v_mul_u32_u24 v117, 54, v116
v_sub_u32 v117, v115, v117
v_mul_u32_u24 v116, 2032128, v116
v_mul_u32_u24 v117, 5376, v117
v_add_u32 v118, v116, v117
v_lshl_add_u32 v118, v114, 4, v118
v_add_u32 v118, 1746432, v118
v_mov_b32 v116, 972
v_cmp_gt_u32 s[34:35], v116, v247
v_mov_b32 v116, 0x7fff0000
s_nop 0
v_cndmask_b32 v238, v116, v118, s[34:35]
buffer_load_dwordx4 a[96:99], v238, s[4:7], 0 offen offset:0
buffer_load_dwordx4 a[100:103], v238, s[4:7], 0 offen offset:64
buffer_load_dwordx4 a[104:107], v238, s[4:7], 0 offen offset:128
buffer_load_dwordx4 a[108:111], v238, s[4:7], 0 offen offset:192
buffer_load_dwordx4 a[112:115], v238, s[4:7], 0 offen offset:256
buffer_load_dwordx4 a[116:119], v238, s[4:7], 0 offen offset:320
buffer_load_dwordx4 a[120:123], v238, s[4:7], 0 offen offset:384
buffer_load_dwordx4 a[124:127], v238, s[4:7], 0 offen offset:448
buffer_load_dwordx4 a[128:131], v238, s[4:7], 0 offen offset:512
buffer_load_dwordx4 a[132:135], v238, s[4:7], 0 offen offset:576
buffer_load_dwordx4 a[136:139], v238, s[4:7], 0 offen offset:640
buffer_load_dwordx4 a[140:143], v238, s[4:7], 0 offen offset:704
v_lshrrev_b32 v115, 2, v113
v_cmp_eq_u32 s[34:35], v115, v114
v_mov_b32 v116, 0x7fff0000
v_lshlrev_b32 v117, 2, v245
v_cndmask_b32 v242, v116, v117, s[34:35]
v_lshrrev_b32 v115, 2, v113
v_cmp_eq_u32 s[34:35], v115, v114
v_mov_b32 v116, 0x7fff0000
v_lshlrev_b32 v117, 2, v246
v_cndmask_b32 v243, v116, v117, s[34:35]
v_lshrrev_b32 v115, 2, v113
v_cmp_eq_u32 s[34:35], v115, v114
v_mov_b32 v116, 0x7fff0000
v_lshlrev_b32 v117, 2, v247
v_cndmask_b32 v244, v116, v117, s[34:35]
s_cmp_lg_u32 s16, 0
s_cbranch_scc1 L_pw_ok
s_cmp_lg_u32 s2, 0
s_cbranch_scc1 L_pw_poll
s_mov_b32 s32, 0
L_pw_w:
buffer_load_dword v115, off, s[44:47], 0 offset:24 sc1
s_waitcnt vmcnt(0)
v_readfirstlane_b32 s31, v115
s_nop 3
s_cmp_ge_u32 s31, 144
s_cbranch_scc1 L_pw_w_ok
s_sleep 4
s_add_u32 s32, s32, 1
s_cmp_lt_u32 s32, 10000
s_cbranch_scc1 L_pw_w
L_pw_w_ok:
v_mov_b32 v115, 1
s_mov_b64 exec, 1
buffer_store_dword v115, off, s[44:47], 0 offset:128 sc1
s_mov_b64 exec, -1
s_branch L_pw_ok
L_pw_poll:
s_mov_b32 s32, 0
L_pw:
buffer_load_dword v115, off, s[44:47], 0 offset:128 sc1
s_waitcnt vmcnt(0)
v_readfirstlane_b32 s31, v115
s_nop 3
s_cmp_ge_u32 s31, 1
s_cbranch_scc1 L_pw_ok
s_sleep 8
s_add_u32 s32, s32, 1
s_cmp_lt_u32 s32, 10000
s_cbranch_scc1 L_pw
L_pw_ok:
s_barrier
s_add_u32 m0, s17, 0
s_add_u32 s24, s25, 0
buffer_load_dwordx4 v251, s[12:15], s24 offen offset:0  lds
buffer_load_dwordx4 v251, s[12:15], s24 offen offset:1024  lds
buffer_load_dwordx4 v251, s[12:15], s24 offen offset:2048  lds
buffer_load_dwordx4 v251, s[12:15], s24 offen offset:3072  lds
s_add_u32 m0, s17, 4096
s_add_u32 s24, s25, 4096
buffer_load_dwordx4 v251, s[12:15], s24 offen offset:0  lds
buffer_load_dwordx4 v251, s[12:15], s24 offen offset:1024  lds
s_add_u32 m0, s17, 24576
s_add_u32 s24, s25, 24576
buffer_load_dwordx4 v251, s[12:15], s24 offen offset:0  lds
buffer_load_dwordx4 v251, s[12:15], s24 offen offset:1024  lds
buffer_load_dwordx4 v251, s[12:15], s24 offen offset:2048  lds
buffer_load_dwordx4 v251, s[12:15], s24 offen offset:3072  lds
s_add_u32 m0, s17, 28672
s_add_u32 s24, s25, 28672
buffer_load_dwordx4 v251, s[12:15], s24 offen offset:0  lds
buffer_load_dwordx4 v251, s[12:15], s24 offen offset:1024  lds
s_waitcnt vmcnt(6)
s_barrier
ds_read_b128 v[172:175], v252 offset:0
ds_read_b128 v[176:179], v252 offset:1024
ds_read_b128 v[180:183], v252 offset:2048
ds_read_b128 v[184:187], v252 offset:3072
s_add_u32 m0, s17, 49152
s_add_u32 s24, s25, 49152
buffer_load_dwordx4 v251, s[12:15], s24 offen offset:0  lds
buffer_load_dwordx4 v251, s[12:15], s24 offen offset:1024  lds
buffer_load_dwordx4 v251, s[12:15], s24 offen offset:2048  lds
buffer_load_dwordx4 v251, s[12:15], s24 offen offset:3072  lds
s_add_u32 m0, s17, 53248
s_add_u32 s24, s25, 53248
buffer_load_dwordx4 v251, s[12:15], s24 offen offset:0  lds
buffer_load_dwordx4 v251, s[12:15], s24 offen offset:1024  lds
s_add_u32 m0, s17, 73728
s_add_u32 s24, s25, 73728
buffer_load_dwordx4 v251, s[12:15], s24 offen offset:0  lds
buffer_load_dwordx4 v251, s[12:15], s24 offen offset:1024  lds
buffer_load_dwordx4 v251, s[12:15], s24 offen offset:2048  lds
buffer_load_dwordx4 v251, s[12:15], s24 offen offset:3072  lds
s_add_u32 m0, s17, 77824
s_add_u32 s24, s25, 77824
buffer_load_dwordx4 v251, s[12:15], s24 offen offset:0  lds
buffer_load_dwordx4 v251, s[12:15], s24 offen offset:1024  lds
L_ppass:
s_waitcnt vmcnt(35) lgkmcnt(3)
v_mfma_f32_16x16x32_bf16 v[64:67], v[172:175], a[0:3], 0
ds_read_b128 v[188:191], v252 offset:4096
s_waitcnt vmcnt(34) lgkmcnt(3)
v_mfma_f32_16x16x32_bf16 v[64:67], v[176:179], a[4:7], v[64:67]
s_waitcnt vmcnt(33) lgkmcnt(2)
v_mfma_f32_16x16x32_bf16 v[64:67], v[180:183], a[8:11], v[64:67]
ds_read_b128 v[192:195], v252 offset:5120
s_waitcnt vmcnt(32) lgkmcnt(2)
v_mfma_f32_16x16x32_bf16 v[64:67], v[184:187], a[12:15], v[64:67]
s_waitcnt vmcnt(23)
v_mfma_f32_16x16x32_bf16 v[68:71], v[172:175], a[48:51], 0
ds_read_b128 v[196:199], v252 offset:6144
s_waitcnt vmcnt(22)
v_mfma_f32_16x16x32_bf16 v[68:71], v[176:179], a[52:55], v[68:71]
s_waitcnt vmcnt(21)
v_mfma_f32_16x16x32_bf16 v[68:71], v[180:183], a[56:59], v[68:71]
ds_read_b128 v[200:203], v252 offset:7168
s_waitcnt vmcnt(20)
v_mfma_f32_16x16x32_bf16 v[68:71], v[184:187], a[60:63], v[68:71]
s_waitcnt vmcnt(11)
v_mfma_f32_16x16x32_bf16 v[72:75], v[172:175], a[96:99], 0
s_waitcnt vmcnt(10)
v_mfma_f32_16x16x32_bf16 v[72:75], v[176:179], a[100:103], v[72:75]
s_waitcnt vmcnt(9)
v_mfma_f32_16x16x32_bf16 v[72:75], v[180:183], a[104:107], v[72:75]
s_waitcnt vmcnt(8)
v_mfma_f32_16x16x32_bf16 v[72:75], v[184:187], a[108:111], v[72:75]
s_waitcnt lgkmcnt(3)
v_mfma_f32_16x16x32_bf16 v[64:67], v[188:191], a[16:19], v[64:67]
ds_read_b128 v[172:175], v252 offset:8192
s_waitcnt lgkmcnt(3)
v_mfma_f32_16x16x32_bf16 v[64:67], v[192:195], a[20:23], v[64:67]
s_waitcnt lgkmcnt(2)
v_mfma_f32_16x16x32_bf16 v[64:67], v[196:199], a[24:27], v[64:67]
ds_read_b128 v[176:179], v252 offset:9216
s_waitcnt lgkmcnt(2)
v_mfma_f32_16x16x32_bf16 v[64:67], v[200:203], a[28:31], v[64:67]
v_mfma_f32_16x16x32_bf16 v[68:71], v[188:191], a[64:67], v[68:71]
ds_read_b128 v[180:183], v252 offset:10240
v_mfma_f32_16x16x32_bf16 v[68:71], v[192:195], a[68:71], v[68:71]
v_mfma_f32_16x16x32_bf16 v[68:71], v[196:199], a[72:75], v[68:71]
ds_read_b128 v[184:187], v252 offset:11264
v_mfma_f32_16x16x32_bf16 v[68:71], v[200:203], a[76:79], v[68:71]
s_waitcnt vmcnt(7)
v_mfma_f32_16x16x32_bf16 v[72:75], v[188:191], a[112:115], v[72:75]
s_waitcnt vmcnt(6)
v_mfma_f32_16x16x32_bf16 v[72:75], v[192:195], a[116:119], v[72:75]
s_waitcnt vmcnt(5)
v_mfma_f32_16x16x32_bf16 v[72:75], v[196:199], a[120:123], v[72:75]
s_waitcnt vmcnt(4)
v_mfma_f32_16x16x32_bf16 v[72:75], v[200:203], a[124:127], v[72:75]
s_waitcnt lgkmcnt(3)
v_mfma_f32_16x16x32_bf16 v[64:67], v[172:175], a[32:35], v[64:67]
ds_read_b128 v[188:191], v252 offset:12288
s_waitcnt lgkmcnt(3)
v_mfma_f32_16x16x32_bf16 v[64:67], v[176:179], a[36:39], v[64:67]
s_waitcnt lgkmcnt(2)
v_mfma_f32_16x16x32_bf16 v[64:67], v[180:183], a[40:43], v[64:67]
ds_read_b128 v[192:195], v252 offset:13312
s_waitcnt lgkmcnt(2)
v_mfma_f32_16x16x32_bf16 v[64:67], v[184:187], a[44:47], v[64:67]
v_mfma_f32_16x16x32_bf16 v[68:71], v[172:175], a[80:83], v[68:71]
ds_read_b128 v[196:199], v252 offset:14336
v_mfma_f32_16x16x32_bf16 v[68:71], v[176:179], a[84:87], v[68:71]
v_mfma_f32_16x16x32_bf16 v[68:71], v[180:183], a[88:91], v[68:71]
ds_read_b128 v[200:203], v252 offset:15360
v_mfma_f32_16x16x32_bf16 v[68:71], v[184:187], a[92:95], v[68:71]
s_waitcnt vmcnt(3)
v_mfma_f32_16x16x32_bf16 v[72:75], v[172:175], a[128:131], v[72:75]
s_waitcnt vmcnt(2)
v_mfma_f32_16x16x32_bf16 v[72:75], v[176:179], a[132:135], v[72:75]
s_waitcnt vmcnt(1)
v_mfma_f32_16x16x32_bf16 v[72:75], v[180:183], a[136:139], v[72:75]
s_waitcnt vmcnt(0)
v_mfma_f32_16x16x32_bf16 v[72:75], v[184:187], a[140:143], v[72:75]
v_cvt_pk_bf16_f32 v88, v64, v65
v_cvt_pk_bf16_f32 v89, v66, v67
s_waitcnt lgkmcnt(3)
v_mfma_f32_16x16x32_bf16 v[76:79], v[188:191], a[0:3], 0
ds_read_b128 v[172:175], v252 offset:16384
s_waitcnt lgkmcnt(3)
v_mfma_f32_16x16x32_bf16 v[76:79], v[192:195], a[4:7], v[76:79]
s_waitcnt lgkmcnt(2)
v_mfma_f32_16x16x32_bf16 v[76:79], v[196:199], a[8:11], v[76:79]
ds_read_b128 v[176:179], v252 offset:17408
s_waitcnt lgkmcnt(2)
v_mfma_f32_16x16x32_bf16 v[76:79], v[200:203], a[12:15], v[76:79]
v_cvt_pk_bf16_f32 v92, v68, v69
v_cvt_pk_bf16_f32 v93, v70, v71
v_mfma_f32_16x16x32_bf16 v[80:83], v[188:191], a[48:51], 0
ds_read_b128 v[180:183], v252 offset:18432
v_mfma_f32_16x16x32_bf16 v[80:83], v[192:195], a[52:55], v[80:83]
v_mfma_f32_16x16x32_bf16 v[80:83], v[196:199], a[56:59], v[80:83]
ds_read_b128 v[184:187], v252 offset:19456
v_mfma_f32_16x16x32_bf16 v[80:83], v[200:203], a[60:63], v[80:83]
v_cvt_pk_bf16_f32 v96, v72, v73
v_cvt_pk_bf16_f32 v97, v74, v75
v_mfma_f32_16x16x32_bf16 v[84:87], v[188:191], a[96:99], 0
v_mfma_f32_16x16x32_bf16 v[84:87], v[192:195], a[100:103], v[84:87]
v_mfma_f32_16x16x32_bf16 v[84:87], v[196:199], a[104:107], v[84:87]
v_mfma_f32_16x16x32_bf16 v[84:87], v[200:203], a[108:111], v[84:87]
s_waitcnt lgkmcnt(3)
v_mfma_f32_16x16x32_bf16 v[76:79], v[172:175], a[16:19], v[76:79]
ds_read_b128 v[188:191], v252 offset:20480
s_waitcnt lgkmcnt(3)
v_mfma_f32_16x16x32_bf16 v[76:79], v[176:179], a[20:23], v[76:79]
s_waitcnt lgkmcnt(2)
v_mfma_f32_16x16x32_bf16 v[76:79], v[180:183], a[24:27], v[76:79]
ds_read_b128 v[192:195], v252 offset:21504
s_waitcnt lgkmcnt(2)
v_mfma_f32_16x16x32_bf16 v[76:79], v[184:187], a[28:31], v[76:79]
v_mfma_f32_16x16x32_bf16 v[80:83], v[172:175], a[64:67], v[80:83]
ds_read_b128 v[196:199], v252 offset:22528
v_mfma_f32_16x16x32_bf16 v[80:83], v[176:179], a[68:71], v[80:83]
v_mfma_f32_16x16x32_bf16 v[80:83], v[180:183], a[72:75], v[80:83]
ds_read_b128 v[200:203], v252 offset:23552
v_mfma_f32_16x16x32_bf16 v[80:83], v[184:187], a[76:79], v[80:83]
v_mfma_f32_16x16x32_bf16 v[84:87], v[172:175], a[112:115], v[84:87]
v_mfma_f32_16x16x32_bf16 v[84:87], v[176:179], a[116:119], v[84:87]
v_mfma_f32_16x16x32_bf16 v[84:87], v[180:183], a[120:123], v[84:87]
v_mfma_f32_16x16x32_bf16 v[84:87], v[184:187], a[124:127], v[84:87]
s_waitcnt vmcnt(12) lgkmcnt(0)
s_barrier
v_add_u32 v252, 24576, v252
v_mfma_f32_16x16x32_bf16 v[76:79], v[188:191], a[32:35], v[76:79]
s_add_u32 m0, s17, 0
s_add_u32 s24, s25, 98304
v_mfma_f32_16x16x32_bf16 v[76:79], v[192:195], a[36:39], v[76:79]
ds_read_b128 v[172:175], v252 offset:0
v_mfma_f32_16x16x32_bf16 v[76:79], v[196:199], a[40:43], v[76:79]
buffer_load_dwordx4 v251, s[12:15], s24 offen offset:0  lds
v_mfma_f32_16x16x32_bf16 v[76:79], v[200:203], a[44:47], v[76:79]
ds_read_b128 v[176:179], v252 offset:1024
v_mfma_f32_16x16x32_bf16 v[80:83], v[188:191], a[80:83], v[80:83]
v_mfma_f32_16x16x32_bf16 v[80:83], v[192:195], a[84:87], v[80:83]
ds_read_b128 v[180:183], v252 offset:2048
v_mfma_f32_16x16x32_bf16 v[80:83], v[196:199], a[88:91], v[80:83]
buffer_load_dwordx4 v251, s[12:15], s24 offen offset:1024  lds
v_mfma_f32_16x16x32_bf16 v[80:83], v[200:203], a[92:95], v[80:83]
ds_read_b128 v[184:187], v252 offset:3072
v_mfma_f32_16x16x32_bf16 v[84:87], v[188:191], a[128:131], v[84:87]
v_mfma_f32_16x16x32_bf16 v[84:87], v[192:195], a[132:135], v[84:87]
v_mfma_f32_16x16x32_bf16 v[84:87], v[196:199], a[136:139], v[84:87]
buffer_load_dwordx4 v251, s[12:15], s24 offen offset:2048  lds
v_mfma_f32_16x16x32_bf16 v[84:87], v[200:203], a[140:143], v[84:87]
v_cvt_pk_bf16_f32 v90, v76, v77
v_cvt_pk_bf16_f32 v91, v78, v79
s_waitcnt lgkmcnt(3)
v_mfma_f32_16x16x32_bf16 v[64:67], v[172:175], a[0:3], 0
ds_read_b128 v[188:191], v252 offset:4096
s_waitcnt lgkmcnt(3)
v_mfma_f32_16x16x32_bf16 v[64:67], v[176:179], a[4:7], v[64:67]
s_waitcnt lgkmcnt(2)
v_mfma_f32_16x16x32_bf16 v[64:67], v[180:183], a[8:11], v[64:67]
buffer_load_dwordx4 v251, s[12:15], s24 offen offset:3072  lds
ds_read_b128 v[192:195], v252 offset:5120
s_waitcnt lgkmcnt(2)
v_mfma_f32_16x16x32_bf16 v[64:67], v[184:187], a[12:15], v[64:67]
v_cvt_pk_bf16_f32 v94, v80, v81
v_cvt_pk_bf16_f32 v95, v82, v83
v_mfma_f32_16x16x32_bf16 v[68:71], v[172:175], a[48:51], 0
s_add_u32 m0, s17, 4096
s_add_u32 s24, s25, 102400
ds_read_b128 v[196:199], v252 offset:6144
v_mfma_f32_16x16x32_bf16 v[68:71], v[176:179], a[52:55], v[68:71]
v_mfma_f32_16x16x32_bf16 v[68:71], v[180:183], a[56:59], v[68:71]
buffer_load_dwordx4 v251, s[12:15], s24 offen offset:0  lds
ds_read_b128 v[200:203], v252 offset:7168
v_mfma_f32_16x16x32_bf16 v[68:71], v[184:187], a[60:63], v[68:71]
v_cvt_pk_bf16_f32 v98, v84, v85
v_cvt_pk_bf16_f32 v99, v86, v87
v_mfma_f32_16x16x32_bf16 v[72:75], v[172:175], a[96:99], 0
v_mfma_f32_16x16x32_bf16 v[72:75], v[176:179], a[100:103], v[72:75]
v_mfma_f32_16x16x32_bf16 v[72:75], v[180:183], a[104:107], v[72:75]
buffer_load_dwordx4 v251, s[12:15], s24 offen offset:1024  lds
v_mfma_f32_16x16x32_bf16 v[72:75], v[184:187], a[108:111], v[72:75]
v_mfma_f32_16x16x32_bf16 v[0:3], a[0:3], v[88:91], 0
buffer_store_dwordx4 v[88:91], v237, s[40:43], s28 offen sc1
s_add_u32 s28, s28, 1024
v_mfma_f32_16x16x32_bf16 v[4:7], a[48:51], v[92:95], 0
buffer_store_dwordx4 v[92:95], v237, s[40:43], s29 offen sc1
s_add_u32 s29, s29, 1024
v_mfma_f32_16x16x32_bf16 v[8:11], a[96:99], v[96:99], 0
buffer_store_dwordx4 v[96:99], v237, s[40:43], s30 offen sc1
s_add_u32 s30, s30, 1024
s_waitcnt lgkmcnt(3)
v_mfma_f32_16x16x32_bf16 v[64:67], v[188:191], a[16:19], v[64:67]
ds_read_b128 v[172:175], v252 offset:8192
s_waitcnt lgkmcnt(3)
v_mfma_f32_16x16x32_bf16 v[64:67], v[192:195], a[20:23], v[64:67]
s_waitcnt lgkmcnt(2)
v_mfma_f32_16x16x32_bf16 v[64:67], v[196:199], a[24:27], v[64:67]
ds_read_b128 v[176:179], v252 offset:9216
s_waitcnt lgkmcnt(2)
v_mfma_f32_16x16x32_bf16 v[64:67], v[200:203], a[28:31], v[64:67]
v_mfma_f32_16x16x32_bf16 v[68:71], v[188:191], a[64:67], v[68:71]
ds_read_b128 v[180:183], v252 offset:10240
v_mfma_f32_16x16x32_bf16 v[68:71], v[192:195], a[68:71], v[68:71]
v_mfma_f32_16x16x32_bf16 v[68:71], v[196:199], a[72:75], v[68:71]
ds_read_b128 v[184:187], v252 offset:11264
v_mfma_f32_16x16x32_bf16 v[68:71], v[200:203], a[76:79], v[68:71]
v_mfma_f32_16x16x32_bf16 v[72:75], v[188:191], a[112:115], v[72:75]
v_mfma_f32_16x16x32_bf16 v[72:75], v[192:195], a[116:119], v[72:75]
v_mfma_f32_16x16x32_bf16 v[72:75], v[196:199], a[120:123], v[72:75]
v_mfma_f32_16x16x32_bf16 v[72:75], v[200:203], a[124:127], v[72:75]
s_waitcnt lgkmcnt(3)
v_mfma_f32_16x16x32_bf16 v[64:67], v[172:175], a[32:35], v[64:67]
ds_read_b128 v[188:191], v252 offset:12288
s_waitcnt lgkmcnt(3)
v_mfma_f32_16x16x32_bf16 v[64:67], v[176:179], a[36:39], v[64:67]
s_waitcnt lgkmcnt(2)
v_mfma_f32_16x16x32_bf16 v[64:67], v[180:183], a[40:43], v[64:67]
ds_read_b128 v[192:195], v252 offset:13312
s_waitcnt lgkmcnt(2)
v_mfma_f32_16x16x32_bf16 v[64:67], v[184:187], a[44:47], v[64:67]
v_mfma_f32_16x16x32_bf16 v[68:71], v[172:175], a[80:83], v[68:71]
ds_read_b128 v[196:199], v252 offset:14336
v_mfma_f32_16x16x32_bf16 v[68:71], v[176:179], a[84:87], v[68:71]
v_mfma_f32_16x16x32_bf16 v[68:71], v[180:183], a[88:91], v[68:71]
ds_read_b128 v[200:203], v252 offset:15360
v_mfma_f32_16x16x32_bf16 v[68:71], v[184:187], a[92:95], v[68:71]
v_mfma_f32_16x16x32_bf16 v[72:75], v[172:175], a[128:131], v[72:75]
v_mfma_f32_16x16x32_bf16 v[72:75], v[176:179], a[132:135], v[72:75]
v_mfma_f32_16x16x32_bf16 v[72:75], v[180:183], a[136:139], v[72:75]
v_mfma_f32_16x16x32_bf16 v[72:75], v[184:187], a[140:143], v[72:75]
v_cvt_pk_bf16_f32 v88, v64, v65
v_cvt_pk_bf16_f32 v89, v66, v67
s_waitcnt lgkmcnt(3)
v_mfma_f32_16x16x32_bf16 v[76:79], v[188:191], a[0:3], 0
ds_read_b128 v[172:175], v252 offset:16384
s_waitcnt lgkmcnt(3)
v_mfma_f32_16x16x32_bf16 v[76:79], v[192:195], a[4:7], v[76:79]
s_waitcnt lgkmcnt(2)
v_mfma_f32_16x16x32_bf16 v[76:79], v[196:199], a[8:11], v[76:79]
ds_read_b128 v[176:179], v252 offset:17408
s_waitcnt lgkmcnt(2)
v_mfma_f32_16x16x32_bf16 v[76:79], v[200:203], a[12:15], v[76:79]
v_cvt_pk_bf16_f32 v92, v68, v69
v_cvt_pk_bf16_f32 v93, v70, v71
v_mfma_f32_16x16x32_bf16 v[80:83], v[188:191], a[48:51], 0
ds_read_b128 v[180:183], v252 offset:18432
v_mfma_f32_16x16x32_bf16 v[80:83], v[192:195], a[52:55], v[80:83]
v_mfma_f32_16x16x32_bf16 v[80:83], v[196:199], a[56:59], v[80:83]
ds_read_b128 v[184:187], v252 offset:19456
v_mfma_f32_16x16x32_bf16 v[80:83], v[200:203], a[60:63], v[80:83]
v_cvt_pk_bf16_f32 v96, v72, v73
v_cvt_pk_bf16_f32 v97, v74, v75
v_mfma_f32_16x16x32_bf16 v[84:87], v[188:191], a[96:99], 0
v_mfma_f32_16x16x32_bf16 v[84:87], v[192:195], a[100:103], v[84:87]
v_mfma_f32_16x16x32_bf16 v[84:87], v[196:199], a[104:107], v[84:87]
v_mfma_f32_16x16x32_bf16 v[84:87], v[200:203], a[108:111], v[84:87]
s_waitcnt lgkmcnt(3)
v_mfma_f32_16x16x32_bf16 v[76:79], v[172:175], a[16:19], v[76:79]
ds_read_b128 v[188:191], v252 offset:20480
s_waitcnt lgkmcnt(3)
v_mfma_f32_16x16x32_bf16 v[76:79], v[176:179], a[20:23], v[76:79]
s_waitcnt lgkmcnt(2)
v_mfma_f32_16x16x32_bf16 v[76:79], v[180:183], a[24:27], v[76:79]
ds_read_b128 v[192:195], v252 offset:21504
s_waitcnt lgkmcnt(2)
v_mfma_f32_16x16x32_bf16 v[76:79], v[184:187], a[28:31], v[76:79]
v_mfma_f32_16x16x32_bf16 v[80:83], v[172:175], a[64:67], v[80:83]
ds_read_b128 v[196:199], v252 offset:22528
v_mfma_f32_16x16x32_bf16 v[80:83], v[176:179], a[68:71], v[80:83]
v_mfma_f32_16x16x32_bf16 v[80:83], v[180:183], a[72:75], v[80:83]
ds_read_b128 v[200:203], v252 offset:23552
v_mfma_f32_16x16x32_bf16 v[80:83], v[184:187], a[76:79], v[80:83]
v_mfma_f32_16x16x32_bf16 v[84:87], v[172:175], a[112:115], v[84:87]
v_mfma_f32_16x16x32_bf16 v[84:87], v[176:179], a[116:119], v[84:87]
v_mfma_f32_16x16x32_bf16 v[84:87], v[180:183], a[120:123], v[84:87]
v_mfma_f32_16x16x32_bf16 v[84:87], v[184:187], a[124:127], v[84:87]
s_waitcnt vmcnt(15) lgkmcnt(0)
s_barrier
v_add_u32 v252, 24576, v252
v_mfma_f32_16x16x32_bf16 v[76:79], v[188:191], a[32:35], v[76:79]
s_add_u32 m0, s17, 24576
s_add_u32 s24, s25, 122880
v_mfma_f32_16x16x32_bf16 v[76:79], v[192:195], a[36:39], v[76:79]
ds_read_b128 v[172:175], v252 offset:0
v_mfma_f32_16x16x32_bf16 v[76:79], v[196:199], a[40:43], v[76:79]
buffer_load_dwordx4 v251, s[12:15], s24 offen offset:0  lds
v_mfma_f32_16x16x32_bf16 v[76:79], v[200:203], a[44:47], v[76:79]
ds_read_b128 v[176:179], v252 offset:1024
v_mfma_f32_16x16x32_bf16 v[80:83], v[188:191], a[80:83], v[80:83]
v_mfma_f32_16x16x32_bf16 v[80:83], v[192:195], a[84:87], v[80:83]
ds_read_b128 v[180:183], v252 offset:2048
v_mfma_f32_16x16x32_bf16 v[80:83], v[196:199], a[88:91], v[80:83]
buffer_load_dwordx4 v251, s[12:15], s24 offen offset:1024  lds
v_mfma_f32_16x16x32_bf16 v[80:83], v[200:203], a[92:95], v[80:83]
ds_read_b128 v[184:187], v252 offset:3072
v_mfma_f32_16x16x32_bf16 v[84:87], v[188:191], a[128:131], v[84:87]
v_mfma_f32_16x16x32_bf16 v[84:87], v[192:195], a[132:135], v[84:87]
v_mfma_f32_16x16x32_bf16 v[84:87], v[196:199], a[136:139], v[84:87]
buffer_load_dwordx4 v251, s[12:15], s24 offen offset:2048  lds
v_mfma_f32_16x16x32_bf16 v[84:87], v[200:203], a[140:143], v[84:87]
v_cvt_pk_bf16_f32 v90, v76, v77
v_cvt_pk_bf16_f32 v91, v78, v79
s_waitcnt lgkmcnt(3)
v_mfma_f32_16x16x32_bf16 v[64:67], v[172:175], a[0:3], 0
ds_read_b128 v[188:191], v252 offset:4096
s_waitcnt lgkmcnt(3)
v_mfma_f32_16x16x32_bf16 v[64:67], v[176:179], a[4:7], v[64:67]
s_waitcnt lgkmcnt(2)
v_mfma_f32_16x16x32_bf16 v[64:67], v[180:183], a[8:11], v[64:67]
buffer_load_dwordx4 v251, s[12:15], s24 offen offset:3072  lds
ds_read_b128 v[192:195], v252 offset:5120
s_waitcnt lgkmcnt(2)
v_mfma_f32_16x16x32_bf16 v[64:67], v[184:187], a[12:15], v[64:67]
v_cvt_pk_bf16_f32 v94, v80, v81
v_cvt_pk_bf16_f32 v95, v82, v83
v_mfma_f32_16x16x32_bf16 v[68:71], v[172:175], a[48:51], 0
s_add_u32 m0, s17, 28672
s_add_u32 s24, s25, 126976
ds_read_b128 v[196:199], v252 offset:6144
v_mfma_f32_16x16x32_bf16 v[68:71], v[176:179], a[52:55], v[68:71]
v_mfma_f32_16x16x32_bf16 v[68:71], v[180:183], a[56:59], v[68:71]
buffer_load_dwordx4 v251, s[12:15], s24 offen offset:0  lds
ds_read_b128 v[200:203], v252 offset:7168
v_mfma_f32_16x16x32_bf16 v[68:71], v[184:187], a[60:63], v[68:71]
v_cvt_pk_bf16_f32 v98, v84, v85
v_cvt_pk_bf16_f32 v99, v86, v87
v_mfma_f32_16x16x32_bf16 v[72:75], v[172:175], a[96:99], 0
v_mfma_f32_16x16x32_bf16 v[72:75], v[176:179], a[100:103], v[72:75]
v_mfma_f32_16x16x32_bf16 v[72:75], v[180:183], a[104:107], v[72:75]
buffer_load_dwordx4 v251, s[12:15], s24 offen offset:1024  lds
v_mfma_f32_16x16x32_bf16 v[72:75], v[184:187], a[108:111], v[72:75]
v_mfma_f32_16x16x32_bf16 v[0:3], a[4:7], v[88:91], v[0:3]
buffer_store_dwordx4 v[88:91], v237, s[40:43], s28 offen sc1
s_add_u32 s28, s28, 1024
v_mfma_f32_16x16x32_bf16 v[4:7], a[52:55], v[92:95], v[4:7]
buffer_store_dwordx4 v[92:95], v237, s[40:43], s29 offen sc1
s_add_u32 s29, s29, 1024
v_mfma_f32_16x16x32_bf16 v[8:11], a[100:103], v[96:99], v[8:11]
buffer_store_dwordx4 v[96:99], v237, s[40:43], s30 offen sc1
s_add_u32 s30, s30, 1024
s_waitcnt lgkmcnt(3)
v_mfma_f32_16x16x32_bf16 v[64:67], v[188:191], a[16:19], v[64:67]
ds_read_b128 v[172:175], v252 offset:8192
s_waitcnt lgkmcnt(3)
v_mfma_f32_16x16x32_bf16 v[64:67], v[192:195], a[20:23], v[64:67]
s_waitcnt lgkmcnt(2)
v_mfma_f32_16x16x32_bf16 v[64:67], v[196:199], a[24:27], v[64:67]
ds_read_b128 v[176:179], v252 offset:9216
s_waitcnt lgkmcnt(2)
v_mfma_f32_16x16x32_bf16 v[64:67], v[200:203], a[28:31], v[64:67]
v_mfma_f32_16x16x32_bf16 v[68:71], v[188:191], a[64:67], v[68:71]
ds_read_b128 v[180:183], v252 offset:10240
v_mfma_f32_16x16x32_bf16 v[68:71], v[192:195], a[68:71], v[68:71]
v_mfma_f32_16x16x32_bf16 v[68:71], v[196:199], a[72:75], v[68:71]
ds_read_b128 v[184:187], v252 offset:11264
v_mfma_f32_16x16x32_bf16 v[68:71], v[200:203], a[76:79], v[68:71]
v_mfma_f32_16x16x32_bf16 v[72:75], v[188:191], a[112:115], v[72:75]
v_mfma_f32_16x16x32_bf16 v[72:75], v[192:195], a[116:119], v[72:75]
v_mfma_f32_16x16x32_bf16 v[72:75], v[196:199], a[120:123], v[72:75]
v_mfma_f32_16x16x32_bf16 v[72:75], v[200:203], a[124:127], v[72:75]
s_waitcnt lgkmcnt(3)
v_mfma_f32_16x16x32_bf16 v[64:67], v[172:175], a[32:35], v[64:67]
ds_read_b128 v[188:191], v252 offset:12288
s_waitcnt lgkmcnt(3)
v_mfma_f32_16x16x32_bf16 v[64:67], v[176:179], a[36:39], v[64:67]
s_waitcnt lgkmcnt(2)
v_mfma_f32_16x16x32_bf16 v[64:67], v[180:183], a[40:43], v[64:67]
ds_read_b128 v[192:195], v252 offset:13312
s_waitcnt lgkmcnt(2)
v_mfma_f32_16x16x32_bf16 v[64:67], v[184:187], a[44:47], v[64:67]
v_mfma_f32_16x16x32_bf16 v[68:71], v[172:175], a[80:83], v[68:71]
ds_read_b128 v[196:199], v252 offset:14336
v_mfma_f32_16x16x32_bf16 v[68:71], v[176:179], a[84:87], v[68:71]
v_mfma_f32_16x16x32_bf16 v[68:71], v[180:183], a[88:91], v[68:71]
ds_read_b128 v[200:203], v252 offset:15360
v_mfma_f32_16x16x32_bf16 v[68:71], v[184:187], a[92:95], v[68:71]
v_mfma_f32_16x16x32_bf16 v[72:75], v[172:175], a[128:131], v[72:75]
v_mfma_f32_16x16x32_bf16 v[72:75], v[176:179], a[132:135], v[72:75]
v_mfma_f32_16x16x32_bf16 v[72:75], v[180:183], a[136:139], v[72:75]
v_mfma_f32_16x16x32_bf16 v[72:75], v[184:187], a[140:143], v[72:75]
v_cvt_pk_bf16_f32 v88, v64, v65
v_cvt_pk_bf16_f32 v89, v66, v67
s_waitcnt lgkmcnt(3)
v_mfma_f32_16x16x32_bf16 v[76:79], v[188:191], a[0:3], 0
ds_read_b128 v[172:175], v252 offset:16384
s_waitcnt lgkmcnt(3)
v_mfma_f32_16x16x32_bf16 v[76:79], v[192:195], a[4:7], v[76:79]
s_waitcnt lgkmcnt(2)
v_mfma_f32_16x16x32_bf16 v[76:79], v[196:199], a[8:11], v[76:79]
ds_read_b128 v[176:179], v252 offset:17408
s_waitcnt lgkmcnt(2)
v_mfma_f32_16x16x32_bf16 v[76:79], v[200:203], a[12:15], v[76:79]
v_cvt_pk_bf16_f32 v92, v68, v69
v_cvt_pk_bf16_f32 v93, v70, v71
v_mfma_f32_16x16x32_bf16 v[80:83], v[188:191], a[48:51], 0
ds_read_b128 v[180:183], v252 offset:18432
v_mfma_f32_16x16x32_bf16 v[80:83], v[192:195], a[52:55], v[80:83]
v_mfma_f32_16x16x32_bf16 v[80:83], v[196:199], a[56:59], v[80:83]
ds_read_b128 v[184:187], v252 offset:19456
v_mfma_f32_16x16x32_bf16 v[80:83], v[200:203], a[60:63], v[80:83]
v_cvt_pk_bf16_f32 v96, v72, v73
v_cvt_pk_bf16_f32 v97, v74, v75
v_mfma_f32_16x16x32_bf16 v[84:87], v[188:191], a[96:99], 0
v_mfma_f32_16x16x32_bf16 v[84:87], v[192:195], a[100:103], v[84:87]
v_mfma_f32_16x16x32_bf16 v[84:87], v[196:199], a[104:107], v[84:87]
v_mfma_f32_16x16x32_bf16 v[84:87], v[200:203], a[108:111], v[84:87]
s_waitcnt lgkmcnt(3)
v_mfma_f32_16x16x32_bf16 v[76:79], v[172:175], a[16:19], v[76:79]
ds_read_b128 v[188:191], v252 offset:20480
s_waitcnt lgkmcnt(3)
v_mfma_f32_16x16x32_bf16 v[76:79], v[176:179], a[20:23], v[76:79]
s_waitcnt lgkmcnt(2)
v_mfma_f32_16x16x32_bf16 v[76:79], v[180:183], a[24:27], v[76:79]
ds_read_b128 v[192:195], v252 offset:21504
s_waitcnt lgkmcnt(2)
v_mfma_f32_16x16x32_bf16 v[76:79], v[184:187], a[28:31], v[76:79]
v_mfma_f32_16x16x32_bf16 v[80:83], v[172:175], a[64:67], v[80:83]
ds_read_b128 v[196:199], v252 offset:22528
v_mfma_f32_16x16x32_bf16 v[80:83], v[176:179], a[68:71], v[80:83]
v_mfma_f32_16x16x32_bf16 v[80:83], v[180:183], a[72:75], v[80:83]
ds_read_b128 v[200:203], v252 offset:23552
v_mfma_f32_16x16x32_bf16 v[80:83], v[184:187], a[76:79], v[80:83]
v_mfma_f32_16x16x32_bf16 v[84:87], v[172:175], a[112:115], v[84:87]
v_mfma_f32_16x16x32_bf16 v[84:87], v[176:179], a[116:119], v[84:87]
v_mfma_f32_16x16x32_bf16 v[84:87], v[180:183], a[120:123], v[84:87]
v_mfma_f32_16x16x32_bf16 v[84:87], v[184:187], a[124:127], v[84:87]
s_waitcnt vmcnt(18) lgkmcnt(0)
s_barrier
v_add_u32 v252, 24576, v252
v_mfma_f32_16x16x32_bf16 v[76:79], v[188:191], a[32:35], v[76:79]
s_add_u32 m0, s17, 49152
s_add_u32 s24, s25, 147456
v_mfma_f32_16x16x32_bf16 v[76:79], v[192:195], a[36:39], v[76:79]
ds_read_b128 v[172:175], v252 offset:0
v_mfma_f32_16x16x32_bf16 v[76:79], v[196:199], a[40:43], v[76:79]
buffer_load_dwordx4 v251, s[12:15], s24 offen offset:0  lds
v_mfma_f32_16x16x32_bf16 v[76:79], v[200:203], a[44:47], v[76:79]
ds_read_b128 v[176:179], v252 offset:1024
v_mfma_f32_16x16x32_bf16 v[80:83], v[188:191], a[80:83], v[80:83]
v_mfma_f32_16x16x32_bf16 v[80:83], v[192:195], a[84:87], v[80:83]
ds_read_b128 v[180:183], v252 offset:2048
v_mfma_f32_16x16x32_bf16 v[80:83], v[196:199], a[88:91], v[80:83]
buffer_load_dwordx4 v251, s[12:15], s24 offen offset:1024  lds
v_mfma_f32_16x16x32_bf16 v[80:83], v[200:203], a[92:95], v[80:83]
ds_read_b128 v[184:187], v252 offset:3072
v_mfma_f32_16x16x32_bf16 v[84:87], v[188:191], a[128:131], v[84:87]
v_mfma_f32_16x16x32_bf16 v[84:87], v[192:195], a[132:135], v[84:87]
v_mfma_f32_16x16x32_bf16 v[84:87], v[196:199], a[136:139], v[84:87]
buffer_load_dwordx4 v251, s[12:15], s24 offen offset:2048  lds
v_mfma_f32_16x16x32_bf16 v[84:87], v[200:203], a[140:143], v[84:87]
v_cvt_pk_bf16_f32 v90, v76, v77
v_cvt_pk_bf16_f32 v91, v78, v79
s_waitcnt lgkmcnt(3)
v_mfma_f32_16x16x32_bf16 v[64:67], v[172:175], a[0:3], 0
ds_read_b128 v[188:191], v252 offset:4096
s_waitcnt lgkmcnt(3)
v_mfma_f32_16x16x32_bf16 v[64:67], v[176:179], a[4:7], v[64:67]
s_waitcnt lgkmcnt(2)
v_mfma_f32_16x16x32_bf16 v[64:67], v[180:183], a[8:11], v[64:67]
buffer_load_dwordx4 v251, s[12:15], s24 offen offset:3072  lds
ds_read_b128 v[192:195], v252 offset:5120
s_waitcnt lgkmcnt(2)
v_mfma_f32_16x16x32_bf16 v[64:67], v[184:187], a[12:15], v[64:67]
v_cvt_pk_bf16_f32 v94, v80, v81
v_cvt_pk_bf16_f32 v95, v82, v83
v_mfma_f32_16x16x32_bf16 v[68:71], v[172:175], a[48:51], 0
s_add_u32 m0, s17, 53248
s_add_u32 s24, s25, 151552
ds_read_b128 v[196:199], v252 offset:6144
v_mfma_f32_16x16x32_bf16 v[68:71], v[176:179], a[52:55], v[68:71]
v_mfma_f32_16x16x32_bf16 v[68:71], v[180:183], a[56:59], v[68:71]
buffer_load_dwordx4 v251, s[12:15], s24 offen offset:0  lds
ds_read_b128 v[200:203], v252 offset:7168
v_mfma_f32_16x16x32_bf16 v[68:71], v[184:187], a[60:63], v[68:71]
v_cvt_pk_bf16_f32 v98, v84, v85
v_cvt_pk_bf16_f32 v99, v86, v87
v_mfma_f32_16x16x32_bf16 v[72:75], v[172:175], a[96:99], 0
v_mfma_f32_16x16x32_bf16 v[72:75], v[176:179], a[100:103], v[72:75]
v_mfma_f32_16x16x32_bf16 v[72:75], v[180:183], a[104:107], v[72:75]
buffer_load_dwordx4 v251, s[12:15], s24 offen offset:1024  lds
v_mfma_f32_16x16x32_bf16 v[72:75], v[184:187], a[108:111], v[72:75]
v_mfma_f32_16x16x32_bf16 v[0:3], a[8:11], v[88:91], v[0:3]
buffer_store_dwordx4 v[88:91], v237, s[40:43], s28 offen sc1
s_add_u32 s28, s28, 1024
v_mfma_f32_16x16x32_bf16 v[4:7], a[56:59], v[92:95], v[4:7]
buffer_store_dwordx4 v[92:95], v237, s[40:43], s29 offen sc1
s_add_u32 s29, s29, 1024
v_mfma_f32_16x16x32_bf16 v[8:11], a[104:107], v[96:99], v[8:11]
buffer_store_dwordx4 v[96:99], v237, s[40:43], s30 offen sc1
s_add_u32 s30, s30, 1024
s_waitcnt lgkmcnt(3)
v_mfma_f32_16x16x32_bf16 v[64:67], v[188:191], a[16:19], v[64:67]
ds_read_b128 v[172:175], v252 offset:8192
s_waitcnt lgkmcnt(3)
v_mfma_f32_16x16x32_bf16 v[64:67], v[192:195], a[20:23], v[64:67]
s_waitcnt lgkmcnt(2)
v_mfma_f32_16x16x32_bf16 v[64:67], v[196:199], a[24:27], v[64:67]
ds_read_b128 v[176:179], v252 offset:9216
s_waitcnt lgkmcnt(2)
v_mfma_f32_16x16x32_bf16 v[64:67], v[200:203], a[28:31], v[64:67]
v_mfma_f32_16x16x32_bf16 v[68:71], v[188:191], a[64:67], v[68:71]
ds_read_b128 v[180:183], v252 offset:10240
v_mfma_f32_16x16x32_bf16 v[68:71], v[192:195], a[68:71], v[68:71]
v_mfma_f32_16x16x32_bf16 v[68:71], v[196:199], a[72:75], v[68:71]
ds_read_b128 v[184:187], v252 offset:11264
v_mfma_f32_16x16x32_bf16 v[68:71], v[200:203], a[76:79], v[68:71]
v_mfma_f32_16x16x32_bf16 v[72:75], v[188:191], a[112:115], v[72:75]
v_mfma_f32_16x16x32_bf16 v[72:75], v[192:195], a[116:119], v[72:75]
v_mfma_f32_16x16x32_bf16 v[72:75], v[196:199], a[120:123], v[72:75]
v_mfma_f32_16x16x32_bf16 v[72:75], v[200:203], a[124:127], v[72:75]
s_waitcnt lgkmcnt(3)
v_mfma_f32_16x16x32_bf16 v[64:67], v[172:175], a[32:35], v[64:67]
ds_read_b128 v[188:191], v252 offset:12288
s_waitcnt lgkmcnt(3)
v_mfma_f32_16x16x32_bf16 v[64:67], v[176:179], a[36:39], v[64:67]
s_waitcnt lgkmcnt(2)
v_mfma_f32_16x16x32_bf16 v[64:67], v[180:183], a[40:43], v[64:67]
ds_read_b128 v[192:195], v252 offset:13312
s_waitcnt lgkmcnt(2)
v_mfma_f32_16x16x32_bf16 v[64:67], v[184:187], a[44:47], v[64:67]
v_mfma_f32_16x16x32_bf16 v[68:71], v[172:175], a[80:83], v[68:71]
ds_read_b128 v[196:199], v252 offset:14336
v_mfma_f32_16x16x32_bf16 v[68:71], v[176:179], a[84:87], v[68:71]
v_mfma_f32_16x16x32_bf16 v[68:71], v[180:183], a[88:91], v[68:71]
ds_read_b128 v[200:203], v252 offset:15360
v_mfma_f32_16x16x32_bf16 v[68:71], v[184:187], a[92:95], v[68:71]
v_mfma_f32_16x16x32_bf16 v[72:75], v[172:175], a[128:131], v[72:75]
v_mfma_f32_16x16x32_bf16 v[72:75], v[176:179], a[132:135], v[72:75]
v_mfma_f32_16x16x32_bf16 v[72:75], v[180:183], a[136:139], v[72:75]
v_mfma_f32_16x16x32_bf16 v[72:75], v[184:187], a[140:143], v[72:75]
v_cvt_pk_bf16_f32 v88, v64, v65
v_cvt_pk_bf16_f32 v89, v66, v67
s_waitcnt lgkmcnt(3)
v_mfma_f32_16x16x32_bf16 v[76:79], v[188:191], a[0:3], 0
ds_read_b128 v[172:175], v252 offset:16384
s_waitcnt lgkmcnt(3)
v_mfma_f32_16x16x32_bf16 v[76:79], v[192:195], a[4:7], v[76:79]
s_waitcnt lgkmcnt(2)
v_mfma_f32_16x16x32_bf16 v[76:79], v[196:199], a[8:11], v[76:79]
ds_read_b128 v[176:179], v252 offset:17408
s_waitcnt lgkmcnt(2)
v_mfma_f32_16x16x32_bf16 v[76:79], v[200:203], a[12:15], v[76:79]
v_cvt_pk_bf16_f32 v92, v68, v69
v_cvt_pk_bf16_f32 v93, v70, v71
v_mfma_f32_16x16x32_bf16 v[80:83], v[188:191], a[48:51], 0
ds_read_b128 v[180:183], v252 offset:18432
v_mfma_f32_16x16x32_bf16 v[80:83], v[192:195], a[52:55], v[80:83]
v_mfma_f32_16x16x32_bf16 v[80:83], v[196:199], a[56:59], v[80:83]
ds_read_b128 v[184:187], v252 offset:19456
v_mfma_f32_16x16x32_bf16 v[80:83], v[200:203], a[60:63], v[80:83]
v_cvt_pk_bf16_f32 v96, v72, v73
v_cvt_pk_bf16_f32 v97, v74, v75
v_mfma_f32_16x16x32_bf16 v[84:87], v[188:191], a[96:99], 0
v_mfma_f32_16x16x32_bf16 v[84:87], v[192:195], a[100:103], v[84:87]
v_mfma_f32_16x16x32_bf16 v[84:87], v[196:199], a[104:107], v[84:87]
v_mfma_f32_16x16x32_bf16 v[84:87], v[200:203], a[108:111], v[84:87]
s_waitcnt lgkmcnt(3)
v_mfma_f32_16x16x32_bf16 v[76:79], v[172:175], a[16:19], v[76:79]
ds_read_b128 v[188:191], v252 offset:20480
s_waitcnt lgkmcnt(3)
v_mfma_f32_16x16x32_bf16 v[76:79], v[176:179], a[20:23], v[76:79]
s_waitcnt lgkmcnt(2)
v_mfma_f32_16x16x32_bf16 v[76:79], v[180:183], a[24:27], v[76:79]
ds_read_b128 v[192:195], v252 offset:21504
s_waitcnt lgkmcnt(2)
v_mfma_f32_16x16x32_bf16 v[76:79], v[184:187], a[28:31], v[76:79]
v_mfma_f32_16x16x32_bf16 v[80:83], v[172:175], a[64:67], v[80:83]
ds_read_b128 v[196:199], v252 offset:22528
v_mfma_f32_16x16x32_bf16 v[80:83], v[176:179], a[68:71], v[80:83]
v_mfma_f32_16x16x32_bf16 v[80:83], v[180:183], a[72:75], v[80:83]
ds_read_b128 v[200:203], v252 offset:23552
v_mfma_f32_16x16x32_bf16 v[80:83], v[184:187], a[76:79], v[80:83]
v_mfma_f32_16x16x32_bf16 v[84:87], v[172:175], a[112:115], v[84:87]
v_mfma_f32_16x16x32_bf16 v[84:87], v[176:179], a[116:119], v[84:87]
v_mfma_f32_16x16x32_bf16 v[84:87], v[180:183], a[120:123], v[84:87]
v_mfma_f32_16x16x32_bf16 v[84:87], v[184:187], a[124:127], v[84:87]
s_waitcnt vmcnt(21) lgkmcnt(0)
s_barrier
v_add_u32 v252, 4294893568, v252
v_mfma_f32_16x16x32_bf16 v[76:79], v[188:191], a[32:35], v[76:79]
s_add_u32 m0, s17, 73728
s_add_u32 s24, s25, 172032
v_mfma_f32_16x16x32_bf16 v[76:79], v[192:195], a[36:39], v[76:79]
ds_read_b128 v[172:175], v252 offset:0
v_mfma_f32_16x16x32_bf16 v[76:79], v[196:199], a[40:43], v[76:79]
buffer_load_dwordx4 v251, s[12:15], s24 offen offset:0  lds
v_mfma_f32_16x16x32_bf16 v[76:79], v[200:203], a[44:47], v[76:79]
ds_read_b128 v[176:179], v252 offset:1024
v_mfma_f32_16x16x32_bf16 v[80:83], v[188:191], a[80:83], v[80:83]
v_mfma_f32_16x16x32_bf16 v[80:83], v[192:195], a[84:87], v[80:83]
ds_read_b128 v[180:183], v252 offset:2048
v_mfma_f32_16x16x32_bf16 v[80:83], v[196:199], a[88:91], v[80:83]
buffer_load_dwordx4 v251, s[12:15], s24 offen offset:1024  lds
v_mfma_f32_16x16x32_bf16 v[80:83], v[200:203], a[92:95], v[80:83]
ds_read_b128 v[184:187], v252 offset:3072
v_mfma_f32_16x16x32_bf16 v[84:87], v[188:191], a[128:131], v[84:87]
v_mfma_f32_16x16x32_bf16 v[84:87], v[192:195], a[132:135], v[84:87]
v_mfma_f32_16x16x32_bf16 v[84:87], v[196:199], a[136:139], v[84:87]
buffer_load_dwordx4 v251, s[12:15], s24 offen offset:2048  lds
v_mfma_f32_16x16x32_bf16 v[84:87], v[200:203], a[140:143], v[84:87]
v_cvt_pk_bf16_f32 v90, v76, v77
v_cvt_pk_bf16_f32 v91, v78, v79
s_waitcnt lgkmcnt(3)
v_mfma_f32_16x16x32_bf16 v[64:67], v[172:175], a[0:3], 0
ds_read_b128 v[188:191], v252 offset:4096
s_waitcnt lgkmcnt(3)
v_mfma_f32_16x16x32_bf16 v[64:67], v[176:179], a[4:7], v[64:67]
s_waitcnt lgkmcnt(2)
v_mfma_f32_16x16x32_bf16 v[64:67], v[180:183], a[8:11], v[64:67]
buffer_load_dwordx4 v251, s[12:15], s24 offen offset:3072  lds
ds_read_b128 v[192:195], v252 offset:5120
s_waitcnt lgkmcnt(2)
v_mfma_f32_16x16x32_bf16 v[64:67], v[184:187], a[12:15], v[64:67]
v_cvt_pk_bf16_f32 v94, v80, v81
v_cvt_pk_bf16_f32 v95, v82, v83
v_mfma_f32_16x16x32_bf16 v[68:71], v[172:175], a[48:51], 0
s_add_u32 m0, s17, 77824
s_add_u32 s24, s25, 176128
ds_read_b128 v[196:199], v252 offset:6144
v_mfma_f32_16x16x32_bf16 v[68:71], v[176:179], a[52:55], v[68:71]
v_mfma_f32_16x16x32_bf16 v[68:71], v[180:183], a[56:59], v[68:71]
buffer_load_dwordx4 v251, s[12:15], s24 offen offset:0  lds
ds_read_b128 v[200:203], v252 offset:7168
v_mfma_f32_16x16x32_bf16 v[68:71], v[184:187], a[60:63], v[68:71]
v_cvt_pk_bf16_f32 v98, v84, v85
v_cvt_pk_bf16_f32 v99, v86, v87
v_mfma_f32_16x16x32_bf16 v[72:75], v[172:175], a[96:99], 0
v_mfma_f32_16x16x32_bf16 v[72:75], v[176:179], a[100:103], v[72:75]
v_mfma_f32_16x16x32_bf16 v[72:75], v[180:183], a[104:107], v[72:75]
buffer_load_dwordx4 v251, s[12:15], s24 offen offset:1024  lds
v_mfma_f32_16x16x32_bf16 v[72:75], v[184:187], a[108:111], v[72:75]
v_mfma_f32_16x16x32_bf16 v[0:3], a[12:15], v[88:91], v[0:3]
buffer_store_dwordx4 v[88:91], v237, s[40:43], s28 offen sc1
s_add_u32 s28, s28, 1024
v_mfma_f32_16x16x32_bf16 v[4:7], a[60:63], v[92:95], v[4:7]
buffer_store_dwordx4 v[92:95], v237, s[40:43], s29 offen sc1
s_add_u32 s29, s29, 1024
v_mfma_f32_16x16x32_bf16 v[8:11], a[108:111], v[96:99], v[8:11]
buffer_store_dwordx4 v[96:99], v237, s[40:43], s30 offen sc1
s_add_u32 s30, s30, 1024
s_waitcnt lgkmcnt(3)
v_mfma_f32_16x16x32_bf16 v[64:67], v[188:191], a[16:19], v[64:67]
ds_read_b128 v[172:175], v252 offset:8192
s_waitcnt lgkmcnt(3)
v_mfma_f32_16x16x32_bf16 v[64:67], v[192:195], a[20:23], v[64:67]
s_waitcnt lgkmcnt(2)
v_mfma_f32_16x16x32_bf16 v[64:67], v[196:199], a[24:27], v[64:67]
ds_read_b128 v[176:179], v252 offset:9216
s_waitcnt lgkmcnt(2)
v_mfma_f32_16x16x32_bf16 v[64:67], v[200:203], a[28:31], v[64:67]
v_mfma_f32_16x16x32_bf16 v[68:71], v[188:191], a[64:67], v[68:71]
ds_read_b128 v[180:183], v252 offset:10240
v_mfma_f32_16x16x32_bf16 v[68:71], v[192:195], a[68:71], v[68:71]
v_mfma_f32_16x16x32_bf16 v[68:71], v[196:199], a[72:75], v[68:71]
ds_read_b128 v[184:187], v252 offset:11264
v_mfma_f32_16x16x32_bf16 v[68:71], v[200:203], a[76:79], v[68:71]
v_mfma_f32_16x16x32_bf16 v[72:75], v[188:191], a[112:115], v[72:75]
v_mfma_f32_16x16x32_bf16 v[72:75], v[192:195], a[116:119], v[72:75]
v_mfma_f32_16x16x32_bf16 v[72:75], v[196:199], a[120:123], v[72:75]
v_mfma_f32_16x16x32_bf16 v[72:75], v[200:203], a[124:127], v[72:75]
s_waitcnt lgkmcnt(3)
v_mfma_f32_16x16x32_bf16 v[64:67], v[172:175], a[32:35], v[64:67]
ds_read_b128 v[188:191], v252 offset:12288
s_waitcnt lgkmcnt(3)
v_mfma_f32_16x16x32_bf16 v[64:67], v[176:179], a[36:39], v[64:67]
s_waitcnt lgkmcnt(2)
v_mfma_f32_16x16x32_bf16 v[64:67], v[180:183], a[40:43], v[64:67]
ds_read_b128 v[192:195], v252 offset:13312
s_waitcnt lgkmcnt(2)
v_mfma_f32_16x16x32_bf16 v[64:67], v[184:187], a[44:47], v[64:67]
v_mfma_f32_16x16x32_bf16 v[68:71], v[172:175], a[80:83], v[68:71]
ds_read_b128 v[196:199], v252 offset:14336
v_mfma_f32_16x16x32_bf16 v[68:71], v[176:179], a[84:87], v[68:71]
v_mfma_f32_16x16x32_bf16 v[68:71], v[180:183], a[88:91], v[68:71]
ds_read_b128 v[200:203], v252 offset:15360
v_mfma_f32_16x16x32_bf16 v[68:71], v[184:187], a[92:95], v[68:71]
v_mfma_f32_16x16x32_bf16 v[72:75], v[172:175], a[128:131], v[72:75]
v_mfma_f32_16x16x32_bf16 v[72:75], v[176:179], a[132:135], v[72:75]
v_mfma_f32_16x16x32_bf16 v[72:75], v[180:183], a[136:139], v[72:75]
v_mfma_f32_16x16x32_bf16 v[72:75], v[184:187], a[140:143], v[72:75]
v_cvt_pk_bf16_f32 v88, v64, v65
v_cvt_pk_bf16_f32 v89, v66, v67
s_waitcnt lgkmcnt(3)
v_mfma_f32_16x16x32_bf16 v[76:79], v[188:191], a[0:3], 0
ds_read_b128 v[172:175], v252 offset:16384
s_waitcnt lgkmcnt(3)
v_mfma_f32_16x16x32_bf16 v[76:79], v[192:195], a[4:7], v[76:79]
s_waitcnt lgkmcnt(2)
v_mfma_f32_16x16x32_bf16 v[76:79], v[196:199], a[8:11], v[76:79]
ds_read_b128 v[176:179], v252 offset:17408
s_waitcnt lgkmcnt(2)
v_mfma_f32_16x16x32_bf16 v[76:79], v[200:203], a[12:15], v[76:79]
v_cvt_pk_bf16_f32 v92, v68, v69
v_cvt_pk_bf16_f32 v93, v70, v71
v_mfma_f32_16x16x32_bf16 v[80:83], v[188:191], a[48:51], 0
ds_read_b128 v[180:183], v252 offset:18432
v_mfma_f32_16x16x32_bf16 v[80:83], v[192:195], a[52:55], v[80:83]
v_mfma_f32_16x16x32_bf16 v[80:83], v[196:199], a[56:59], v[80:83]
ds_read_b128 v[184:187], v252 offset:19456
v_mfma_f32_16x16x32_bf16 v[80:83], v[200:203], a[60:63], v[80:83]
v_cvt_pk_bf16_f32 v96, v72, v73
v_cvt_pk_bf16_f32 v97, v74, v75
v_mfma_f32_16x16x32_bf16 v[84:87], v[188:191], a[96:99], 0
v_mfma_f32_16x16x32_bf16 v[84:87], v[192:195], a[100:103], v[84:87]
v_mfma_f32_16x16x32_bf16 v[84:87], v[196:199], a[104:107], v[84:87]
v_mfma_f32_16x16x32_bf16 v[84:87], v[200:203], a[108:111], v[84:87]
s_waitcnt lgkmcnt(3)
v_mfma_f32_16x16x32_bf16 v[76:79], v[172:175], a[16:19], v[76:79]
ds_read_b128 v[188:191], v252 offset:20480
s_waitcnt lgkmcnt(3)
v_mfma_f32_16x16x32_bf16 v[76:79], v[176:179], a[20:23], v[76:79]
s_waitcnt lgkmcnt(2)
v_mfma_f32_16x16x32_bf16 v[76:79], v[180:183], a[24:27], v[76:79]
ds_read_b128 v[192:195], v252 offset:21504
s_waitcnt lgkmcnt(2)
v_mfma_f32_16x16x32_bf16 v[76:79], v[184:187], a[28:31], v[76:79]
v_mfma_f32_16x16x32_bf16 v[80:83], v[172:175], a[64:67], v[80:83]
ds_read_b128 v[196:199], v252 offset:22528
v_mfma_f32_16x16x32_bf16 v[80:83], v[176:179], a[68:71], v[80:83]
v_mfma_f32_16x16x32_bf16 v[80:83], v[180:183], a[72:75], v[80:83]
ds_read_b128 v[200:203], v252 offset:23552
v_mfma_f32_16x16x32_bf16 v[80:83], v[184:187], a[76:79], v[80:83]
v_mfma_f32_16x16x32_bf16 v[84:87], v[172:175], a[112:115], v[84:87]
v_mfma_f32_16x16x32_bf16 v[84:87], v[176:179], a[116:119], v[84:87]
v_mfma_f32_16x16x32_bf16 v[84:87], v[180:183], a[120:123], v[84:87]
v_mfma_f32_16x16x32_bf16 v[84:87], v[184:187], a[124:127], v[84:87]
s_waitcnt vmcnt(21) lgkmcnt(0)
s_barrier
v_add_u32 v252, 24576, v252
v_mfma_f32_16x16x32_bf16 v[76:79], v[188:191], a[32:35], v[76:79]
s_add_u32 m0, s17, 0
s_add_u32 s24, s25, 196608
v_mfma_f32_16x16x32_bf16 v[76:79], v[192:195], a[36:39], v[76:79]
ds_read_b128 v[172:175], v252 offset:0
v_mfma_f32_16x16x32_bf16 v[76:79], v[196:199], a[40:43], v[76:79]
buffer_load_dwordx4 v251, s[12:15], s24 offen offset:0  lds
v_mfma_f32_16x16x32_bf16 v[76:79], v[200:203], a[44:47], v[76:79]
ds_read_b128 v[176:179], v252 offset:1024
v_mfma_f32_16x16x32_bf16 v[80:83], v[188:191], a[80:83], v[80:83]
v_mfma_f32_16x16x32_bf16 v[80:83], v[192:195], a[84:87], v[80:83]
ds_read_b128 v[180:183], v252 offset:2048
v_mfma_f32_16x16x32_bf16 v[80:83], v[196:199], a[88:91], v[80:83]
buffer_load_dwordx4 v251, s[12:15], s24 offen offset:1024  lds
v_mfma_f32_16x16x32_bf16 v[80:83], v[200:203], a[92:95], v[80:83]
ds_read_b128 v[184:187], v252 offset:3072
v_mfma_f32_16x16x32_bf16 v[84:87], v[188:191], a[128:131], v[84:87]
v_mfma_f32_16x16x32_bf16 v[84:87], v[192:195], a[132:135], v[84:87]
v_mfma_f32_16x16x32_bf16 v[84:87], v[196:199], a[136:139], v[84:87]
buffer_load_dwordx4 v251, s[12:15], s24 offen offset:2048  lds
v_mfma_f32_16x16x32_bf16 v[84:87], v[200:203], a[140:143], v[84:87]
v_cvt_pk_bf16_f32 v90, v76, v77
v_cvt_pk_bf16_f32 v91, v78, v79
s_waitcnt lgkmcnt(3)
v_mfma_f32_16x16x32_bf16 v[64:67], v[172:175], a[0:3], 0
ds_read_b128 v[188:191], v252 offset:4096
s_waitcnt lgkmcnt(3)
v_mfma_f32_16x16x32_bf16 v[64:67], v[176:179], a[4:7], v[64:67]
s_waitcnt lgkmcnt(2)
v_mfma_f32_16x16x32_bf16 v[64:67], v[180:183], a[8:11], v[64:67]
buffer_load_dwordx4 v251, s[12:15], s24 offen offset:3072  lds
ds_read_b128 v[192:195], v252 offset:5120
s_waitcnt lgkmcnt(2)
v_mfma_f32_16x16x32_bf16 v[64:67], v[184:187], a[12:15], v[64:67]
v_cvt_pk_bf16_f32 v94, v80, v81
v_cvt_pk_bf16_f32 v95, v82, v83
v_mfma_f32_16x16x32_bf16 v[68:71], v[172:175], a[48:51], 0
s_add_u32 m0, s17, 4096
s_add_u32 s24, s25, 200704
ds_read_b128 v[196:199], v252 offset:6144
v_mfma_f32_16x16x32_bf16 v[68:71], v[176:179], a[52:55], v[68:71]
v_mfma_f32_16x16x32_bf16 v[68:71], v[180:183], a[56:59], v[68:71]
buffer_load_dwordx4 v251, s[12:15], s24 offen offset:0  lds
ds_read_b128 v[200:203], v252 offset:7168
v_mfma_f32_16x16x32_bf16 v[68:71], v[184:187], a[60:63], v[68:71]
v_cvt_pk_bf16_f32 v98, v84, v85
v_cvt_pk_bf16_f32 v99, v86, v87
v_mfma_f32_16x16x32_bf16 v[72:75], v[172:175], a[96:99], 0
v_mfma_f32_16x16x32_bf16 v[72:75], v[176:179], a[100:103], v[72:75]
v_mfma_f32_16x16x32_bf16 v[72:75], v[180:183], a[104:107], v[72:75]
buffer_load_dwordx4 v251, s[12:15], s24 offen offset:1024  lds
v_mfma_f32_16x16x32_bf16 v[72:75], v[184:187], a[108:111], v[72:75]
v_mfma_f32_16x16x32_bf16 v[0:3], a[16:19], v[88:91], v[0:3]
buffer_store_dwordx4 v[88:91], v237, s[40:43], s28 offen sc1
s_add_u32 s28, s28, 1024
v_mfma_f32_16x16x32_bf16 v[4:7], a[64:67], v[92:95], v[4:7]
buffer_store_dwordx4 v[92:95], v237, s[40:43], s29 offen sc1
s_add_u32 s29, s29, 1024
v_mfma_f32_16x16x32_bf16 v[8:11], a[112:115], v[96:99], v[8:11]
buffer_store_dwordx4 v[96:99], v237, s[40:43], s30 offen sc1
s_add_u32 s30, s30, 1024
s_waitcnt lgkmcnt(3)
v_mfma_f32_16x16x32_bf16 v[64:67], v[188:191], a[16:19], v[64:67]
ds_read_b128 v[172:175], v252 offset:8192
s_waitcnt lgkmcnt(3)
v_mfma_f32_16x16x32_bf16 v[64:67], v[192:195], a[20:23], v[64:67]
s_waitcnt lgkmcnt(2)
v_mfma_f32_16x16x32_bf16 v[64:67], v[196:199], a[24:27], v[64:67]
ds_read_b128 v[176:179], v252 offset:9216
s_waitcnt lgkmcnt(2)
v_mfma_f32_16x16x32_bf16 v[64:67], v[200:203], a[28:31], v[64:67]
v_mfma_f32_16x16x32_bf16 v[68:71], v[188:191], a[64:67], v[68:71]
ds_read_b128 v[180:183], v252 offset:10240
v_mfma_f32_16x16x32_bf16 v[68:71], v[192:195], a[68:71], v[68:71]
v_mfma_f32_16x16x32_bf16 v[68:71], v[196:199], a[72:75], v[68:71]
ds_read_b128 v[184:187], v252 offset:11264
v_mfma_f32_16x16x32_bf16 v[68:71], v[200:203], a[76:79], v[68:71]
v_mfma_f32_16x16x32_bf16 v[72:75], v[188:191], a[112:115], v[72:75]
v_mfma_f32_16x16x32_bf16 v[72:75], v[192:195], a[116:119], v[72:75]
v_mfma_f32_16x16x32_bf16 v[72:75], v[196:199], a[120:123], v[72:75]
v_mfma_f32_16x16x32_bf16 v[72:75], v[200:203], a[124:127], v[72:75]
s_waitcnt lgkmcnt(3)
v_mfma_f32_16x16x32_bf16 v[64:67], v[172:175], a[32:35], v[64:67]
ds_read_b128 v[188:191], v252 offset:12288
s_waitcnt lgkmcnt(3)
v_mfma_f32_16x16x32_bf16 v[64:67], v[176:179], a[36:39], v[64:67]
s_waitcnt lgkmcnt(2)
v_mfma_f32_16x16x32_bf16 v[64:67], v[180:183], a[40:43], v[64:67]
ds_read_b128 v[192:195], v252 offset:13312
s_waitcnt lgkmcnt(2)
v_mfma_f32_16x16x32_bf16 v[64:67], v[184:187], a[44:47], v[64:67]
v_mfma_f32_16x16x32_bf16 v[68:71], v[172:175], a[80:83], v[68:71]
ds_read_b128 v[196:199], v252 offset:14336
v_mfma_f32_16x16x32_bf16 v[68:71], v[176:179], a[84:87], v[68:71]
v_mfma_f32_16x16x32_bf16 v[68:71], v[180:183], a[88:91], v[68:71]
ds_read_b128 v[200:203], v252 offset:15360
v_mfma_f32_16x16x32_bf16 v[68:71], v[184:187], a[92:95], v[68:71]
v_mfma_f32_16x16x32_bf16 v[72:75], v[172:175], a[128:131], v[72:75]
v_mfma_f32_16x16x32_bf16 v[72:75], v[176:179], a[132:135], v[72:75]
v_mfma_f32_16x16x32_bf16 v[72:75], v[180:183], a[136:139], v[72:75]
v_mfma_f32_16x16x32_bf16 v[72:75], v[184:187], a[140:143], v[72:75]
v_cvt_pk_bf16_f32 v88, v64, v65
v_cvt_pk_bf16_f32 v89, v66, v67
s_waitcnt lgkmcnt(3)
v_mfma_f32_16x16x32_bf16 v[76:79], v[188:191], a[0:3], 0
ds_read_b128 v[172:175], v252 offset:16384
s_waitcnt lgkmcnt(3)
v_mfma_f32_16x16x32_bf16 v[76:79], v[192:195], a[4:7], v[76:79]
s_waitcnt lgkmcnt(2)
v_mfma_f32_16x16x32_bf16 v[76:79], v[196:199], a[8:11], v[76:79]
ds_read_b128 v[176:179], v252 offset:17408
s_waitcnt lgkmcnt(2)
v_mfma_f32_16x16x32_bf16 v[76:79], v[200:203], a[12:15], v[76:79]
v_cvt_pk_bf16_f32 v92, v68, v69
v_cvt_pk_bf16_f32 v93, v70, v71
v_mfma_f32_16x16x32_bf16 v[80:83], v[188:191], a[48:51], 0
ds_read_b128 v[180:183], v252 offset:18432
v_mfma_f32_16x16x32_bf16 v[80:83], v[192:195], a[52:55], v[80:83]
v_mfma_f32_16x16x32_bf16 v[80:83], v[196:199], a[56:59], v[80:83]
ds_read_b128 v[184:187], v252 offset:19456
v_mfma_f32_16x16x32_bf16 v[80:83], v[200:203], a[60:63], v[80:83]
v_cvt_pk_bf16_f32 v96, v72, v73
v_cvt_pk_bf16_f32 v97, v74, v75
v_mfma_f32_16x16x32_bf16 v[84:87], v[188:191], a[96:99], 0
v_mfma_f32_16x16x32_bf16 v[84:87], v[192:195], a[100:103], v[84:87]
v_mfma_f32_16x16x32_bf16 v[84:87], v[196:199], a[104:107], v[84:87]
v_mfma_f32_16x16x32_bf16 v[84:87], v[200:203], a[108:111], v[84:87]
s_waitcnt lgkmcnt(3)
v_mfma_f32_16x16x32_bf16 v[76:79], v[172:175], a[16:19], v[76:79]
ds_read_b128 v[188:191], v252 offset:20480
s_waitcnt lgkmcnt(3)
v_mfma_f32_16x16x32_bf16 v[76:79], v[176:179], a[20:23], v[76:79]
s_waitcnt lgkmcnt(2)
v_mfma_f32_16x16x32_bf16 v[76:79], v[180:183], a[24:27], v[76:79]
ds_read_b128 v[192:195], v252 offset:21504
s_waitcnt lgkmcnt(2)
v_mfma_f32_16x16x32_bf16 v[76:79], v[184:187], a[28:31], v[76:79]
v_mfma_f32_16x16x32_bf16 v[80:83], v[172:175], a[64:67], v[80:83]
ds_read_b128 v[196:199], v252 offset:22528
v_mfma_f32_16x16x32_bf16 v[80:83], v[176:179], a[68:71], v[80:83]
v_mfma_f32_16x16x32_bf16 v[80:83], v[180:183], a[72:75], v[80:83]
ds_read_b128 v[200:203], v252 offset:23552
v_mfma_f32_16x16x32_bf16 v[80:83], v[184:187], a[76:79], v[80:83]
v_mfma_f32_16x16x32_bf16 v[84:87], v[172:175], a[112:115], v[84:87]
v_mfma_f32_16x16x32_bf16 v[84:87], v[176:179], a[116:119], v[84:87]
v_mfma_f32_16x16x32_bf16 v[84:87], v[180:183], a[120:123], v[84:87]
v_mfma_f32_16x16x32_bf16 v[84:87], v[184:187], a[124:127], v[84:87]
s_waitcnt vmcnt(21) lgkmcnt(0)
s_barrier
v_add_u32 v252, 24576, v252
v_mfma_f32_16x16x32_bf16 v[76:79], v[188:191], a[32:35], v[76:79]
s_add_u32 m0, s17, 24576
s_add_u32 s24, s25, 221184
v_mfma_f32_16x16x32_bf16 v[76:79], v[192:195], a[36:39], v[76:79]
ds_read_b128 v[172:175], v252 offset:0
v_mfma_f32_16x16x32_bf16 v[76:79], v[196:199], a[40:43], v[76:79]
buffer_load_dwordx4 v251, s[12:15], s24 offen offset:0  lds
v_mfma_f32_16x16x32_bf16 v[76:79], v[200:203], a[44:47], v[76:79]
ds_read_b128 v[176:179], v252 offset:1024
v_mfma_f32_16x16x32_bf16 v[80:83], v[188:191], a[80:83], v[80:83]
v_mfma_f32_16x16x32_bf16 v[80:83], v[192:195], a[84:87], v[80:83]
ds_read_b128 v[180:183], v252 offset:2048
v_mfma_f32_16x16x32_bf16 v[80:83], v[196:199], a[88:91], v[80:83]
buffer_load_dwordx4 v251, s[12:15], s24 offen offset:1024  lds
v_mfma_f32_16x16x32_bf16 v[80:83], v[200:203], a[92:95], v[80:83]
ds_read_b128 v[184:187], v252 offset:3072
v_mfma_f32_16x16x32_bf16 v[84:87], v[188:191], a[128:131], v[84:87]
v_mfma_f32_16x16x32_bf16 v[84:87], v[192:195], a[132:135], v[84:87]
v_mfma_f32_16x16x32_bf16 v[84:87], v[196:199], a[136:139], v[84:87]
buffer_load_dwordx4 v251, s[12:15], s24 offen offset:2048  lds
v_mfma_f32_16x16x32_bf16 v[84:87], v[200:203], a[140:143], v[84:87]
v_cvt_pk_bf16_f32 v90, v76, v77
v_cvt_pk_bf16_f32 v91, v78, v79
s_waitcnt lgkmcnt(3)
v_mfma_f32_16x16x32_bf16 v[64:67], v[172:175], a[0:3], 0
ds_read_b128 v[188:191], v252 offset:4096
s_waitcnt lgkmcnt(3)
v_mfma_f32_16x16x32_bf16 v[64:67], v[176:179], a[4:7], v[64:67]
s_waitcnt lgkmcnt(2)
v_mfma_f32_16x16x32_bf16 v[64:67], v[180:183], a[8:11], v[64:67]
buffer_load_dwordx4 v251, s[12:15], s24 offen offset:3072  lds
ds_read_b128 v[192:195], v252 offset:5120
s_waitcnt lgkmcnt(2)
v_mfma_f32_16x16x32_bf16 v[64:67], v[184:187], a[12:15], v[64:67]
v_cvt_pk_bf16_f32 v94, v80, v81
v_cvt_pk_bf16_f32 v95, v82, v83
v_mfma_f32_16x16x32_bf16 v[68:71], v[172:175], a[48:51], 0
s_add_u32 m0, s17, 28672
s_add_u32 s24, s25, 225280
ds_read_b128 v[196:199], v252 offset:6144
v_mfma_f32_16x16x32_bf16 v[68:71], v[176:179], a[52:55], v[68:71]
v_mfma_f32_16x16x32_bf16 v[68:71], v[180:183], a[56:59], v[68:71]
buffer_load_dwordx4 v251, s[12:15], s24 offen offset:0  lds
ds_read_b128 v[200:203], v252 offset:7168
v_mfma_f32_16x16x32_bf16 v[68:71], v[184:187], a[60:63], v[68:71]
v_cvt_pk_bf16_f32 v98, v84, v85
v_cvt_pk_bf16_f32 v99, v86, v87
v_mfma_f32_16x16x32_bf16 v[72:75], v[172:175], a[96:99], 0
v_mfma_f32_16x16x32_bf16 v[72:75], v[176:179], a[100:103], v[72:75]
v_mfma_f32_16x16x32_bf16 v[72:75], v[180:183], a[104:107], v[72:75]
buffer_load_dwordx4 v251, s[12:15], s24 offen offset:1024  lds
v_mfma_f32_16x16x32_bf16 v[72:75], v[184:187], a[108:111], v[72:75]
v_mfma_f32_16x16x32_bf16 v[0:3], a[20:23], v[88:91], v[0:3]
buffer_store_dwordx4 v[88:91], v237, s[40:43], s28 offen sc1
s_add_u32 s28, s28, 1024
v_mfma_f32_16x16x32_bf16 v[4:7], a[68:71], v[92:95], v[4:7]
buffer_store_dwordx4 v[92:95], v237, s[40:43], s29 offen sc1
s_add_u32 s29, s29, 1024
v_mfma_f32_16x16x32_bf16 v[8:11], a[116:119], v[96:99], v[8:11]
buffer_store_dwordx4 v[96:99], v237, s[40:43], s30 offen sc1
s_add_u32 s30, s30, 1024
s_waitcnt lgkmcnt(3)
v_mfma_f32_16x16x32_bf16 v[64:67], v[188:191], a[16:19], v[64:67]
ds_read_b128 v[172:175], v252 offset:8192
s_waitcnt lgkmcnt(3)
v_mfma_f32_16x16x32_bf16 v[64:67], v[192:195], a[20:23], v[64:67]
s_waitcnt lgkmcnt(2)
v_mfma_f32_16x16x32_bf16 v[64:67], v[196:199], a[24:27], v[64:67]
ds_read_b128 v[176:179], v252 offset:9216
s_waitcnt lgkmcnt(2)
v_mfma_f32_16x16x32_bf16 v[64:67], v[200:203], a[28:31], v[64:67]
v_mfma_f32_16x16x32_bf16 v[68:71], v[188:191], a[64:67], v[68:71]
ds_read_b128 v[180:183], v252 offset:10240
v_mfma_f32_16x16x32_bf16 v[68:71], v[192:195], a[68:71], v[68:71]
v_mfma_f32_16x16x32_bf16 v[68:71], v[196:199], a[72:75], v[68:71]
ds_read_b128 v[184:187], v252 offset:11264
v_mfma_f32_16x16x32_bf16 v[68:71], v[200:203], a[76:79], v[68:71]
v_mfma_f32_16x16x32_bf16 v[72:75], v[188:191], a[112:115], v[72:75]
v_mfma_f32_16x16x32_bf16 v[72:75], v[192:195], a[116:119], v[72:75]
v_mfma_f32_16x16x32_bf16 v[72:75], v[196:199], a[120:123], v[72:75]
v_mfma_f32_16x16x32_bf16 v[72:75], v[200:203], a[124:127], v[72:75]
s_waitcnt lgkmcnt(3)
v_mfma_f32_16x16x32_bf16 v[64:67], v[172:175], a[32:35], v[64:67]
ds_read_b128 v[188:191], v252 offset:12288
s_waitcnt lgkmcnt(3)
v_mfma_f32_16x16x32_bf16 v[64:67], v[176:179], a[36:39], v[64:67]
s_waitcnt lgkmcnt(2)
v_mfma_f32_16x16x32_bf16 v[64:67], v[180:183], a[40:43], v[64:67]
ds_read_b128 v[192:195], v252 offset:13312
s_waitcnt lgkmcnt(2)
v_mfma_f32_16x16x32_bf16 v[64:67], v[184:187], a[44:47], v[64:67]
v_mfma_f32_16x16x32_bf16 v[68:71], v[172:175], a[80:83], v[68:71]
ds_read_b128 v[196:199], v252 offset:14336
v_mfma_f32_16x16x32_bf16 v[68:71], v[176:179], a[84:87], v[68:71]
v_mfma_f32_16x16x32_bf16 v[68:71], v[180:183], a[88:91], v[68:71]
ds_read_b128 v[200:203], v252 offset:15360
v_mfma_f32_16x16x32_bf16 v[68:71], v[184:187], a[92:95], v[68:71]
v_mfma_f32_16x16x32_bf16 v[72:75], v[172:175], a[128:131], v[72:75]
v_mfma_f32_16x16x32_bf16 v[72:75], v[176:179], a[132:135], v[72:75]
v_mfma_f32_16x16x32_bf16 v[72:75], v[180:183], a[136:139], v[72:75]
v_mfma_f32_16x16x32_bf16 v[72:75], v[184:187], a[140:143], v[72:75]
v_cvt_pk_bf16_f32 v88, v64, v65
v_cvt_pk_bf16_f32 v89, v66, v67
s_waitcnt lgkmcnt(3)
v_mfma_f32_16x16x32_bf16 v[76:79], v[188:191], a[0:3], 0
ds_read_b128 v[172:175], v252 offset:16384
s_waitcnt lgkmcnt(3)
v_mfma_f32_16x16x32_bf16 v[76:79], v[192:195], a[4:7], v[76:79]
s_waitcnt lgkmcnt(2)
v_mfma_f32_16x16x32_bf16 v[76:79], v[196:199], a[8:11], v[76:79]
ds_read_b128 v[176:179], v252 offset:17408
s_waitcnt lgkmcnt(2)
v_mfma_f32_16x16x32_bf16 v[76:79], v[200:203], a[12:15], v[76:79]
v_cvt_pk_bf16_f32 v92, v68, v69
v_cvt_pk_bf16_f32 v93, v70, v71
v_mfma_f32_16x16x32_bf16 v[80:83], v[188:191], a[48:51], 0
ds_read_b128 v[180:183], v252 offset:18432
v_mfma_f32_16x16x32_bf16 v[80:83], v[192:195], a[52:55], v[80:83]
v_mfma_f32_16x16x32_bf16 v[80:83], v[196:199], a[56:59], v[80:83]
ds_read_b128 v[184:187], v252 offset:19456
v_mfma_f32_16x16x32_bf16 v[80:83], v[200:203], a[60:63], v[80:83]
v_cvt_pk_bf16_f32 v96, v72, v73
v_cvt_pk_bf16_f32 v97, v74, v75
v_mfma_f32_16x16x32_bf16 v[84:87], v[188:191], a[96:99], 0
v_mfma_f32_16x16x32_bf16 v[84:87], v[192:195], a[100:103], v[84:87]
v_mfma_f32_16x16x32_bf16 v[84:87], v[196:199], a[104:107], v[84:87]
v_mfma_f32_16x16x32_bf16 v[84:87], v[200:203], a[108:111], v[84:87]
s_waitcnt lgkmcnt(3)
v_mfma_f32_16x16x32_bf16 v[76:79], v[172:175], a[16:19], v[76:79]
ds_read_b128 v[188:191], v252 offset:20480
s_waitcnt lgkmcnt(3)
v_mfma_f32_16x16x32_bf16 v[76:79], v[176:179], a[20:23], v[76:79]
s_waitcnt lgkmcnt(2)
v_mfma_f32_16x16x32_bf16 v[76:79], v[180:183], a[24:27], v[76:79]
ds_read_b128 v[192:195], v252 offset:21504
s_waitcnt lgkmcnt(2)
v_mfma_f32_16x16x32_bf16 v[76:79], v[184:187], a[28:31], v[76:79]
v_mfma_f32_16x16x32_bf16 v[80:83], v[172:175], a[64:67], v[80:83]
ds_read_b128 v[196:199], v252 offset:22528
v_mfma_f32_16x16x32_bf16 v[80:83], v[176:179], a[68:71], v[80:83]
v_mfma_f32_16x16x32_bf16 v[80:83], v[180:183], a[72:75], v[80:83]
ds_read_b128 v[200:203], v252 offset:23552
v_mfma_f32_16x16x32_bf16 v[80:83], v[184:187], a[76:79], v[80:83]
v_mfma_f32_16x16x32_bf16 v[84:87], v[172:175], a[112:115], v[84:87]
v_mfma_f32_16x16x32_bf16 v[84:87], v[176:179], a[116:119], v[84:87]
v_mfma_f32_16x16x32_bf16 v[84:87], v[180:183], a[120:123], v[84:87]
v_mfma_f32_16x16x32_bf16 v[84:87], v[184:187], a[124:127], v[84:87]
s_waitcnt vmcnt(21) lgkmcnt(0)
s_barrier
v_add_u32 v252, 24576, v252
v_mfma_f32_16x16x32_bf16 v[76:79], v[188:191], a[32:35], v[76:79]
s_add_u32 m0, s17, 49152
s_add_u32 s24, s25, 245760
v_mfma_f32_16x16x32_bf16 v[76:79], v[192:195], a[36:39], v[76:79]
ds_read_b128 v[172:175], v252 offset:0
v_mfma_f32_16x16x32_bf16 v[76:79], v[196:199], a[40:43], v[76:79]
buffer_load_dwordx4 v251, s[12:15], s24 offen offset:0  lds
v_mfma_f32_16x16x32_bf16 v[76:79], v[200:203], a[44:47], v[76:79]
ds_read_b128 v[176:179], v252 offset:1024
v_mfma_f32_16x16x32_bf16 v[80:83], v[188:191], a[80:83], v[80:83]
v_mfma_f32_16x16x32_bf16 v[80:83], v[192:195], a[84:87], v[80:83]
ds_read_b128 v[180:183], v252 offset:2048
v_mfma_f32_16x16x32_bf16 v[80:83], v[196:199], a[88:91], v[80:83]
buffer_load_dwordx4 v251, s[12:15], s24 offen offset:1024  lds
v_mfma_f32_16x16x32_bf16 v[80:83], v[200:203], a[92:95], v[80:83]
ds_read_b128 v[184:187], v252 offset:3072
v_mfma_f32_16x16x32_bf16 v[84:87], v[188:191], a[128:131], v[84:87]
v_mfma_f32_16x16x32_bf16 v[84:87], v[192:195], a[132:135], v[84:87]
v_mfma_f32_16x16x32_bf16 v[84:87], v[196:199], a[136:139], v[84:87]
buffer_load_dwordx4 v251, s[12:15], s24 offen offset:2048  lds
v_mfma_f32_16x16x32_bf16 v[84:87], v[200:203], a[140:143], v[84:87]
v_cvt_pk_bf16_f32 v90, v76, v77
v_cvt_pk_bf16_f32 v91, v78, v79
s_waitcnt lgkmcnt(3)
v_mfma_f32_16x16x32_bf16 v[64:67], v[172:175], a[0:3], 0
ds_read_b128 v[188:191], v252 offset:4096
s_waitcnt lgkmcnt(3)
v_mfma_f32_16x16x32_bf16 v[64:67], v[176:179], a[4:7], v[64:67]
s_waitcnt lgkmcnt(2)
v_mfma_f32_16x16x32_bf16 v[64:67], v[180:183], a[8:11], v[64:67]
buffer_load_dwordx4 v251, s[12:15], s24 offen offset:3072  lds
ds_read_b128 v[192:195], v252 offset:5120
s_waitcnt lgkmcnt(2)
v_mfma_f32_16x16x32_bf16 v[64:67], v[184:187], a[12:15], v[64:67]
v_cvt_pk_bf16_f32 v94, v80, v81
v_cvt_pk_bf16_f32 v95, v82, v83
v_mfma_f32_16x16x32_bf16 v[68:71], v[172:175], a[48:51], 0
s_add_u32 m0, s17, 53248
s_add_u32 s24, s25, 249856
ds_read_b128 v[196:199], v252 offset:6144
v_mfma_f32_16x16x32_bf16 v[68:71], v[176:179], a[52:55], v[68:71]
v_mfma_f32_16x16x32_bf16 v[68:71], v[180:183], a[56:59], v[68:71]
buffer_load_dwordx4 v251, s[12:15], s24 offen offset:0  lds
ds_read_b128 v[200:203], v252 offset:7168
v_mfma_f32_16x16x32_bf16 v[68:71], v[184:187], a[60:63], v[68:71]
v_cvt_pk_bf16_f32 v98, v84, v85
v_cvt_pk_bf16_f32 v99, v86, v87
v_mfma_f32_16x16x32_bf16 v[72:75], v[172:175], a[96:99], 0
v_mfma_f32_16x16x32_bf16 v[72:75], v[176:179], a[100:103], v[72:75]
v_mfma_f32_16x16x32_bf16 v[72:75], v[180:183], a[104:107], v[72:75]
buffer_load_dwordx4 v251, s[12:15], s24 offen offset:1024  lds
v_mfma_f32_16x16x32_bf16 v[72:75], v[184:187], a[108:111], v[72:75]
v_mfma_f32_16x16x32_bf16 v[0:3], a[24:27], v[88:91], v[0:3]
buffer_store_dwordx4 v[88:91], v237, s[40:43], s28 offen sc1
s_add_u32 s28, s28, 1024
v_mfma_f32_16x16x32_bf16 v[4:7], a[72:75], v[92:95], v[4:7]
buffer_store_dwordx4 v[92:95], v237, s[40:43], s29 offen sc1
s_add_u32 s29, s29, 1024
v_mfma_f32_16x16x32_bf16 v[8:11], a[120:123], v[96:99], v[8:11]
buffer_store_dwordx4 v[96:99], v237, s[40:43], s30 offen sc1
s_add_u32 s30, s30, 1024
s_waitcnt lgkmcnt(3)
v_mfma_f32_16x16x32_bf16 v[64:67], v[188:191], a[16:19], v[64:67]
ds_read_b128 v[172:175], v252 offset:8192
s_waitcnt lgkmcnt(3)
v_mfma_f32_16x16x32_bf16 v[64:67], v[192:195], a[20:23], v[64:67]
s_waitcnt lgkmcnt(2)
v_mfma_f32_16x16x32_bf16 v[64:67], v[196:199], a[24:27], v[64:67]
ds_read_b128 v[176:179], v252 offset:9216
s_waitcnt lgkmcnt(2)
v_mfma_f32_16x16x32_bf16 v[64:67], v[200:203], a[28:31], v[64:67]
v_mfma_f32_16x16x32_bf16 v[68:71], v[188:191], a[64:67], v[68:71]
ds_read_b128 v[180:183], v252 offset:10240
v_mfma_f32_16x16x32_bf16 v[68:71], v[192:195], a[68:71], v[68:71]
v_mfma_f32_16x16x32_bf16 v[68:71], v[196:199], a[72:75], v[68:71]
ds_read_b128 v[184:187], v252 offset:11264
v_mfma_f32_16x16x32_bf16 v[68:71], v[200:203], a[76:79], v[68:71]
v_mfma_f32_16x16x32_bf16 v[72:75], v[188:191], a[112:115], v[72:75]
v_mfma_f32_16x16x32_bf16 v[72:75], v[192:195], a[116:119], v[72:75]
v_mfma_f32_16x16x32_bf16 v[72:75], v[196:199], a[120:123], v[72:75]
v_mfma_f32_16x16x32_bf16 v[72:75], v[200:203], a[124:127], v[72:75]
s_waitcnt lgkmcnt(3)
v_mfma_f32_16x16x32_bf16 v[64:67], v[172:175], a[32:35], v[64:67]
ds_read_b128 v[188:191], v252 offset:12288
s_waitcnt lgkmcnt(3)
v_mfma_f32_16x16x32_bf16 v[64:67], v[176:179], a[36:39], v[64:67]
s_waitcnt lgkmcnt(2)
v_mfma_f32_16x16x32_bf16 v[64:67], v[180:183], a[40:43], v[64:67]
ds_read_b128 v[192:195], v252 offset:13312
s_waitcnt lgkmcnt(2)
v_mfma_f32_16x16x32_bf16 v[64:67], v[184:187], a[44:47], v[64:67]
v_mfma_f32_16x16x32_bf16 v[68:71], v[172:175], a[80:83], v[68:71]
ds_read_b128 v[196:199], v252 offset:14336
v_mfma_f32_16x16x32_bf16 v[68:71], v[176:179], a[84:87], v[68:71]
v_mfma_f32_16x16x32_bf16 v[68:71], v[180:183], a[88:91], v[68:71]
ds_read_b128 v[200:203], v252 offset:15360
v_mfma_f32_16x16x32_bf16 v[68:71], v[184:187], a[92:95], v[68:71]
v_mfma_f32_16x16x32_bf16 v[72:75], v[172:175], a[128:131], v[72:75]
v_mfma_f32_16x16x32_bf16 v[72:75], v[176:179], a[132:135], v[72:75]
v_mfma_f32_16x16x32_bf16 v[72:75], v[180:183], a[136:139], v[72:75]
v_mfma_f32_16x16x32_bf16 v[72:75], v[184:187], a[140:143], v[72:75]
v_cvt_pk_bf16_f32 v88, v64, v65
v_cvt_pk_bf16_f32 v89, v66, v67
s_waitcnt lgkmcnt(3)
v_mfma_f32_16x16x32_bf16 v[76:79], v[188:191], a[0:3], 0
ds_read_b128 v[172:175], v252 offset:16384
s_waitcnt lgkmcnt(3)
v_mfma_f32_16x16x32_bf16 v[76:79], v[192:195], a[4:7], v[76:79]
s_waitcnt lgkmcnt(2)
v_mfma_f32_16x16x32_bf16 v[76:79], v[196:199], a[8:11], v[76:79]
ds_read_b128 v[176:179], v252 offset:17408
s_waitcnt lgkmcnt(2)
v_mfma_f32_16x16x32_bf16 v[76:79], v[200:203], a[12:15], v[76:79]
v_cvt_pk_bf16_f32 v92, v68, v69
v_cvt_pk_bf16_f32 v93, v70, v71
v_mfma_f32_16x16x32_bf16 v[80:83], v[188:191], a[48:51], 0
ds_read_b128 v[180:183], v252 offset:18432
v_mfma_f32_16x16x32_bf16 v[80:83], v[192:195], a[52:55], v[80:83]
v_mfma_f32_16x16x32_bf16 v[80:83], v[196:199], a[56:59], v[80:83]
ds_read_b128 v[184:187], v252 offset:19456
v_mfma_f32_16x16x32_bf16 v[80:83], v[200:203], a[60:63], v[80:83]
v_cvt_pk_bf16_f32 v96, v72, v73
v_cvt_pk_bf16_f32 v97, v74, v75
v_mfma_f32_16x16x32_bf16 v[84:87], v[188:191], a[96:99], 0
v_mfma_f32_16x16x32_bf16 v[84:87], v[192:195], a[100:103], v[84:87]
v_mfma_f32_16x16x32_bf16 v[84:87], v[196:199], a[104:107], v[84:87]
v_mfma_f32_16x16x32_bf16 v[84:87], v[200:203], a[108:111], v[84:87]
s_waitcnt lgkmcnt(3)
v_mfma_f32_16x16x32_bf16 v[76:79], v[172:175], a[16:19], v[76:79]
ds_read_b128 v[188:191], v252 offset:20480
s_waitcnt lgkmcnt(3)
v_mfma_f32_16x16x32_bf16 v[76:79], v[176:179], a[20:23], v[76:79]
s_waitcnt lgkmcnt(2)
v_mfma_f32_16x16x32_bf16 v[76:79], v[180:183], a[24:27], v[76:79]
ds_read_b128 v[192:195], v252 offset:21504
s_waitcnt lgkmcnt(2)
v_mfma_f32_16x16x32_bf16 v[76:79], v[184:187], a[28:31], v[76:79]
v_mfma_f32_16x16x32_bf16 v[80:83], v[172:175], a[64:67], v[80:83]
ds_read_b128 v[196:199], v252 offset:22528
v_mfma_f32_16x16x32_bf16 v[80:83], v[176:179], a[68:71], v[80:83]
v_mfma_f32_16x16x32_bf16 v[80:83], v[180:183], a[72:75], v[80:83]
ds_read_b128 v[200:203], v252 offset:23552
v_mfma_f32_16x16x32_bf16 v[80:83], v[184:187], a[76:79], v[80:83]
v_mfma_f32_16x16x32_bf16 v[84:87], v[172:175], a[112:115], v[84:87]
v_mfma_f32_16x16x32_bf16 v[84:87], v[176:179], a[116:119], v[84:87]
v_mfma_f32_16x16x32_bf16 v[84:87], v[180:183], a[120:123], v[84:87]
v_mfma_f32_16x16x32_bf16 v[84:87], v[184:187], a[124:127], v[84:87]
s_waitcnt vmcnt(21) lgkmcnt(0)
s_barrier
v_add_u32 v252, 4294893568, v252
v_mfma_f32_16x16x32_bf16 v[76:79], v[188:191], a[32:35], v[76:79]
s_add_u32 m0, s17, 73728
s_add_u32 s24, s25, 270336
v_mfma_f32_16x16x32_bf16 v[76:79], v[192:195], a[36:39], v[76:79]
ds_read_b128 v[172:175], v252 offset:0
v_mfma_f32_16x16x32_bf16 v[76:79], v[196:199], a[40:43], v[76:79]
buffer_load_dwordx4 v251, s[12:15], s24 offen offset:0  lds
v_mfma_f32_16x16x32_bf16 v[76:79], v[200:203], a[44:47], v[76:79]
ds_read_b128 v[176:179], v252 offset:1024
v_mfma_f32_16x16x32_bf16 v[80:83], v[188:191], a[80:83], v[80:83]
v_mfma_f32_16x16x32_bf16 v[80:83], v[192:195], a[84:87], v[80:83]
ds_read_b128 v[180:183], v252 offset:2048
v_mfma_f32_16x16x32_bf16 v[80:83], v[196:199], a[88:91], v[80:83]
buffer_load_dwordx4 v251, s[12:15], s24 offen offset:1024  lds
v_mfma_f32_16x16x32_bf16 v[80:83], v[200:203], a[92:95], v[80:83]
ds_read_b128 v[184:187], v252 offset:3072
v_mfma_f32_16x16x32_bf16 v[84:87], v[188:191], a[128:131], v[84:87]
v_mfma_f32_16x16x32_bf16 v[84:87], v[192:195], a[132:135], v[84:87]
v_mfma_f32_16x16x32_bf16 v[84:87], v[196:199], a[136:139], v[84:87]
buffer_load_dwordx4 v251, s[12:15], s24 offen offset:2048  lds
v_mfma_f32_16x16x32_bf16 v[84:87], v[200:203], a[140:143], v[84:87]
v_cvt_pk_bf16_f32 v90, v76, v77
v_cvt_pk_bf16_f32 v91, v78, v79
s_waitcnt lgkmcnt(3)
v_mfma_f32_16x16x32_bf16 v[64:67], v[172:175], a[0:3], 0
ds_read_b128 v[188:191], v252 offset:4096
s_waitcnt lgkmcnt(3)
v_mfma_f32_16x16x32_bf16 v[64:67], v[176:179], a[4:7], v[64:67]
s_waitcnt lgkmcnt(2)
v_mfma_f32_16x16x32_bf16 v[64:67], v[180:183], a[8:11], v[64:67]
buffer_load_dwordx4 v251, s[12:15], s24 offen offset:3072  lds
ds_read_b128 v[192:195], v252 offset:5120
s_waitcnt lgkmcnt(2)
v_mfma_f32_16x16x32_bf16 v[64:67], v[184:187], a[12:15], v[64:67]
v_cvt_pk_bf16_f32 v94, v80, v81
v_cvt_pk_bf16_f32 v95, v82, v83
v_mfma_f32_16x16x32_bf16 v[68:71], v[172:175], a[48:51], 0
s_add_u32 m0, s17, 77824
s_add_u32 s24, s25, 274432
ds_read_b128 v[196:199], v252 offset:6144
v_mfma_f32_16x16x32_bf16 v[68:71], v[176:179], a[52:55], v[68:71]
v_mfma_f32_16x16x32_bf16 v[68:71], v[180:183], a[56:59], v[68:71]
buffer_load_dwordx4 v251, s[12:15], s24 offen offset:0  lds
ds_read_b128 v[200:203], v252 offset:7168
v_mfma_f32_16x16x32_bf16 v[68:71], v[184:187], a[60:63], v[68:71]
v_cvt_pk_bf16_f32 v98, v84, v85
v_cvt_pk_bf16_f32 v99, v86, v87
v_mfma_f32_16x16x32_bf16 v[72:75], v[172:175], a[96:99], 0
v_mfma_f32_16x16x32_bf16 v[72:75], v[176:179], a[100:103], v[72:75]
v_mfma_f32_16x16x32_bf16 v[72:75], v[180:183], a[104:107], v[72:75]
buffer_load_dwordx4 v251, s[12:15], s24 offen offset:1024  lds
v_mfma_f32_16x16x32_bf16 v[72:75], v[184:187], a[108:111], v[72:75]
v_mfma_f32_16x16x32_bf16 v[0:3], a[28:31], v[88:91], v[0:3]
buffer_store_dwordx4 v[88:91], v237, s[40:43], s28 offen sc1
s_add_u32 s28, s28, 1024
v_mfma_f32_16x16x32_bf16 v[4:7], a[76:79], v[92:95], v[4:7]
buffer_store_dwordx4 v[92:95], v237, s[40:43], s29 offen sc1
s_add_u32 s29, s29, 1024
v_mfma_f32_16x16x32_bf16 v[8:11], a[124:127], v[96:99], v[8:11]
buffer_store_dwordx4 v[96:99], v237, s[40:43], s30 offen sc1
s_add_u32 s30, s30, 1024
s_waitcnt lgkmcnt(3)
v_mfma_f32_16x16x32_bf16 v[64:67], v[188:191], a[16:19], v[64:67]
ds_read_b128 v[172:175], v252 offset:8192
s_waitcnt lgkmcnt(3)
v_mfma_f32_16x16x32_bf16 v[64:67], v[192:195], a[20:23], v[64:67]
s_waitcnt lgkmcnt(2)
v_mfma_f32_16x16x32_bf16 v[64:67], v[196:199], a[24:27], v[64:67]
ds_read_b128 v[176:179], v252 offset:9216
s_waitcnt lgkmcnt(2)
v_mfma_f32_16x16x32_bf16 v[64:67], v[200:203], a[28:31], v[64:67]
v_mfma_f32_16x16x32_bf16 v[68:71], v[188:191], a[64:67], v[68:71]
ds_read_b128 v[180:183], v252 offset:10240
v_mfma_f32_16x16x32_bf16 v[68:71], v[192:195], a[68:71], v[68:71]
v_mfma_f32_16x16x32_bf16 v[68:71], v[196:199], a[72:75], v[68:71]
ds_read_b128 v[184:187], v252 offset:11264
v_mfma_f32_16x16x32_bf16 v[68:71], v[200:203], a[76:79], v[68:71]
v_mfma_f32_16x16x32_bf16 v[72:75], v[188:191], a[112:115], v[72:75]
v_mfma_f32_16x16x32_bf16 v[72:75], v[192:195], a[116:119], v[72:75]
v_mfma_f32_16x16x32_bf16 v[72:75], v[196:199], a[120:123], v[72:75]
v_mfma_f32_16x16x32_bf16 v[72:75], v[200:203], a[124:127], v[72:75]
s_waitcnt lgkmcnt(3)
v_mfma_f32_16x16x32_bf16 v[64:67], v[172:175], a[32:35], v[64:67]
ds_read_b128 v[188:191], v252 offset:12288
s_waitcnt lgkmcnt(3)
v_mfma_f32_16x16x32_bf16 v[64:67], v[176:179], a[36:39], v[64:67]
s_waitcnt lgkmcnt(2)
v_mfma_f32_16x16x32_bf16 v[64:67], v[180:183], a[40:43], v[64:67]
ds_read_b128 v[192:195], v252 offset:13312
s_waitcnt lgkmcnt(2)
v_mfma_f32_16x16x32_bf16 v[64:67], v[184:187], a[44:47], v[64:67]
v_mfma_f32_16x16x32_bf16 v[68:71], v[172:175], a[80:83], v[68:71]
ds_read_b128 v[196:199], v252 offset:14336
v_mfma_f32_16x16x32_bf16 v[68:71], v[176:179], a[84:87], v[68:71]
v_mfma_f32_16x16x32_bf16 v[68:71], v[180:183], a[88:91], v[68:71]
ds_read_b128 v[200:203], v252 offset:15360
v_mfma_f32_16x16x32_bf16 v[68:71], v[184:187], a[92:95], v[68:71]
v_mfma_f32_16x16x32_bf16 v[72:75], v[172:175], a[128:131], v[72:75]
v_mfma_f32_16x16x32_bf16 v[72:75], v[176:179], a[132:135], v[72:75]
v_mfma_f32_16x16x32_bf16 v[72:75], v[180:183], a[136:139], v[72:75]
v_mfma_f32_16x16x32_bf16 v[72:75], v[184:187], a[140:143], v[72:75]
v_cvt_pk_bf16_f32 v88, v64, v65
v_cvt_pk_bf16_f32 v89, v66, v67
s_waitcnt lgkmcnt(3)
v_mfma_f32_16x16x32_bf16 v[76:79], v[188:191], a[0:3], 0
ds_read_b128 v[172:175], v252 offset:16384
s_waitcnt lgkmcnt(3)
v_mfma_f32_16x16x32_bf16 v[76:79], v[192:195], a[4:7], v[76:79]
s_waitcnt lgkmcnt(2)
v_mfma_f32_16x16x32_bf16 v[76:79], v[196:199], a[8:11], v[76:79]
ds_read_b128 v[176:179], v252 offset:17408
s_waitcnt lgkmcnt(2)
v_mfma_f32_16x16x32_bf16 v[76:79], v[200:203], a[12:15], v[76:79]
v_cvt_pk_bf16_f32 v92, v68, v69
v_cvt_pk_bf16_f32 v93, v70, v71
v_mfma_f32_16x16x32_bf16 v[80:83], v[188:191], a[48:51], 0
ds_read_b128 v[180:183], v252 offset:18432
v_mfma_f32_16x16x32_bf16 v[80:83], v[192:195], a[52:55], v[80:83]
v_mfma_f32_16x16x32_bf16 v[80:83], v[196:199], a[56:59], v[80:83]
ds_read_b128 v[184:187], v252 offset:19456
v_mfma_f32_16x16x32_bf16 v[80:83], v[200:203], a[60:63], v[80:83]
v_cvt_pk_bf16_f32 v96, v72, v73
v_cvt_pk_bf16_f32 v97, v74, v75
v_mfma_f32_16x16x32_bf16 v[84:87], v[188:191], a[96:99], 0
v_mfma_f32_16x16x32_bf16 v[84:87], v[192:195], a[100:103], v[84:87]
v_mfma_f32_16x16x32_bf16 v[84:87], v[196:199], a[104:107], v[84:87]
v_mfma_f32_16x16x32_bf16 v[84:87], v[200:203], a[108:111], v[84:87]
s_waitcnt lgkmcnt(3)
v_mfma_f32_16x16x32_bf16 v[76:79], v[172:175], a[16:19], v[76:79]
ds_read_b128 v[188:191], v252 offset:20480
s_waitcnt lgkmcnt(3)
v_mfma_f32_16x16x32_bf16 v[76:79], v[176:179], a[20:23], v[76:79]
s_waitcnt lgkmcnt(2)
v_mfma_f32_16x16x32_bf16 v[76:79], v[180:183], a[24:27], v[76:79]
ds_read_b128 v[192:195], v252 offset:21504
s_waitcnt lgkmcnt(2)
v_mfma_f32_16x16x32_bf16 v[76:79], v[184:187], a[28:31], v[76:79]
v_mfma_f32_16x16x32_bf16 v[80:83], v[172:175], a[64:67], v[80:83]
ds_read_b128 v[196:199], v252 offset:22528
v_mfma_f32_16x16x32_bf16 v[80:83], v[176:179], a[68:71], v[80:83]
v_mfma_f32_16x16x32_bf16 v[80:83], v[180:183], a[72:75], v[80:83]
ds_read_b128 v[200:203], v252 offset:23552
v_mfma_f32_16x16x32_bf16 v[80:83], v[184:187], a[76:79], v[80:83]
v_mfma_f32_16x16x32_bf16 v[84:87], v[172:175], a[112:115], v[84:87]
v_mfma_f32_16x16x32_bf16 v[84:87], v[176:179], a[116:119], v[84:87]
v_mfma_f32_16x16x32_bf16 v[84:87], v[180:183], a[120:123], v[84:87]
v_mfma_f32_16x16x32_bf16 v[84:87], v[184:187], a[124:127], v[84:87]
s_waitcnt vmcnt(21) lgkmcnt(0)
s_barrier
v_add_u32 v252, 24576, v252
v_mfma_f32_16x16x32_bf16 v[76:79], v[188:191], a[32:35], v[76:79]
s_add_u32 m0, s17, 0
s_add_u32 s24, s25, 0
v_mfma_f32_16x16x32_bf16 v[76:79], v[192:195], a[36:39], v[76:79]
ds_read_b128 v[172:175], v252 offset:0
v_mfma_f32_16x16x32_bf16 v[76:79], v[196:199], a[40:43], v[76:79]
buffer_load_dwordx4 v251, s[12:15], s24 offen offset:0  lds
v_mfma_f32_16x16x32_bf16 v[76:79], v[200:203], a[44:47], v[76:79]
ds_read_b128 v[176:179], v252 offset:1024
v_mfma_f32_16x16x32_bf16 v[80:83], v[188:191], a[80:83], v[80:83]
v_mfma_f32_16x16x32_bf16 v[80:83], v[192:195], a[84:87], v[80:83]
ds_read_b128 v[180:183], v252 offset:2048
v_mfma_f32_16x16x32_bf16 v[80:83], v[196:199], a[88:91], v[80:83]
buffer_load_dwordx4 v251, s[12:15], s24 offen offset:1024  lds
v_mfma_f32_16x16x32_bf16 v[80:83], v[200:203], a[92:95], v[80:83]
ds_read_b128 v[184:187], v252 offset:3072
v_mfma_f32_16x16x32_bf16 v[84:87], v[188:191], a[128:131], v[84:87]
v_mfma_f32_16x16x32_bf16 v[84:87], v[192:195], a[132:135], v[84:87]
v_mfma_f32_16x16x32_bf16 v[84:87], v[196:199], a[136:139], v[84:87]
buffer_load_dwordx4 v251, s[12:15], s24 offen offset:2048  lds
v_mfma_f32_16x16x32_bf16 v[84:87], v[200:203], a[140:143], v[84:87]
v_cvt_pk_bf16_f32 v90, v76, v77
v_cvt_pk_bf16_f32 v91, v78, v79
s_waitcnt lgkmcnt(3)
v_mfma_f32_16x16x32_bf16 v[64:67], v[172:175], a[0:3], 0
ds_read_b128 v[188:191], v252 offset:4096
s_waitcnt lgkmcnt(3)
v_mfma_f32_16x16x32_bf16 v[64:67], v[176:179], a[4:7], v[64:67]
s_waitcnt lgkmcnt(2)
v_mfma_f32_16x16x32_bf16 v[64:67], v[180:183], a[8:11], v[64:67]
buffer_load_dwordx4 v251, s[12:15], s24 offen offset:3072  lds
ds_read_b128 v[192:195], v252 offset:5120
s_waitcnt lgkmcnt(2)
v_mfma_f32_16x16x32_bf16 v[64:67], v[184:187], a[12:15], v[64:67]
v_cvt_pk_bf16_f32 v94, v80, v81
v_cvt_pk_bf16_f32 v95, v82, v83
v_mfma_f32_16x16x32_bf16 v[68:71], v[172:175], a[48:51], 0
s_add_u32 m0, s17, 4096
s_add_u32 s24, s25, 4096
ds_read_b128 v[196:199], v252 offset:6144
v_mfma_f32_16x16x32_bf16 v[68:71], v[176:179], a[52:55], v[68:71]
v_mfma_f32_16x16x32_bf16 v[68:71], v[180:183], a[56:59], v[68:71]
buffer_load_dwordx4 v251, s[12:15], s24 offen offset:0  lds
ds_read_b128 v[200:203], v252 offset:7168
v_mfma_f32_16x16x32_bf16 v[68:71], v[184:187], a[60:63], v[68:71]
v_cvt_pk_bf16_f32 v98, v84, v85
v_cvt_pk_bf16_f32 v99, v86, v87
v_mfma_f32_16x16x32_bf16 v[72:75], v[172:175], a[96:99], 0
v_mfma_f32_16x16x32_bf16 v[72:75], v[176:179], a[100:103], v[72:75]
v_mfma_f32_16x16x32_bf16 v[72:75], v[180:183], a[104:107], v[72:75]
buffer_load_dwordx4 v251, s[12:15], s24 offen offset:1024  lds
v_mfma_f32_16x16x32_bf16 v[72:75], v[184:187], a[108:111], v[72:75]
v_mfma_f32_16x16x32_bf16 v[0:3], a[32:35], v[88:91], v[0:3]
buffer_store_dwordx4 v[88:91], v237, s[40:43], s28 offen sc1
s_add_u32 s28, s28, 1024
v_mfma_f32_16x16x32_bf16 v[4:7], a[80:83], v[92:95], v[4:7]
buffer_store_dwordx4 v[92:95], v237, s[40:43], s29 offen sc1
s_add_u32 s29, s29, 1024
v_mfma_f32_16x16x32_bf16 v[8:11], a[128:131], v[96:99], v[8:11]
buffer_store_dwordx4 v[96:99], v237, s[40:43], s30 offen sc1
s_add_u32 s30, s30, 1024
s_waitcnt lgkmcnt(3)
v_mfma_f32_16x16x32_bf16 v[64:67], v[188:191], a[16:19], v[64:67]
ds_read_b128 v[172:175], v252 offset:8192
s_waitcnt lgkmcnt(3)
v_mfma_f32_16x16x32_bf16 v[64:67], v[192:195], a[20:23], v[64:67]
s_waitcnt lgkmcnt(2)
v_mfma_f32_16x16x32_bf16 v[64:67], v[196:199], a[24:27], v[64:67]
ds_read_b128 v[176:179], v252 offset:9216
s_waitcnt lgkmcnt(2)
v_mfma_f32_16x16x32_bf16 v[64:67], v[200:203], a[28:31], v[64:67]
v_mfma_f32_16x16x32_bf16 v[68:71], v[188:191], a[64:67], v[68:71]
ds_read_b128 v[180:183], v252 offset:10240
v_mfma_f32_16x16x32_bf16 v[68:71], v[192:195], a[68:71], v[68:71]
v_mfma_f32_16x16x32_bf16 v[68:71], v[196:199], a[72:75], v[68:71]
ds_read_b128 v[184:187], v252 offset:11264
v_mfma_f32_16x16x32_bf16 v[68:71], v[200:203], a[76:79], v[68:71]
v_mfma_f32_16x16x32_bf16 v[72:75], v[188:191], a[112:115], v[72:75]
v_mfma_f32_16x16x32_bf16 v[72:75], v[192:195], a[116:119], v[72:75]
v_mfma_f32_16x16x32_bf16 v[72:75], v[196:199], a[120:123], v[72:75]
v_mfma_f32_16x16x32_bf16 v[72:75], v[200:203], a[124:127], v[72:75]
s_waitcnt lgkmcnt(3)
v_mfma_f32_16x16x32_bf16 v[64:67], v[172:175], a[32:35], v[64:67]
ds_read_b128 v[188:191], v252 offset:12288
s_waitcnt lgkmcnt(3)
v_mfma_f32_16x16x32_bf16 v[64:67], v[176:179], a[36:39], v[64:67]
s_waitcnt lgkmcnt(2)
v_mfma_f32_16x16x32_bf16 v[64:67], v[180:183], a[40:43], v[64:67]
ds_read_b128 v[192:195], v252 offset:13312
s_waitcnt lgkmcnt(2)
v_mfma_f32_16x16x32_bf16 v[64:67], v[184:187], a[44:47], v[64:67]
v_mfma_f32_16x16x32_bf16 v[68:71], v[172:175], a[80:83], v[68:71]
ds_read_b128 v[196:199], v252 offset:14336
v_mfma_f32_16x16x32_bf16 v[68:71], v[176:179], a[84:87], v[68:71]
v_mfma_f32_16x16x32_bf16 v[68:71], v[180:183], a[88:91], v[68:71]
ds_read_b128 v[200:203], v252 offset:15360
v_mfma_f32_16x16x32_bf16 v[68:71], v[184:187], a[92:95], v[68:71]
v_mfma_f32_16x16x32_bf16 v[72:75], v[172:175], a[128:131], v[72:75]
v_mfma_f32_16x16x32_bf16 v[72:75], v[176:179], a[132:135], v[72:75]
v_mfma_f32_16x16x32_bf16 v[72:75], v[180:183], a[136:139], v[72:75]
v_mfma_f32_16x16x32_bf16 v[72:75], v[184:187], a[140:143], v[72:75]
v_cvt_pk_bf16_f32 v88, v64, v65
v_cvt_pk_bf16_f32 v89, v66, v67
s_waitcnt lgkmcnt(3)
v_mfma_f32_16x16x32_bf16 v[76:79], v[188:191], a[0:3], 0
ds_read_b128 v[172:175], v252 offset:16384
s_waitcnt lgkmcnt(3)
v_mfma_f32_16x16x32_bf16 v[76:79], v[192:195], a[4:7], v[76:79]
s_waitcnt lgkmcnt(2)
v_mfma_f32_16x16x32_bf16 v[76:79], v[196:199], a[8:11], v[76:79]
ds_read_b128 v[176:179], v252 offset:17408
s_waitcnt lgkmcnt(2)
v_mfma_f32_16x16x32_bf16 v[76:79], v[200:203], a[12:15], v[76:79]
v_cvt_pk_bf16_f32 v92, v68, v69
v_cvt_pk_bf16_f32 v93, v70, v71
v_mfma_f32_16x16x32_bf16 v[80:83], v[188:191], a[48:51], 0
ds_read_b128 v[180:183], v252 offset:18432
v_mfma_f32_16x16x32_bf16 v[80:83], v[192:195], a[52:55], v[80:83]
v_mfma_f32_16x16x32_bf16 v[80:83], v[196:199], a[56:59], v[80:83]
ds_read_b128 v[184:187], v252 offset:19456
v_mfma_f32_16x16x32_bf16 v[80:83], v[200:203], a[60:63], v[80:83]
v_cvt_pk_bf16_f32 v96, v72, v73
v_cvt_pk_bf16_f32 v97, v74, v75
v_mfma_f32_16x16x32_bf16 v[84:87], v[188:191], a[96:99], 0
v_mfma_f32_16x16x32_bf16 v[84:87], v[192:195], a[100:103], v[84:87]
v_mfma_f32_16x16x32_bf16 v[84:87], v[196:199], a[104:107], v[84:87]
v_mfma_f32_16x16x32_bf16 v[84:87], v[200:203], a[108:111], v[84:87]
s_waitcnt lgkmcnt(3)
v_mfma_f32_16x16x32_bf16 v[76:79], v[172:175], a[16:19], v[76:79]
ds_read_b128 v[188:191], v252 offset:20480
s_waitcnt lgkmcnt(3)
v_mfma_f32_16x16x32_bf16 v[76:79], v[176:179], a[20:23], v[76:79]
s_waitcnt lgkmcnt(2)
v_mfma_f32_16x16x32_bf16 v[76:79], v[180:183], a[24:27], v[76:79]
ds_read_b128 v[192:195], v252 offset:21504
s_waitcnt lgkmcnt(2)
v_mfma_f32_16x16x32_bf16 v[76:79], v[184:187], a[28:31], v[76:79]
v_mfma_f32_16x16x32_bf16 v[80:83], v[172:175], a[64:67], v[80:83]
ds_read_b128 v[196:199], v252 offset:22528
v_mfma_f32_16x16x32_bf16 v[80:83], v[176:179], a[68:71], v[80:83]
v_mfma_f32_16x16x32_bf16 v[80:83], v[180:183], a[72:75], v[80:83]
ds_read_b128 v[200:203], v252 offset:23552
v_mfma_f32_16x16x32_bf16 v[80:83], v[184:187], a[76:79], v[80:83]
v_mfma_f32_16x16x32_bf16 v[84:87], v[172:175], a[112:115], v[84:87]
v_mfma_f32_16x16x32_bf16 v[84:87], v[176:179], a[116:119], v[84:87]
v_mfma_f32_16x16x32_bf16 v[84:87], v[180:183], a[120:123], v[84:87]
v_mfma_f32_16x16x32_bf16 v[84:87], v[184:187], a[124:127], v[84:87]
s_waitcnt vmcnt(21) lgkmcnt(0)
s_barrier
v_add_u32 v252, 24576, v252
v_mfma_f32_16x16x32_bf16 v[76:79], v[188:191], a[32:35], v[76:79]
s_add_u32 m0, s17, 24576
s_add_u32 s24, s25, 24576
v_mfma_f32_16x16x32_bf16 v[76:79], v[192:195], a[36:39], v[76:79]
ds_read_b128 v[172:175], v252 offset:0
v_mfma_f32_16x16x32_bf16 v[76:79], v[196:199], a[40:43], v[76:79]
buffer_load_dwordx4 v251, s[12:15], s24 offen offset:0  lds
v_mfma_f32_16x16x32_bf16 v[76:79], v[200:203], a[44:47], v[76:79]
ds_read_b128 v[176:179], v252 offset:1024
v_mfma_f32_16x16x32_bf16 v[80:83], v[188:191], a[80:83], v[80:83]
v_mfma_f32_16x16x32_bf16 v[80:83], v[192:195], a[84:87], v[80:83]
ds_read_b128 v[180:183], v252 offset:2048
v_mfma_f32_16x16x32_bf16 v[80:83], v[196:199], a[88:91], v[80:83]
buffer_load_dwordx4 v251, s[12:15], s24 offen offset:1024  lds
v_mfma_f32_16x16x32_bf16 v[80:83], v[200:203], a[92:95], v[80:83]
ds_read_b128 v[184:187], v252 offset:3072
v_mfma_f32_16x16x32_bf16 v[84:87], v[188:191], a[128:131], v[84:87]
v_mfma_f32_16x16x32_bf16 v[84:87], v[192:195], a[132:135], v[84:87]
v_mfma_f32_16x16x32_bf16 v[84:87], v[196:199], a[136:139], v[84:87]
buffer_load_dwordx4 v251, s[12:15], s24 offen offset:2048  lds
v_mfma_f32_16x16x32_bf16 v[84:87], v[200:203], a[140:143], v[84:87]
v_cvt_pk_bf16_f32 v90, v76, v77
v_cvt_pk_bf16_f32 v91, v78, v79
s_waitcnt lgkmcnt(3)
v_mfma_f32_16x16x32_bf16 v[64:67], v[172:175], a[0:3], 0
ds_read_b128 v[188:191], v252 offset:4096
s_waitcnt lgkmcnt(3)
v_mfma_f32_16x16x32_bf16 v[64:67], v[176:179], a[4:7], v[64:67]
s_waitcnt lgkmcnt(2)
v_mfma_f32_16x16x32_bf16 v[64:67], v[180:183], a[8:11], v[64:67]
buffer_load_dwordx4 v251, s[12:15], s24 offen offset:3072  lds
ds_read_b128 v[192:195], v252 offset:5120
s_waitcnt lgkmcnt(2)
v_mfma_f32_16x16x32_bf16 v[64:67], v[184:187], a[12:15], v[64:67]
v_cvt_pk_bf16_f32 v94, v80, v81
v_cvt_pk_bf16_f32 v95, v82, v83
v_mfma_f32_16x16x32_bf16 v[68:71], v[172:175], a[48:51], 0
s_add_u32 m0, s17, 28672
s_add_u32 s24, s25, 28672
ds_read_b128 v[196:199], v252 offset:6144
v_mfma_f32_16x16x32_bf16 v[68:71], v[176:179], a[52:55], v[68:71]
v_mfma_f32_16x16x32_bf16 v[68:71], v[180:183], a[56:59], v[68:71]
buffer_load_dwordx4 v251, s[12:15], s24 offen offset:0  lds
ds_read_b128 v[200:203], v252 offset:7168
v_mfma_f32_16x16x32_bf16 v[68:71], v[184:187], a[60:63], v[68:71]
v_cvt_pk_bf16_f32 v98, v84, v85
v_cvt_pk_bf16_f32 v99, v86, v87
v_mfma_f32_16x16x32_bf16 v[72:75], v[172:175], a[96:99], 0
v_mfma_f32_16x16x32_bf16 v[72:75], v[176:179], a[100:103], v[72:75]
v_mfma_f32_16x16x32_bf16 v[72:75], v[180:183], a[104:107], v[72:75]
buffer_load_dwordx4 v251, s[12:15], s24 offen offset:1024  lds
v_mfma_f32_16x16x32_bf16 v[72:75], v[184:187], a[108:111], v[72:75]
v_mfma_f32_16x16x32_bf16 v[0:3], a[36:39], v[88:91], v[0:3]
buffer_store_dwordx4 v[88:91], v237, s[40:43], s28 offen sc1
s_add_u32 s28, s28, 1024
v_mfma_f32_16x16x32_bf16 v[4:7], a[84:87], v[92:95], v[4:7]
buffer_store_dwordx4 v[92:95], v237, s[40:43], s29 offen sc1
s_add_u32 s29, s29, 1024
v_mfma_f32_16x16x32_bf16 v[8:11], a[132:135], v[96:99], v[8:11]
buffer_store_dwordx4 v[96:99], v237, s[40:43], s30 offen sc1
s_add_u32 s30, s30, 1024
s_waitcnt lgkmcnt(3)
v_mfma_f32_16x16x32_bf16 v[64:67], v[188:191], a[16:19], v[64:67]
ds_read_b128 v[172:175], v252 offset:8192
s_waitcnt lgkmcnt(3)
v_mfma_f32_16x16x32_bf16 v[64:67], v[192:195], a[20:23], v[64:67]
s_waitcnt lgkmcnt(2)
v_mfma_f32_16x16x32_bf16 v[64:67], v[196:199], a[24:27], v[64:67]
ds_read_b128 v[176:179], v252 offset:9216
s_waitcnt lgkmcnt(2)
v_mfma_f32_16x16x32_bf16 v[64:67], v[200:203], a[28:31], v[64:67]
v_mfma_f32_16x16x32_bf16 v[68:71], v[188:191], a[64:67], v[68:71]
ds_read_b128 v[180:183], v252 offset:10240
v_mfma_f32_16x16x32_bf16 v[68:71], v[192:195], a[68:71], v[68:71]
v_mfma_f32_16x16x32_bf16 v[68:71], v[196:199], a[72:75], v[68:71]
ds_read_b128 v[184:187], v252 offset:11264
v_mfma_f32_16x16x32_bf16 v[68:71], v[200:203], a[76:79], v[68:71]
v_mfma_f32_16x16x32_bf16 v[72:75], v[188:191], a[112:115], v[72:75]
v_mfma_f32_16x16x32_bf16 v[72:75], v[192:195], a[116:119], v[72:75]
v_mfma_f32_16x16x32_bf16 v[72:75], v[196:199], a[120:123], v[72:75]
v_mfma_f32_16x16x32_bf16 v[72:75], v[200:203], a[124:127], v[72:75]
s_waitcnt lgkmcnt(3)
v_mfma_f32_16x16x32_bf16 v[64:67], v[172:175], a[32:35], v[64:67]
ds_read_b128 v[188:191], v252 offset:12288
s_waitcnt lgkmcnt(3)
v_mfma_f32_16x16x32_bf16 v[64:67], v[176:179], a[36:39], v[64:67]
s_waitcnt lgkmcnt(2)
v_mfma_f32_16x16x32_bf16 v[64:67], v[180:183], a[40:43], v[64:67]
ds_read_b128 v[192:195], v252 offset:13312
s_waitcnt lgkmcnt(2)
v_mfma_f32_16x16x32_bf16 v[64:67], v[184:187], a[44:47], v[64:67]
v_mfma_f32_16x16x32_bf16 v[68:71], v[172:175], a[80:83], v[68:71]
ds_read_b128 v[196:199], v252 offset:14336
v_mfma_f32_16x16x32_bf16 v[68:71], v[176:179], a[84:87], v[68:71]
v_mfma_f32_16x16x32_bf16 v[68:71], v[180:183], a[88:91], v[68:71]
ds_read_b128 v[200:203], v252 offset:15360
v_mfma_f32_16x16x32_bf16 v[68:71], v[184:187], a[92:95], v[68:71]
v_mfma_f32_16x16x32_bf16 v[72:75], v[172:175], a[128:131], v[72:75]
v_mfma_f32_16x16x32_bf16 v[72:75], v[176:179], a[132:135], v[72:75]
v_mfma_f32_16x16x32_bf16 v[72:75], v[180:183], a[136:139], v[72:75]
v_mfma_f32_16x16x32_bf16 v[72:75], v[184:187], a[140:143], v[72:75]
v_cvt_pk_bf16_f32 v88, v64, v65
v_cvt_pk_bf16_f32 v89, v66, v67
s_waitcnt lgkmcnt(3)
v_mfma_f32_16x16x32_bf16 v[76:79], v[188:191], a[0:3], 0
ds_read_b128 v[172:175], v252 offset:16384
s_waitcnt lgkmcnt(3)
v_mfma_f32_16x16x32_bf16 v[76:79], v[192:195], a[4:7], v[76:79]
s_waitcnt lgkmcnt(2)
v_mfma_f32_16x16x32_bf16 v[76:79], v[196:199], a[8:11], v[76:79]
ds_read_b128 v[176:179], v252 offset:17408
s_waitcnt lgkmcnt(2)
v_mfma_f32_16x16x32_bf16 v[76:79], v[200:203], a[12:15], v[76:79]
v_cvt_pk_bf16_f32 v92, v68, v69
v_cvt_pk_bf16_f32 v93, v70, v71
v_mfma_f32_16x16x32_bf16 v[80:83], v[188:191], a[48:51], 0
ds_read_b128 v[180:183], v252 offset:18432
v_mfma_f32_16x16x32_bf16 v[80:83], v[192:195], a[52:55], v[80:83]
v_mfma_f32_16x16x32_bf16 v[80:83], v[196:199], a[56:59], v[80:83]
ds_read_b128 v[184:187], v252 offset:19456
v_mfma_f32_16x16x32_bf16 v[80:83], v[200:203], a[60:63], v[80:83]
v_cvt_pk_bf16_f32 v96, v72, v73
v_cvt_pk_bf16_f32 v97, v74, v75
v_mfma_f32_16x16x32_bf16 v[84:87], v[188:191], a[96:99], 0
v_mfma_f32_16x16x32_bf16 v[84:87], v[192:195], a[100:103], v[84:87]
v_mfma_f32_16x16x32_bf16 v[84:87], v[196:199], a[104:107], v[84:87]
v_mfma_f32_16x16x32_bf16 v[84:87], v[200:203], a[108:111], v[84:87]
s_waitcnt lgkmcnt(3)
v_mfma_f32_16x16x32_bf16 v[76:79], v[172:175], a[16:19], v[76:79]
ds_read_b128 v[188:191], v252 offset:20480
s_waitcnt lgkmcnt(3)
v_mfma_f32_16x16x32_bf16 v[76:79], v[176:179], a[20:23], v[76:79]
s_waitcnt lgkmcnt(2)
v_mfma_f32_16x16x32_bf16 v[76:79], v[180:183], a[24:27], v[76:79]
ds_read_b128 v[192:195], v252 offset:21504
s_waitcnt lgkmcnt(2)
v_mfma_f32_16x16x32_bf16 v[76:79], v[184:187], a[28:31], v[76:79]
v_mfma_f32_16x16x32_bf16 v[80:83], v[172:175], a[64:67], v[80:83]
ds_read_b128 v[196:199], v252 offset:22528
v_mfma_f32_16x16x32_bf16 v[80:83], v[176:179], a[68:71], v[80:83]
v_mfma_f32_16x16x32_bf16 v[80:83], v[180:183], a[72:75], v[80:83]
ds_read_b128 v[200:203], v252 offset:23552
v_mfma_f32_16x16x32_bf16 v[80:83], v[184:187], a[76:79], v[80:83]
v_mfma_f32_16x16x32_bf16 v[84:87], v[172:175], a[112:115], v[84:87]
v_mfma_f32_16x16x32_bf16 v[84:87], v[176:179], a[116:119], v[84:87]
v_mfma_f32_16x16x32_bf16 v[84:87], v[180:183], a[120:123], v[84:87]
v_mfma_f32_16x16x32_bf16 v[84:87], v[184:187], a[124:127], v[84:87]
s_waitcnt vmcnt(21) lgkmcnt(0)
s_barrier
v_add_u32 v252, 24576, v252
v_mfma_f32_16x16x32_bf16 v[76:79], v[188:191], a[32:35], v[76:79]
s_add_u32 m0, s17, 49152
s_add_u32 s24, s25, 49152
v_mfma_f32_16x16x32_bf16 v[76:79], v[192:195], a[36:39], v[76:79]
ds_read_b128 v[172:175], v252 offset:0
v_mfma_f32_16x16x32_bf16 v[76:79], v[196:199], a[40:43], v[76:79]
buffer_load_dwordx4 v251, s[12:15], s24 offen offset:0  lds
v_mfma_f32_16x16x32_bf16 v[76:79], v[200:203], a[44:47], v[76:79]
ds_read_b128 v[176:179], v252 offset:1024
v_mfma_f32_16x16x32_bf16 v[80:83], v[188:191], a[80:83], v[80:83]
v_mfma_f32_16x16x32_bf16 v[80:83], v[192:195], a[84:87], v[80:83]
ds_read_b128 v[180:183], v252 offset:2048
v_mfma_f32_16x16x32_bf16 v[80:83], v[196:199], a[88:91], v[80:83]
buffer_load_dwordx4 v251, s[12:15], s24 offen offset:1024  lds
v_mfma_f32_16x16x32_bf16 v[80:83], v[200:203], a[92:95], v[80:83]
ds_read_b128 v[184:187], v252 offset:3072
v_mfma_f32_16x16x32_bf16 v[84:87], v[188:191], a[128:131], v[84:87]
v_mfma_f32_16x16x32_bf16 v[84:87], v[192:195], a[132:135], v[84:87]
v_mfma_f32_16x16x32_bf16 v[84:87], v[196:199], a[136:139], v[84:87]
buffer_load_dwordx4 v251, s[12:15], s24 offen offset:2048  lds
v_mfma_f32_16x16x32_bf16 v[84:87], v[200:203], a[140:143], v[84:87]
v_cvt_pk_bf16_f32 v90, v76, v77
v_cvt_pk_bf16_f32 v91, v78, v79
s_waitcnt lgkmcnt(3)
v_mfma_f32_16x16x32_bf16 v[64:67], v[172:175], a[0:3], 0
ds_read_b128 v[188:191], v252 offset:4096
s_waitcnt lgkmcnt(3)
v_mfma_f32_16x16x32_bf16 v[64:67], v[176:179], a[4:7], v[64:67]
s_waitcnt lgkmcnt(2)
v_mfma_f32_16x16x32_bf16 v[64:67], v[180:183], a[8:11], v[64:67]
buffer_load_dwordx4 v251, s[12:15], s24 offen offset:3072  lds
ds_read_b128 v[192:195], v252 offset:5120
s_waitcnt lgkmcnt(2)
v_mfma_f32_16x16x32_bf16 v[64:67], v[184:187], a[12:15], v[64:67]
v_cvt_pk_bf16_f32 v94, v80, v81
v_cvt_pk_bf16_f32 v95, v82, v83
v_mfma_f32_16x16x32_bf16 v[68:71], v[172:175], a[48:51], 0
s_add_u32 m0, s17, 53248
s_add_u32 s24, s25, 53248
ds_read_b128 v[196:199], v252 offset:6144
v_mfma_f32_16x16x32_bf16 v[68:71], v[176:179], a[52:55], v[68:71]
v_mfma_f32_16x16x32_bf16 v[68:71], v[180:183], a[56:59], v[68:71]
buffer_load_dwordx4 v251, s[12:15], s24 offen offset:0  lds
ds_read_b128 v[200:203], v252 offset:7168
v_mfma_f32_16x16x32_bf16 v[68:71], v[184:187], a[60:63], v[68:71]
v_cvt_pk_bf16_f32 v98, v84, v85
v_cvt_pk_bf16_f32 v99, v86, v87
v_mfma_f32_16x16x32_bf16 v[72:75], v[172:175], a[96:99], 0
v_mfma_f32_16x16x32_bf16 v[72:75], v[176:179], a[100:103], v[72:75]
v_mfma_f32_16x16x32_bf16 v[72:75], v[180:183], a[104:107], v[72:75]
buffer_load_dwordx4 v251, s[12:15], s24 offen offset:1024  lds
v_mfma_f32_16x16x32_bf16 v[72:75], v[184:187], a[108:111], v[72:75]
v_mfma_f32_16x16x32_bf16 v[0:3], a[40:43], v[88:91], v[0:3]
buffer_store_dwordx4 v[88:91], v237, s[40:43], s28 offen sc1
s_add_u32 s28, s28, 1024
v_mfma_f32_16x16x32_bf16 v[4:7], a[88:91], v[92:95], v[4:7]
buffer_store_dwordx4 v[92:95], v237, s[40:43], s29 offen sc1
s_add_u32 s29, s29, 1024
v_mfma_f32_16x16x32_bf16 v[8:11], a[136:139], v[96:99], v[8:11]
buffer_store_dwordx4 v[96:99], v237, s[40:43], s30 offen sc1
s_add_u32 s30, s30, 1024
s_waitcnt lgkmcnt(3)
v_mfma_f32_16x16x32_bf16 v[64:67], v[188:191], a[16:19], v[64:67]
ds_read_b128 v[172:175], v252 offset:8192
s_waitcnt lgkmcnt(3)
v_mfma_f32_16x16x32_bf16 v[64:67], v[192:195], a[20:23], v[64:67]
s_waitcnt lgkmcnt(2)
v_mfma_f32_16x16x32_bf16 v[64:67], v[196:199], a[24:27], v[64:67]
ds_read_b128 v[176:179], v252 offset:9216
s_waitcnt lgkmcnt(2)
v_mfma_f32_16x16x32_bf16 v[64:67], v[200:203], a[28:31], v[64:67]
v_mfma_f32_16x16x32_bf16 v[68:71], v[188:191], a[64:67], v[68:71]
ds_read_b128 v[180:183], v252 offset:10240
v_mfma_f32_16x16x32_bf16 v[68:71], v[192:195], a[68:71], v[68:71]
v_mfma_f32_16x16x32_bf16 v[68:71], v[196:199], a[72:75], v[68:71]
ds_read_b128 v[184:187], v252 offset:11264
v_mfma_f32_16x16x32_bf16 v[68:71], v[200:203], a[76:79], v[68:71]
v_mfma_f32_16x16x32_bf16 v[72:75], v[188:191], a[112:115], v[72:75]
v_mfma_f32_16x16x32_bf16 v[72:75], v[192:195], a[116:119], v[72:75]
v_mfma_f32_16x16x32_bf16 v[72:75], v[196:199], a[120:123], v[72:75]
v_mfma_f32_16x16x32_bf16 v[72:75], v[200:203], a[124:127], v[72:75]
s_waitcnt lgkmcnt(3)
v_mfma_f32_16x16x32_bf16 v[64:67], v[172:175], a[32:35], v[64:67]
ds_read_b128 v[188:191], v252 offset:12288
s_waitcnt lgkmcnt(3)
v_mfma_f32_16x16x32_bf16 v[64:67], v[176:179], a[36:39], v[64:67]
s_waitcnt lgkmcnt(2)
v_mfma_f32_16x16x32_bf16 v[64:67], v[180:183], a[40:43], v[64:67]
ds_read_b128 v[192:195], v252 offset:13312
s_waitcnt lgkmcnt(2)
v_mfma_f32_16x16x32_bf16 v[64:67], v[184:187], a[44:47], v[64:67]
v_mfma_f32_16x16x32_bf16 v[68:71], v[172:175], a[80:83], v[68:71]
ds_read_b128 v[196:199], v252 offset:14336
v_mfma_f32_16x16x32_bf16 v[68:71], v[176:179], a[84:87], v[68:71]
v_mfma_f32_16x16x32_bf16 v[68:71], v[180:183], a[88:91], v[68:71]
ds_read_b128 v[200:203], v252 offset:15360
v_mfma_f32_16x16x32_bf16 v[68:71], v[184:187], a[92:95], v[68:71]
v_mfma_f32_16x16x32_bf16 v[72:75], v[172:175], a[128:131], v[72:75]
v_mfma_f32_16x16x32_bf16 v[72:75], v[176:179], a[132:135], v[72:75]
v_mfma_f32_16x16x32_bf16 v[72:75], v[180:183], a[136:139], v[72:75]
v_mfma_f32_16x16x32_bf16 v[72:75], v[184:187], a[140:143], v[72:75]
v_cvt_pk_bf16_f32 v88, v64, v65
v_cvt_pk_bf16_f32 v89, v66, v67
s_waitcnt lgkmcnt(3)
v_mfma_f32_16x16x32_bf16 v[76:79], v[188:191], a[0:3], 0
ds_read_b128 v[172:175], v252 offset:16384
s_waitcnt lgkmcnt(3)
v_mfma_f32_16x16x32_bf16 v[76:79], v[192:195], a[4:7], v[76:79]
s_waitcnt lgkmcnt(2)
v_mfma_f32_16x16x32_bf16 v[76:79], v[196:199], a[8:11], v[76:79]
ds_read_b128 v[176:179], v252 offset:17408
s_waitcnt lgkmcnt(2)
v_mfma_f32_16x16x32_bf16 v[76:79], v[200:203], a[12:15], v[76:79]
v_cvt_pk_bf16_f32 v92, v68, v69
v_cvt_pk_bf16_f32 v93, v70, v71
v_mfma_f32_16x16x32_bf16 v[80:83], v[188:191], a[48:51], 0
ds_read_b128 v[180:183], v252 offset:18432
v_mfma_f32_16x16x32_bf16 v[80:83], v[192:195], a[52:55], v[80:83]
v_mfma_f32_16x16x32_bf16 v[80:83], v[196:199], a[56:59], v[80:83]
ds_read_b128 v[184:187], v252 offset:19456
v_mfma_f32_16x16x32_bf16 v[80:83], v[200:203], a[60:63], v[80:83]
v_cvt_pk_bf16_f32 v96, v72, v73
v_cvt_pk_bf16_f32 v97, v74, v75
v_mfma_f32_16x16x32_bf16 v[84:87], v[188:191], a[96:99], 0
v_mfma_f32_16x16x32_bf16 v[84:87], v[192:195], a[100:103], v[84:87]
v_mfma_f32_16x16x32_bf16 v[84:87], v[196:199], a[104:107], v[84:87]
v_mfma_f32_16x16x32_bf16 v[84:87], v[200:203], a[108:111], v[84:87]
s_waitcnt lgkmcnt(3)
v_mfma_f32_16x16x32_bf16 v[76:79], v[172:175], a[16:19], v[76:79]
ds_read_b128 v[188:191], v252 offset:20480
s_waitcnt lgkmcnt(3)
v_mfma_f32_16x16x32_bf16 v[76:79], v[176:179], a[20:23], v[76:79]
s_waitcnt lgkmcnt(2)
v_mfma_f32_16x16x32_bf16 v[76:79], v[180:183], a[24:27], v[76:79]
ds_read_b128 v[192:195], v252 offset:21504
s_waitcnt lgkmcnt(2)
v_mfma_f32_16x16x32_bf16 v[76:79], v[184:187], a[28:31], v[76:79]
v_mfma_f32_16x16x32_bf16 v[80:83], v[172:175], a[64:67], v[80:83]
ds_read_b128 v[196:199], v252 offset:22528
v_mfma_f32_16x16x32_bf16 v[80:83], v[176:179], a[68:71], v[80:83]
v_mfma_f32_16x16x32_bf16 v[80:83], v[180:183], a[72:75], v[80:83]
ds_read_b128 v[200:203], v252 offset:23552
v_mfma_f32_16x16x32_bf16 v[80:83], v[184:187], a[76:79], v[80:83]
v_mfma_f32_16x16x32_bf16 v[84:87], v[172:175], a[112:115], v[84:87]
v_mfma_f32_16x16x32_bf16 v[84:87], v[176:179], a[116:119], v[84:87]
v_mfma_f32_16x16x32_bf16 v[84:87], v[180:183], a[120:123], v[84:87]
v_mfma_f32_16x16x32_bf16 v[84:87], v[184:187], a[124:127], v[84:87]
s_waitcnt vmcnt(21) lgkmcnt(0)
s_barrier
v_add_u32 v252, 4294893568, v252
v_mfma_f32_16x16x32_bf16 v[76:79], v[188:191], a[32:35], v[76:79]
s_add_u32 m0, s17, 73728
s_add_u32 s24, s25, 73728
v_mfma_f32_16x16x32_bf16 v[76:79], v[192:195], a[36:39], v[76:79]
ds_read_b128 v[172:175], v252 offset:0
v_mfma_f32_16x16x32_bf16 v[76:79], v[196:199], a[40:43], v[76:79]
buffer_load_dwordx4 v251, s[12:15], s24 offen offset:0  lds
v_mfma_f32_16x16x32_bf16 v[76:79], v[200:203], a[44:47], v[76:79]
ds_read_b128 v[176:179], v252 offset:1024
v_mfma_f32_16x16x32_bf16 v[80:83], v[188:191], a[80:83], v[80:83]
v_mfma_f32_16x16x32_bf16 v[80:83], v[192:195], a[84:87], v[80:83]
ds_read_b128 v[180:183], v252 offset:2048
v_mfma_f32_16x16x32_bf16 v[80:83], v[196:199], a[88:91], v[80:83]
buffer_load_dwordx4 v251, s[12:15], s24 offen offset:1024  lds
v_mfma_f32_16x16x32_bf16 v[80:83], v[200:203], a[92:95], v[80:83]
ds_read_b128 v[184:187], v252 offset:3072
v_mfma_f32_16x16x32_bf16 v[84:87], v[188:191], a[128:131], v[84:87]
v_mfma_f32_16x16x32_bf16 v[84:87], v[192:195], a[132:135], v[84:87]
v_mfma_f32_16x16x32_bf16 v[84:87], v[196:199], a[136:139], v[84:87]
buffer_load_dwordx4 v251, s[12:15], s24 offen offset:2048  lds
v_mfma_f32_16x16x32_bf16 v[84:87], v[200:203], a[140:143], v[84:87]
v_cvt_pk_bf16_f32 v90, v76, v77
v_cvt_pk_bf16_f32 v91, v78, v79
buffer_load_dwordx4 v251, s[12:15], s24 offen offset:3072  lds
v_cvt_pk_bf16_f32 v94, v80, v81
v_cvt_pk_bf16_f32 v95, v82, v83
s_add_u32 m0, s17, 77824
s_add_u32 s24, s25, 77824
buffer_load_dwordx4 v251, s[12:15], s24 offen offset:0  lds
v_cvt_pk_bf16_f32 v98, v84, v85
v_cvt_pk_bf16_f32 v99, v86, v87
buffer_load_dwordx4 v251, s[12:15], s24 offen offset:1024  lds
v_mfma_f32_16x16x32_bf16 v[0:3], a[44:47], v[88:91], v[0:3]
buffer_store_dwordx4 v[88:91], v237, s[40:43], s28 offen sc1
s_add_u32 s28, s28, 873472
v_mfma_f32_16x16x32_bf16 v[4:7], a[92:95], v[92:95], v[4:7]
buffer_store_dwordx4 v[92:95], v237, s[40:43], s29 offen sc1
s_add_u32 s29, s29, 873472
v_mfma_f32_16x16x32_bf16 v[8:11], a[140:143], v[96:99], v[8:11]
buffer_store_dwordx4 v[96:99], v237, s[40:43], s30 offen sc1
s_add_u32 s30, s30, 873472
s_add_u32 s27, s27, 1
v_and_b32 v115, 3, v113
v_cmp_eq_u32 s[34:35], 1, v115
s_nop 1
v_cndmask_b32 v0, v0, v1, s[34:35]
v_cmp_eq_u32 s[34:35], 2, v115
s_nop 1
v_cndmask_b32 v0, v0, v2, s[34:35]
v_cmp_eq_u32 s[34:35], 3, v115
s_nop 1
v_cndmask_b32 v0, v0, v3, s[34:35]
v_cmp_eq_u32 s[34:35], 1, v115
s_nop 1
v_cndmask_b32 v4, v4, v5, s[34:35]
v_cmp_eq_u32 s[34:35], 2, v115
s_nop 1
v_cndmask_b32 v4, v4, v6, s[34:35]
v_cmp_eq_u32 s[34:35], 3, v115
s_nop 1
v_cndmask_b32 v4, v4, v7, s[34:35]
v_cmp_eq_u32 s[34:35], 1, v115
s_nop 1
v_cndmask_b32 v8, v8, v9, s[34:35]
v_cmp_eq_u32 s[34:35], 2, v115
s_nop 1
v_cndmask_b32 v8, v8, v10, s[34:35]
v_cmp_eq_u32 s[34:35], 3, v115
s_nop 1
v_cndmask_b32 v8, v8, v11, s[34:35]
s_cmp_eq_u32 s20, 0
s_cselect_b32 s42, 6370816, 0
buffer_store_dword v0, v242, s[40:43], s23 offen sc1
buffer_store_dword v4, v243, s[40:43], s23 offen sc1
buffer_store_dword v8, v244, s[40:43], s23 offen sc1
s_mov_b32 s42, 6370816
s_waitcnt vmcnt(0)
s_barrier
s_cmp_lg_u32 s16, 0
s_cbranch_scc1 L_pnoflag
v_mov_b32 v115, 1
s_mov_b64 exec, 1
buffer_atomic_add v115, off, s[44:47], s26 sc1
s_mov_b64 exec, -1
L_pnoflag:
s_cmp_eq_u32 s36, 2
s_cselect_b32 s6, 0, 109734912
s_lshl_b32 s31, s27, 2
v_lshrrev_b32 v115, 2, v245
v_mul_u32_u24 v115, 12, v115
v_and_b32 v116, 3, v245
v_add_u32 v115, v115, v116
v_add_u32 v115, s31, v115
v_mul_u32_u24 v116, 19419, v115
v_lshrrev_b32 v116, 20, v116
v_mul_u32_u24 v117, 54, v116
v_sub_u32 v117, v115, v117
v_mul_u32_u24 v116, 2032128, v116
v_mul_u32_u24 v117, 5376, v117
v_add_u32 v118, v116, v117
v_lshl_add_u32 v118, v114, 4, v118
v_add_u32 v118, 1746432, v118
v_mov_b32 v116, 972
v_cmp_gt_u32 s[34:35], v116, v245
v_mov_b32 v116, 0x7fff0000
s_nop 0
v_cndmask_b32 v238, v116, v118, s[34:35]
buffer_load_dwordx4 a[0:3], v238, s[4:7], 0 offen offset:0
buffer_load_dwordx4 a[4:7], v238, s[4:7], 0 offen offset:64
buffer_load_dwordx4 a[8:11], v238, s[4:7], 0 offen offset:128
buffer_load_dwordx4 a[12:15], v238, s[4:7], 0 offen offset:192
buffer_load_dwordx4 a[16:19], v238, s[4:7], 0 offen offset:256
buffer_load_dwordx4 a[20:23], v238, s[4:7], 0 offen offset:320
buffer_load_dwordx4 a[24:27], v238, s[4:7], 0 offen offset:384
buffer_load_dwordx4 a[28:31], v238, s[4:7], 0 offen offset:448
buffer_load_dwordx4 a[32:35], v238, s[4:7], 0 offen offset:512
buffer_load_dwordx4 a[36:39], v238, s[4:7], 0 offen offset:576
buffer_load_dwordx4 a[40:43], v238, s[4:7], 0 offen offset:640
buffer_load_dwordx4 a[44:47], v238, s[4:7], 0 offen offset:704
v_lshrrev_b32 v115, 2, v246
v_mul_u32_u24 v115, 12, v115
v_and_b32 v116, 3, v246
v_add_u32 v115, v115, v116
v_add_u32 v115, s31, v115
v_mul_u32_u24 v116, 19419, v115
v_lshrrev_b32 v116, 20, v116
v_mul_u32_u24 v117, 54, v116
v_sub_u32 v117, v115, v117
v_mul_u32_u24 v116, 2032128, v116
v_mul_u32_u24 v117, 5376, v117
v_add_u32 v118, v116, v117
v_lshl_add_u32 v118, v114, 4, v118
v_add_u32 v118, 1746432, v118
v_mov_b32 v116, 972
v_cmp_gt_u32 s[34:35], v116, v246
v_mov_b32 v116, 0x7fff0000
s_nop 0
v_cndmask_b32 v238, v116, v118, s[34:35]
buffer_load_dwordx4 a[48:51], v238, s[4:7], 0 offen offset:0
buffer_load_dwordx4 a[52:55], v238, s[4:7], 0 offen offset:64
buffer_load_dwordx4 a[56:59], v238, s[4:7], 0 offen offset:128
buffer_load_dwordx4 a[60:63], v238, s[4:7], 0 offen offset:192
buffer_load_dwordx4 a[64:67], v238, s[4:7], 0 offen offset:256
buffer_load_dwordx4 a[68:71], v238, s[4:7], 0 offen offset:320
buffer_load_dwordx4 a[72:75], v238, s[4:7], 0 offen offset:384
buffer_load_dwordx4 a[76:79], v238, s[4:7], 0 offen offset:448
buffer_load_dwordx4 a[80:83], v238, s[4:7], 0 offen offset:512
buffer_load_dwordx4 a[84:87], v238, s[4:7], 0 offen offset:576
buffer_load_dwordx4 a[88:91], v238, s[4:7], 0 offen offset:640
buffer_load_dwordx4 a[92:95], v238, s[4:7], 0 offen offset:704
v_lshrrev_b32 v115, 2, v247
v_mul_u32_u24 v115, 12, v115
v_and_b32 v116, 3, v247
v_add_u32 v115, v115, v116
v_add_u32 v115, s31, v115
v_mul_u32_u24 v116, 19419, v115
v_lshrrev_b32 v116, 20, v116
v_mul_u32_u24 v117, 54, v116
v_sub_u32 v117, v115, v117
v_mul_u32_u24 v116, 2032128, v116
v_mul_u32_u24 v117, 5376, v117
v_add_u32 v118, v116, v117
v_lshl_add_u32 v118, v114, 4, v118
v_add_u32 v118, 1746432, v118
v_mov_b32 v116, 972
v_cmp_gt_u32 s[34:35], v116, v247
v_mov_b32 v116, 0x7fff0000
s_nop 0
v_cndmask_b32 v238, v116, v118, s[34:35]
buffer_load_dwordx4 a[96:99], v238, s[4:7], 0 offen offset:0
buffer_load_dwordx4 a[100:103], v238, s[4:7], 0 offen offset:64
buffer_load_dwordx4 a[104:107], v238, s[4:7], 0 offen offset:128
buffer_load_dwordx4 a[108:111], v238, s[4:7], 0 offen offset:192
buffer_load_dwordx4 a[112:115], v238, s[4:7], 0 offen offset:256
buffer_load_dwordx4 a[116:119], v238, s[4:7], 0 offen offset:320
buffer_load_dwordx4 a[120:123], v238, s[4:7], 0 offen offset:384
buffer_load_dwordx4 a[124:127], v238, s[4:7], 0 offen offset:448
buffer_load_dwordx4 a[128:131], v238, s[4:7], 0 offen offset:512
buffer_load_dwordx4 a[132:135], v238, s[4:7], 0 offen offset:576
buffer_load_dwordx4 a[136:139], v238, s[4:7], 0 offen offset:640
buffer_load_dwordx4 a[140:143], v238, s[4:7], 0 offen offset:704
s_add_u32 s23, s23, 4608
s_add_u32 s26, s26, 8
s_add_u32 s36, s36, 1
s_cmp_lt_u32 s36, 3
s_cbranch_scc1 L_ppass
s_endpgm
L_end:
s_endpgm
.section .rodata,"a"
.p2align 6
.amdhsa_kernel standalone__swin_window_attn__vision_kernel
  .amdhsa_next_free_vgpr 512
  .amdhsa_next_free_sgpr 100
  .amdhsa_accum_offset 256
  .amdhsa_group_segment_fixed_size 0
  .amdhsa_kernarg_size 48
  .amdhsa_user_sgpr_count 2
  .amdhsa_user_sgpr_kernarg_segment_ptr 1
  .amdhsa_system_sgpr_workgroup_id_x 1
  .amdhsa_float_denorm_mode_32 3
.end_amdhsa_kernel
.text
```
